```python
import torch

def _softmax(x, axis=-1):
    return torch.softmax(x, dim=axis)

def _gelu(x):
    return torch.nn.functional.gelu(x, approximate='tanh')

def _silu(x):
    return torch.nn.functional.silu(x)

def _sigmoid(x):
    return torch.sigmoid(x)

def _layernorm(x, axis=-1, eps=1e-05):
    m = x.mean(dim=axis, keepdim=True)
    v = x.var(dim=axis, keepdim=True, unbiased=False)
    return (x - m) / torch.sqrt(v + eps)

def _scatter_add(tgt, idx, src, axis=0):
    return tgt.clone().index_add_(axis, idx, src)

def _segment_sum(src, seg, n):
    out = torch.zeros((n,) + src.shape[1:], dtype=src.dtype)
    return out.index_add_(0, seg, src)

def _pad(x, pw):
    flat = tuple((v for pair in reversed(pw) for v in pair))
    return torch.nn.functional.pad(x, flat)
kernel_name = 'standalone__ragged_sequences_varlen_flash_attn__ragged'

def setup_inputs():

    _w = lambda a: (lambda t: t.to(torch.bfloat16) if t.is_floating_point() else t)(torch.as_tensor(a))
    cu = torch.tensor([0, 899, 1287, 3063, 3381, 3962, 4737, 5351, 7180], dtype=torch.int64)
    T = int(cu[-1])
    Hq, Hkv, D = (16, 4, 128)
    assert Hq % Hkv == 0
    return {'q': _w((lambda *s: torch.randn(*s, dtype=torch.bfloat16) * 0.8)(T, Hq, D)), 'k': _w((lambda *s: torch.randn(*s, dtype=torch.bfloat16) * 0.8)(T, Hkv, D)), 'v': _w((lambda *s: torch.randn(*s, dtype=torch.bfloat16) * 0.05)(T, Hkv, D)), 'cu': _w(cu)}

def reference(q, k, v, cu):
    T, Hq, D = q.shape
    Hkv = k.shape[1]
    rep = Hq // Hkv
    scale = D ** (-0.5)
    outs = []
    for i in range(len(cu) - 1):
        s, e = (int(cu[i]), int(cu[i + 1]))
        L = e - s
        qi = q[s:e].clone()
        ki = (lambda x, n, axis: torch.repeat_interleave(x, n, dim=axis))(k[s:e], rep, axis=1)
        vi = (lambda x, n, axis: torch.repeat_interleave(x, n, dim=axis))(v[s:e], rep, axis=1)
        logits = torch.einsum('qhd,khd->hqk', qi, ki) * scale
        ar = torch.arange(L)
        neg = (lambda x, dt: x.to(dt))(ar[None, :] > ar[:, None], logits.dtype) * -1000000000.0
        p = _softmax(logits + neg[None, :, :], axis=-1)
        outs.append(torch.einsum('hqk,khd->qhd', p, vi))
    return torch.concatenate(outs, axis=0)
```

```asm
; @launch grid=(256,1,1) block=(256,1,1) lds=163840
.amdgcn_target "amdgcn-amd-amdhsa--gfx950"
.text
.globl standalone__ragged_sequences_varlen_flash_attn__ragged_kernel
.p2align 8
.type standalone__ragged_sequences_varlen_flash_attn__ragged_kernel,@function
standalone__ragged_sequences_varlen_flash_attn__ragged_kernel:
    s_cmp_ge_u32 s2, 256
    s_cbranch_scc1 L_end
    s_load_dwordx2 s[12:13], s[0:1], 8
    s_load_dwordx2 s[8:9], s[0:1], 0
    s_load_dwordx2 s[16:17], s[0:1], 16
    s_load_dwordx2 s[20:21], s[0:1], 32
    s_getpc_b64 s[32:33]
L_pc:
    s_add_u32 s32, s32, jobtab-L_pc
    s_addc_u32 s33, s33, 0
    v_lshrrev_b32 v1, 6, v0
    v_and_b32 v15, 63, v0
    v_readfirstlane_b32 s27, v1
    s_nop 3
    s_lshr_b32 s28, s27, 1
    s_and_b32 s29, s27, 1
    s_lshl_b32 s3, s2, 7
    s_lshl_b32 s4, s28, 6
    s_add_u32 s3, s3, s4
    s_add_u32 s32, s32, s3
    s_addc_u32 s33, s33, 0
    s_load_dwordx4 s[72:75], s[32:33], 0
    s_load_dwordx8 s[88:95], s[32:33], 16
    s_mov_b32 s24, 0x3e0293ee
    s_mov_b32 s25, 0x53800000
    s_mov_b32 s26, 0x80000000
    s_mov_b32 s76, 0x3c000
    s_lshl_b32 s78, s28, 16
    s_lshl_b32 s3, s29, 13
    s_add_u32 s78, s78, s3
    s_add_u32 s78, s78, 0xc000
    s_lshl_b32 s96, s27, 11
    s_lshl_b32 s97, s28, 16
    s_lshl_b32 s3, s29, 12
    s_add_u32 s97, s97, s3
    v_lshrrev_b32 v5, 4, v15
    v_and_b32 v6, 15, v15
    v_xor_b32 v7, v6, v5
    v_lshlrev_b32 v7, 4, v7
    v_lshl_add_u32 v2, v5, 10, v7
    v_lshl_add_u32 v8, v5, 12, v7
    v_xor_b32 v9, 64, v8
    v_xor_b32 v10, 0x80, v8
    v_xor_b32 v11, 0xc0, v8
    v_lshrrev_b32 v4, 1, v15
    v_and_b32 v12, 1, v15
    v_lshlrev_b32 v12, 7, v12
    v_lshl_add_u32 v12, v4, 10, v12
    v_lshlrev_b32 v7, 2, v5
    v_xor_b32 v7, v6, v7
    v_lshlrev_b32 v7, 4, v7
    v_lshl_add_u32 v3, v5, 10, v7
    s_lshl_b32 s5, s27, 1
    s_add_u32 s3, s5, 0
    s_and_b32 s4, s3, 3
    s_lshl_b32 s4, s4, 6
    s_lshl_b32 s3, s3, 12
    s_sub_u32 s3, s3, 0
    v_xor_b32 v0, s4, v2
    v_add_u32 v0, s3, v0
    v_add_u32 v78, s3, v3
    s_add_u32 s3, s5, 1
    s_and_b32 s4, s3, 3
    s_lshl_b32 s4, s4, 6
    s_lshl_b32 s3, s3, 12
    s_sub_u32 s3, s3, 1024
    v_xor_b32 v1, s4, v2
    v_add_u32 v1, s3, v1
    v_add_u32 v79, s3, v3
    s_lshl_b32 s5, s29, 2
    s_add_u32 s3, s5, 0
    s_and_b32 s4, s3, 3
    s_lshl_b32 s4, s4, 6
    s_lshl_b32 s3, s3, 12
    s_sub_u32 s3, s3, 0
    v_xor_b32 v48, s4, v2
    v_add_u32 v48, s3, v48
    v_add_u32 v52, s3, v3
    s_add_u32 s3, s5, 1
    s_and_b32 s4, s3, 3
    s_lshl_b32 s4, s4, 6
    s_lshl_b32 s3, s3, 12
    s_sub_u32 s3, s3, 1024
    v_xor_b32 v49, s4, v2
    v_add_u32 v49, s3, v49
    v_add_u32 v53, s3, v3
    s_add_u32 s3, s5, 2
    s_and_b32 s4, s3, 3
    s_lshl_b32 s4, s4, 6
    s_lshl_b32 s3, s3, 12
    s_sub_u32 s3, s3, 2048
    v_xor_b32 v50, s4, v2
    v_add_u32 v50, s3, v50
    v_add_u32 v54, s3, v3
    s_add_u32 s3, s5, 3
    s_and_b32 s4, s3, 3
    s_lshl_b32 s4, s4, 6
    s_lshl_b32 s3, s3, 12
    s_sub_u32 s3, s3, 3072
    v_xor_b32 v51, s4, v2
    v_add_u32 v51, s3, v51
    v_add_u32 v55, s3, v3
    s_mov_b32 s10, 29409280
    s_mov_b32 s11, 0x00020000
    s_mov_b32 s14, 7352320
    s_mov_b32 s15, 0x00020000
    s_mov_b32 s18, 7352320
    s_mov_b32 s19, 0x00020000
    s_mov_b32 s22, 29409280
    s_mov_b32 s23, 0x00020000
    s_mov_b32 s39, 0
    s_mov_b32 s3, 1
    s_waitcnt lgkmcnt(0)
    s_lshl_b32 s50, s28, 16
    s_bitcmp1_b32 s75, 10
    s_cselect_b32 s68, s50, 0
    s_cselect_b32 s50, s97, s96
    s_add_u32 s60, s50, 0
    s_add_u32 s64, s50, 32768
    s_add_u32 s61, s50, 8192
    s_add_u32 s65, s50, 40960
    s_add_u32 s62, s50, 16384
    s_add_u32 s66, s50, 49152
    s_add_u32 s63, s50, 24576
    s_add_u32 s67, s50, 57344
    s_sub_u32 s54, s73, 0
    s_cmp_gt_i32 s74, 0
    s_cselect_b32 s54, s54, s26
    s_cselect_b32 m0, s60, s76
    s_bitcmp1_b32 s75, 10
    s_cbranch_scc1 L_pfb1
    buffer_load_dwordx4 v0, s[12:15], s54 offen offset:0 nt lds
    buffer_load_dwordx4 v1, s[12:15], s54 offen offset:1024 nt lds
L_pfe1:
    s_lshl_b32 s50, s29, 9
    s_add_u32 s47, s72, s50
    s_lshl_b32 s50, s28, 8
    s_add_u32 s51, s47, s50
    s_lshl_b32 s50, s27, 13
    s_add_u32 s52, s50, 0x20000
    s_add_u32 s7, s50, 0x10000
    s_lshl_b32 s50, s29, 14
    s_add_u32 s55, s50, 0x20000
    s_add_u32 s56, s50, 0x22000
    s_lshl_b32 s50, s28, 13
    s_add_u32 s57, s55, s50
    s_add_u32 s6, s47, 256
    s_bitcmp1_b32 s75, 10
    s_cselect_b32 s47, s51, s47
    s_cselect_b32 s77, s55, s52
    s_cselect_b32 s79, s56, s7
    s_cselect_b32 s48, s57, s52
    s_cselect_b32 s71, s57, s7
    s_cselect_b32 s46, 9, 17
    s_cselect_b32 s70, 0, 0xfffe0100
    s_cselect_b32 s5, 0, 1
    s_lshr_b32 s50, s39, 10
    s_and_b32 s5, s5, s50
    s_cmp_eq_u32 s5, 1
    s_cselect_b32 s46, 9, s46
    s_cselect_b32 s70, 0, s70
    s_cselect_b32 s71, s48, s71
    s_bitcmp1_b32 s75, 11
    s_cselect_b32 s46, s46, 0
    s_cselect_b32 s5, s5, 0
    s_and_b32 s50, s75, 0x600
    s_cmp_eq_u32 s50, 0x200
    s_cbranch_scc1 L_noq
    s_call_b64 s[30:31], L_qrem_0
    s_bitcmp1_b32 s75, 10
    s_cbranch_scc0 L_nokv
L_noq:
    s_sub_u32 s54, s73, 0x8000
    s_add_u32 m0, s97, 8192
    s_nop 0
    buffer_load_dwordx4 v48, s[12:15], s54 offen offset:0 nt lds
    buffer_load_dwordx4 v49, s[12:15], s54 offen offset:1024 nt lds
    buffer_load_dwordx4 v50, s[12:15], s54 offen offset:2048 nt lds
    buffer_load_dwordx4 v51, s[12:15], s54 offen offset:3072 nt lds
    s_add_u32 m0, s97, 32768
    s_nop 0
    buffer_load_dwordx4 v52, s[16:19], s73 offen offset:0 nt lds
    buffer_load_dwordx4 v53, s[16:19], s73 offen offset:1024 nt lds
    buffer_load_dwordx4 v54, s[16:19], s73 offen offset:2048 nt lds
    buffer_load_dwordx4 v55, s[16:19], s73 offen offset:3072 nt lds
L_nokv:
    v_accvgpr_write_b32 a128, 0
    v_accvgpr_write_b32 a129, 0
    v_accvgpr_write_b32 a130, 0
    v_accvgpr_write_b32 a131, 0
    v_mov_b32 v14, 0xffff
    v_and_b32 v6, 31, v15
    v_lshrrev_b32 v2, 5, v15
    v_lshlrev_b32 v3, 2, v2
    v_sub_u32 v3, v3, v6
    v_mov_b32 v4, 0xf149f2ca
    v_cmp_lt_i32 vcc, 0, v3
    s_nop 1
    v_cndmask_b32 v16, 0, v4, vcc
    v_cmp_lt_i32 vcc, -1, v3
    s_nop 1
    v_cndmask_b32 v17, 0, v4, vcc
    v_cmp_lt_i32 vcc, -2, v3
    s_nop 1
    v_cndmask_b32 v18, 0, v4, vcc
    v_cmp_lt_i32 vcc, -3, v3
    s_nop 1
    v_cndmask_b32 v19, 0, v4, vcc
    v_cmp_lt_i32 vcc, -8, v3
    s_nop 1
    v_cndmask_b32 v20, 0, v4, vcc
    v_cmp_lt_i32 vcc, -9, v3
    s_nop 1
    v_cndmask_b32 v21, 0, v4, vcc
    v_cmp_lt_i32 vcc, -10, v3
    s_nop 1
    v_cndmask_b32 v22, 0, v4, vcc
    v_cmp_lt_i32 vcc, -11, v3
    s_nop 1
    v_cndmask_b32 v23, 0, v4, vcc
    v_cmp_lt_i32 vcc, -16, v3
    s_nop 1
    v_cndmask_b32 v24, 0, v4, vcc
    v_cmp_lt_i32 vcc, -17, v3
    s_nop 1
    v_cndmask_b32 v25, 0, v4, vcc
    v_cmp_lt_i32 vcc, -18, v3
    s_nop 1
    v_cndmask_b32 v26, 0, v4, vcc
    v_cmp_lt_i32 vcc, -19, v3
    s_nop 1
    v_cndmask_b32 v27, 0, v4, vcc
    v_cmp_lt_i32 vcc, -24, v3
    s_nop 1
    v_cndmask_b32 v28, 0, v4, vcc
    v_cmp_lt_i32 vcc, -25, v3
    s_nop 1
    v_cndmask_b32 v29, 0, v4, vcc
    v_cmp_lt_i32 vcc, -26, v3
    s_nop 1
    v_cndmask_b32 v30, 0, v4, vcc
    v_cmp_lt_i32 vcc, -27, v3
    s_nop 1
    v_cndmask_b32 v31, 0, v4, vcc
    v_and_b32 v5, 15, v6
    v_xor_b32 v5, v5, v2
    v_lshlrev_b32 v5, 4, v5
    v_lshl_add_u32 v5, v6, 8, v5
    v_xor_b32 v60, 0, v5
    v_xor_b32 v61, 32, v5
    v_xor_b32 v62, 64, v5
    v_xor_b32 v63, 96, v5
    v_xor_b32 v64, 128, v5
    v_xor_b32 v65, 160, v5
    v_xor_b32 v66, 192, v5
    v_xor_b32 v67, 224, v5
    v_bfe_u32 v5, v15, 2, 2
    v_lshl_add_u32 v6, v2, 2, v5
    v_lshlrev_b32 v6, 8, v6
    v_lshl_add_u32 v6, v5, 6, v6
    v_bfe_u32 v7, v15, 4, 1
    v_lshl_add_u32 v6, v7, 5, v6
    v_and_b32 v7, 3, v15
    v_lshl_add_u32 v6, v7, 3, v6
    v_xor_b32 v56, 0, v6
    v_xor_b32 v57, 64, v6
    v_xor_b32 v58, 128, v6
    v_xor_b32 v59, 192, v6
    s_and_b32 s50, s75, 0x600
    s_cmp_eq_u32 s50, 0
    s_cselect_b32 s4, 2, 3
    s_branch L_job
L_qrem_0:
    s_sub_u32 s46, s46, 1
    s_cmp_eq_u32 s46, 8
    s_cselect_b32 s69, s70, 0
    s_cselect_b32 s48, s71, s48
    s_add_u32 s47, s47, s69
    s_cmp_gt_i32 s46, 0
    s_cbranch_scc0 L_qrem_done
    s_mov_b32 s49, s47
    s_mov_b32 m0, s48
    s_add_u32 s47, s47, 0x4000
    buffer_load_dwordx4 v8, s[8:11], s49 offen nt lds
    s_add_u32 s48, s48, 0x400
L_qrem_1:
    s_sub_u32 s46, s46, 1
    s_cmp_eq_u32 s46, 8
    s_cselect_b32 s69, s70, 0
    s_cselect_b32 s48, s71, s48
    s_add_u32 s47, s47, s69
    s_cmp_gt_i32 s46, 0
    s_cbranch_scc0 L_qrem_done
    s_mov_b32 s49, s47
    s_mov_b32 m0, s48
    s_add_u32 s47, s47, 0x4000
    buffer_load_dwordx4 v9, s[8:11], s49 offen nt lds
    s_add_u32 s48, s48, 0x400
L_qrem_2:
    s_sub_u32 s46, s46, 1
    s_cmp_eq_u32 s46, 8
    s_cselect_b32 s69, s70, 0
    s_cselect_b32 s48, s71, s48
    s_add_u32 s47, s47, s69
    s_cmp_gt_i32 s46, 0
    s_cbranch_scc0 L_qrem_done
    s_mov_b32 s49, s47
    s_mov_b32 m0, s48
    s_add_u32 s47, s47, 0x4000
    buffer_load_dwordx4 v10, s[8:11], s49 offen nt lds
    s_add_u32 s48, s48, 0x400
L_qrem_3:
    s_sub_u32 s46, s46, 1
    s_cmp_eq_u32 s46, 8
    s_cselect_b32 s69, s70, 0
    s_cselect_b32 s48, s71, s48
    s_add_u32 s47, s47, s69
    s_cmp_gt_i32 s46, 0
    s_cbranch_scc0 L_qrem_done
    s_mov_b32 s49, s47
    s_mov_b32 m0, s48
    s_add_u32 s47, s47, 0x4000
    buffer_load_dwordx4 v11, s[8:11], s49 offen nt lds
    s_add_u32 s48, s48, 0x400
    s_branch L_qrem_0
L_qrem_done:
    s_cmp_eq_u32 s5, 0
    s_cbranch_scc1 L_qrem_ret
    s_mov_b32 s5, 0
    s_mov_b32 s47, s6
    s_mov_b32 s48, s7
    s_mov_b32 s71, s7
    s_mov_b32 s46, 9
    s_branch L_qrem_0
L_qrem_ret:
    s_setpc_b64 s[30:31]
L_pfb1:
    buffer_load_dwordx4 v48, s[12:15], s54 offen offset:0 nt lds
    buffer_load_dwordx4 v49, s[12:15], s54 offen offset:1024 nt lds
    buffer_load_dwordx4 v50, s[12:15], s54 offen offset:2048 nt lds
    buffer_load_dwordx4 v51, s[12:15], s54 offen offset:3072 nt lds
    s_branch L_pfe1
L_job:
    s_bitcmp1_b32 s75, 11
    s_cbranch_scc0 L_end
    v_and_or_b32 v80, v60, v14, s77
    v_and_or_b32 v88, v60, v14, s79
    v_and_or_b32 v81, v61, v14, s77
    v_and_or_b32 v89, v61, v14, s79
    v_and_or_b32 v82, v62, v14, s77
    v_and_or_b32 v90, v62, v14, s79
    v_and_or_b32 v83, v63, v14, s77
    v_and_or_b32 v91, v63, v14, s79
    v_and_or_b32 v84, v64, v14, s77
    v_and_or_b32 v92, v64, v14, s79
    v_and_or_b32 v85, v65, v14, s77
    v_and_or_b32 v93, v65, v14, s79
    v_and_or_b32 v86, v66, v14, s77
    v_and_or_b32 v94, v66, v14, s79
    v_and_or_b32 v87, v67, v14, s77
    v_and_or_b32 v95, v67, v14, s79
    s_mov_b64 s[36:37], s[72:73]
    s_mov_b64 s[38:39], s[74:75]
    s_mov_b64 s[72:73], s[88:89]
    s_mov_b64 s[74:75], s[90:91]
    s_mov_b64 s[88:89], s[92:93]
    s_mov_b64 s[90:91], s[94:95]
    s_mov_b64 s[94:95], 0
    s_lshl_b32 s50, s29, 9
    s_add_u32 s40, s36, s50
    v_and_or_b32 v60, v60, v14, s68
    v_and_or_b32 v61, v61, v14, s68
    v_and_or_b32 v62, v62, v14, s68
    v_and_or_b32 v63, v63, v14, s68
    v_and_or_b32 v64, v64, v14, s68
    v_and_or_b32 v65, v65, v14, s68
    v_and_or_b32 v66, v66, v14, s68
    v_and_or_b32 v67, v67, v14, s68
    v_and_or_b32 v56, v56, v14, s68
    v_and_or_b32 v57, v57, v14, s68
    v_and_or_b32 v58, v58, v14, s68
    v_and_or_b32 v59, v59, v14, s68
    s_bitcmp1_b32 s39, 8
    s_cselect_b32 s50, -1, 0
    v_and_b32 v32, s50, v16
    v_and_b32 v33, s50, v17
    v_and_b32 v34, s50, v18
    v_and_b32 v35, s50, v19
    v_and_b32 v36, s50, v20
    v_and_b32 v37, s50, v21
    v_and_b32 v38, s50, v22
    v_and_b32 v39, s50, v23
    v_and_b32 v40, s50, v24
    v_and_b32 v41, s50, v25
    v_and_b32 v42, s50, v26
    v_and_b32 v43, s50, v27
    v_and_b32 v44, s50, v28
    v_and_b32 v45, s50, v29
    v_and_b32 v46, s50, v30
    v_and_b32 v47, s50, v31
    s_sub_u32 s42, s38, 2
    s_sub_u32 s41, s37, 0x10000
    s_cmp_ge_u32 s4, 2
    s_cbranch_scc1 L_js_first
    s_lshl_b32 s50, s29, 9
    s_add_u32 s47, s72, s50
    s_lshl_b32 s50, s28, 8
    s_add_u32 s51, s47, s50
    s_lshl_b32 s50, s27, 13
    s_add_u32 s52, s50, 0x20000
    s_add_u32 s7, s50, 0x10000
    s_lshl_b32 s50, s29, 14
    s_add_u32 s55, s50, 0x20000
    s_add_u32 s56, s50, 0x22000
    s_lshl_b32 s50, s28, 13
    s_add_u32 s57, s55, s50
    s_add_u32 s6, s47, 256
    s_bitcmp1_b32 s75, 10
    s_cselect_b32 s47, s51, s47
    s_cselect_b32 s77, s55, s52
    s_cselect_b32 s79, s56, s7
    s_cselect_b32 s48, s57, s52
    s_cselect_b32 s71, s57, s7
    s_cselect_b32 s46, 9, 17
    s_cselect_b32 s70, 0, 0xfffe0100
    s_cselect_b32 s5, 0, 1
    s_lshr_b32 s50, s39, 10
    s_and_b32 s5, s5, s50
    s_cmp_eq_u32 s5, 1
    s_cselect_b32 s46, 9, s46
    s_cselect_b32 s70, 0, s70
    s_cselect_b32 s71, s48, s71
    s_bitcmp1_b32 s75, 11
    s_cselect_b32 s46, s46, 0
    s_cselect_b32 s5, s5, 0
    s_cmp_eq_u32 s4, 0
    s_cbranch_scc1 L_js_w0
    s_waitcnt vmcnt(18)
L_js_w0:
    s_waitcnt vmcnt(26)
    s_barrier
    ds_read_b128 a[0:3], v80
    ds_read_b128 a[4:7], v81
    ds_read_b128 a[8:11], v82
    ds_read_b128 a[12:15], v83
    ds_read_b128 a[16:19], v84
    ds_read_b128 a[20:23], v85
    ds_read_b128 a[24:27], v86
    ds_read_b128 a[28:31], v87
    ds_read_b128 a[32:35], v88
    ds_read_b128 a[36:39], v89
    ds_read_b128 a[40:43], v90
    ds_read_b128 a[44:47], v91
    ds_read_b128 a[48:51], v92
    ds_read_b128 a[52:55], v93
    ds_read_b128 a[56:59], v94
    ds_read_b128 a[60:63], v95
    s_branch L_js_go
L_js_first:
    s_waitcnt vmcnt(8)
    s_barrier
    ds_read_b128 a[0:3], v80
    ds_read_b128 a[4:7], v81
    ds_read_b128 a[8:11], v82
    ds_read_b128 a[12:15], v83
    ds_read_b128 a[16:19], v84
    ds_read_b128 a[20:23], v85
    ds_read_b128 a[24:27], v86
    ds_read_b128 a[28:31], v87
    ds_read_b128 a[32:35], v88
    ds_read_b128 a[36:39], v89
    ds_read_b128 a[40:43], v90
    ds_read_b128 a[44:47], v91
    ds_read_b128 a[48:51], v92
    ds_read_b128 a[52:55], v93
    ds_read_b128 a[56:59], v94
    ds_read_b128 a[60:63], v95
    s_call_b64 s[30:31], L_qrem_0
    s_lshl_b32 s50, s29, 9
    s_add_u32 s47, s72, s50
    s_lshl_b32 s50, s28, 8
    s_add_u32 s51, s47, s50
    s_lshl_b32 s50, s27, 13
    s_add_u32 s52, s50, 0x20000
    s_add_u32 s7, s50, 0x10000
    s_lshl_b32 s50, s29, 14
    s_add_u32 s55, s50, 0x20000
    s_add_u32 s56, s50, 0x22000
    s_lshl_b32 s50, s28, 13
    s_add_u32 s57, s55, s50
    s_add_u32 s6, s47, 256
    s_bitcmp1_b32 s75, 10
    s_cselect_b32 s47, s51, s47
    s_cselect_b32 s77, s55, s52
    s_cselect_b32 s79, s56, s7
    s_cselect_b32 s48, s57, s52
    s_cselect_b32 s71, s57, s7
    s_cselect_b32 s46, 9, 17
    s_cselect_b32 s70, 0, 0xfffe0100
    s_cselect_b32 s5, 0, 1
    s_lshr_b32 s50, s39, 10
    s_and_b32 s5, s5, s50
    s_cmp_eq_u32 s5, 1
    s_cselect_b32 s46, 9, s46
    s_cselect_b32 s70, 0, s70
    s_cselect_b32 s71, s48, s71
    s_bitcmp1_b32 s75, 11
    s_cselect_b32 s46, s46, 0
    s_cselect_b32 s5, s5, 0
L_js_go:
    s_bitcmp1_b32 s39, 10
    s_cbranch_scc1 L_pre_B
    s_branch L_pre_A

L_pfb3:
    buffer_load_dwordx4 v48, s[12:15], s54 offen offset:0 nt lds
    buffer_load_dwordx4 v49, s[12:15], s54 offen offset:1024 nt lds
    buffer_load_dwordx4 v50, s[12:15], s54 offen offset:2048 nt lds
    buffer_load_dwordx4 v51, s[12:15], s54 offen offset:3072 nt lds
    s_branch L_pfe3
L_pfb4:
    buffer_load_dwordx4 v52, s[16:19], s54 offen offset:0 nt lds
    buffer_load_dwordx4 v53, s[16:19], s54 offen offset:1024 nt lds
    buffer_load_dwordx4 v54, s[16:19], s54 offen offset:2048 nt lds
    buffer_load_dwordx4 v55, s[16:19], s54 offen offset:3072 nt lds
    s_branch L_pfe4
L_pfb5:
    buffer_load_dwordx4 v48, s[12:15], s54 offen offset:0 nt lds
    buffer_load_dwordx4 v49, s[12:15], s54 offen offset:1024 nt lds
    buffer_load_dwordx4 v50, s[12:15], s54 offen offset:2048 nt lds
    buffer_load_dwordx4 v51, s[12:15], s54 offen offset:3072 nt lds
    s_branch L_pfe5
L_hb2:
    s_sub_u32 s54, s37, 65536
    s_cmp_gt_i32 s38, 2
    s_cselect_b32 s54, s54, s26
    s_cselect_b32 m0, s62, s76
    s_bitcmp1_b32 s39, 10
    s_cbranch_scc1 L_pfb3
    buffer_load_dwordx4 v0, s[12:15], s54 offen offset:0 nt lds
    buffer_load_dwordx4 v1, s[12:15], s54 offen offset:1024 nt lds
L_pfe3:
    s_sub_u32 s54, s37, 32768
    s_cmp_gt_i32 s38, 1
    s_cselect_b32 s54, s54, s26
    s_cselect_b32 m0, s65, s76
    s_bitcmp1_b32 s39, 10
    s_cbranch_scc1 L_pfb4
    buffer_load_dwordx4 v78, s[16:19], s54 offen offset:0 nt lds
    buffer_load_dwordx4 v79, s[16:19], s54 offen offset:1024 nt lds
L_pfe4:
    s_sub_u32 s54, s37, 98304
    s_cmp_gt_i32 s38, 3
    s_cselect_b32 s54, s54, s26
    s_cselect_b32 m0, s63, s76
    s_bitcmp1_b32 s39, 10
    s_cbranch_scc1 L_pfb5
    buffer_load_dwordx4 v0, s[12:15], s54 offen offset:0 nt lds
    buffer_load_dwordx4 v1, s[12:15], s54 offen offset:1024 nt lds
L_pfe5:
    s_mov_b32 m0, s76
    s_mov_b32 s49, s26
    buffer_load_dwordx4 v8, s[8:11], s49 offen nt lds
    buffer_load_dwordx4 v8, s[8:11], s49 offen nt lds
    buffer_load_dwordx4 v8, s[8:11], s49 offen nt lds
    buffer_load_dwordx4 v8, s[8:11], s49 offen nt lds
    buffer_load_dwordx4 v8, s[8:11], s49 offen nt lds
    s_waitcnt vmcnt(29)
    s_branch L_hc2
L_cold6:
    s_mov_b32 s3, 0
    s_waitcnt vmcnt(16)
    ds_read_b128 a[0:3], v80
    ds_read_b128 a[4:7], v81
    ds_read_b128 a[8:11], v82
    ds_read_b128 a[12:15], v83
    ds_read_b128 a[16:19], v84
    ds_read_b128 a[20:23], v85
    ds_read_b128 a[24:27], v86
    ds_read_b128 a[28:31], v87
    ds_read_b128 a[32:35], v88
    ds_read_b128 a[36:39], v89
    ds_read_b128 a[40:43], v90
    ds_read_b128 a[44:47], v91
    ds_read_b128 a[48:51], v92
    ds_read_b128 a[52:55], v93
    ds_read_b128 a[56:59], v94
    ds_read_b128 a[60:63], v95
    s_branch L_back6
L_cold7:
    s_waitcnt vmcnt(2)
    ds_read_b128 a[32:35], v88
    ds_read_b128 a[36:39], v89
    ds_read_b128 a[40:43], v90
    ds_read_b128 a[44:47], v91
    ds_read_b128 a[48:51], v92
    ds_read_b128 a[52:55], v93
    ds_read_b128 a[56:59], v94
    ds_read_b128 a[60:63], v95
    s_waitcnt lgkmcnt(0)
    s_branch L_back7
L_pfb9:
    buffer_load_dwordx4 v48, s[12:15], s54 offen offset:0 nt lds
    buffer_load_dwordx4 v49, s[12:15], s54 offen offset:1024 nt lds
    buffer_load_dwordx4 v50, s[12:15], s54 offen offset:2048 nt lds
    buffer_load_dwordx4 v51, s[12:15], s54 offen offset:3072 nt lds
    s_branch L_pfe9
L_pfb10:
    buffer_load_dwordx4 v52, s[16:19], s54 offen offset:0 nt lds
    buffer_load_dwordx4 v53, s[16:19], s54 offen offset:1024 nt lds
    buffer_load_dwordx4 v54, s[16:19], s54 offen offset:2048 nt lds
    buffer_load_dwordx4 v55, s[16:19], s54 offen offset:3072 nt lds
    s_branch L_pfe10
L_pfb11:
    buffer_load_dwordx4 v48, s[12:15], s54 offen offset:0 nt lds
    buffer_load_dwordx4 v49, s[12:15], s54 offen offset:1024 nt lds
    buffer_load_dwordx4 v50, s[12:15], s54 offen offset:2048 nt lds
    buffer_load_dwordx4 v51, s[12:15], s54 offen offset:3072 nt lds
    s_branch L_pfe11
L_hb8:
    s_sub_u32 s54, s37, 65536
    s_cmp_gt_i32 s38, 2
    s_cselect_b32 s54, s54, s26
    s_cselect_b32 m0, s62, s76
    s_bitcmp1_b32 s39, 10
    s_cbranch_scc1 L_pfb9
    buffer_load_dwordx4 v0, s[12:15], s54 offen offset:0 nt lds
    buffer_load_dwordx4 v1, s[12:15], s54 offen offset:1024 nt lds
L_pfe9:
    s_sub_u32 s54, s37, 32768
    s_cmp_gt_i32 s38, 1
    s_cselect_b32 s54, s54, s26
    s_cselect_b32 m0, s65, s76
    s_bitcmp1_b32 s39, 10
    s_cbranch_scc1 L_pfb10
    buffer_load_dwordx4 v78, s[16:19], s54 offen offset:0 nt lds
    buffer_load_dwordx4 v79, s[16:19], s54 offen offset:1024 nt lds
L_pfe10:
    s_sub_u32 s54, s37, 98304
    s_cmp_gt_i32 s38, 3
    s_cselect_b32 s54, s54, s26
    s_cselect_b32 m0, s63, s76
    s_bitcmp1_b32 s39, 10
    s_cbranch_scc1 L_pfb11
    buffer_load_dwordx4 v0, s[12:15], s54 offen offset:0 nt lds
    buffer_load_dwordx4 v1, s[12:15], s54 offen offset:1024 nt lds
L_pfe11:
    s_mov_b32 m0, s76
    s_mov_b32 s49, s26
    buffer_load_dwordx4 v8, s[8:11], s49 offen nt lds
    buffer_load_dwordx4 v8, s[8:11], s49 offen nt lds
    buffer_load_dwordx4 v8, s[8:11], s49 offen nt lds
    buffer_load_dwordx4 v8, s[8:11], s49 offen nt lds
    buffer_load_dwordx4 v8, s[8:11], s49 offen nt lds
    s_mov_b32 s3, 0
    s_waitcnt vmcnt(13)
    s_branch L_hc8
L_pre_A:
    s_bitcmp1_b32 s39, 9
    s_cbranch_scc0 L_head_A_0
L_idle_A:
    s_sub_u32 s46, s46, 1
    s_cmp_eq_u32 s46, 8
    s_cselect_b32 s69, s70, 0
    s_cselect_b32 s48, s71, s48
    s_add_u32 s47, s47, s69
    s_cmp_gt_i32 s42, 0
    s_cselect_b32 s44, s41, s26
    s_cselect_b32 m0, s66, s76
    s_sub_u32 s45, s41, 0x10000
    s_sub_u32 s41, s41, 0x8000
    buffer_load_dwordx4 v78, s[16:19], s44 offen offset:0 lds
    buffer_load_dwordx4 v79, s[16:19], s44 offen offset:1024 lds
    s_cmp_lg_u32 s3, 0
    s_cbranch_scc1 L_hb2
    s_waitcnt vmcnt(8)
L_hc2:
    s_barrier
    s_cmp_gt_i32 s42, 2
    s_cselect_b32 s43, s45, s26
    s_cselect_b32 m0, s60, s76
    s_sub_u32 s42, s42, 1
    buffer_load_dwordx4 v0, s[12:15], s43 offen offset:0 lds
    buffer_load_dwordx4 v1, s[12:15], s43 offen offset:1024 lds
    s_mov_b32 m0, s76
    s_mov_b32 s49, s26
    s_add_u32 s46, s46, 1
    buffer_load_dwordx4 v8, s[8:11], s49 offen nt lds
L_head_A_1:
    s_cmp_lg_u32 s3, 0
    s_cbranch_scc1 L_cold6
L_back6:
    ds_read_b128 a[64:67], v60 offset:8192
    ds_read_b128 a[68:71], v61 offset:8192
    ds_read_b128 a[72:75], v62 offset:8192
    ds_read_b128 a[76:79], v63 offset:8192
    ds_read_b128 a[80:83], v64 offset:8192
    ds_read_b128 a[84:87], v65 offset:8192
    ds_read_b128 a[88:91], v66 offset:8192
    ds_read_b128 a[92:95], v67 offset:8192
    v_mfma_f32_32x32x16_bf16 v[128:143], a[128:131], a[128:131], 0
    s_sub_u32 s46, s46, 1
    s_cmp_eq_u32 s46, 8
    s_cselect_b32 s69, s70, 0
    s_cselect_b32 s48, s71, s48
    s_add_u32 s47, s47, s69
    s_cmp_gt_i32 s42, 0
    s_cselect_b32 s44, s41, s26
    s_cselect_b32 m0, s67, s76
    s_sub_u32 s45, s41, 0x10000
    s_sub_u32 s41, s41, 0x8000
    buffer_load_dwordx4 v78, s[16:19], s44 offen offset:0 lds
    buffer_load_dwordx4 v79, s[16:19], s44 offen offset:1024 lds
    v_mfma_f32_32x32x16_bf16 v[144:159], a[128:131], a[128:131], 0
    v_mov_b32 v70, 0
    v_mov_b32 v72, 0
    s_waitcnt lgkmcnt(0)
    v_mfma_f32_32x32x16_bf16 v[96:111], a[64:67], a[0:3], v[32:47]
    v_mfma_f32_32x32x16_bf16 v[96:111], a[68:71], a[4:7], v[96:111]
    v_mfma_f32_32x32x16_bf16 v[96:111], a[72:75], a[8:11], v[96:111]
    v_mfma_f32_32x32x16_bf16 v[96:111], a[76:79], a[12:15], v[96:111]
    v_mfma_f32_32x32x16_bf16 v[96:111], a[80:83], a[16:19], v[96:111]
    v_mfma_f32_32x32x16_bf16 v[96:111], a[84:87], a[20:23], v[96:111]
    v_mfma_f32_32x32x16_bf16 v[96:111], a[88:91], a[24:27], v[96:111]
    v_mfma_f32_32x32x16_bf16 v[96:111], a[92:95], a[28:31], v[96:111]
    v_mfma_f32_32x32x16_bf16 v[160:175], a[128:131], a[128:131], 0
    s_nop 5
    v_mfma_f32_32x32x16_bf16 v[176:191], a[128:131], a[128:131], 0
    s_nop 4
    v_max3_f32 v2, v96, v97, v98
    v_mfma_f32_32x32x16_bf16 v[192:207], a[128:131], a[128:131], 0
    v_max3_f32 v3, v99, v100, v101
    v_max3_f32 v2, v2, v102, v103
    v_max3_f32 v3, v3, v104, v105
    v_max3_f32 v2, v2, v106, v107
    v_max3_f32 v3, v3, v108, v109
    v_max3_f32 v2, v2, v110, v111
    v_mfma_f32_32x32x16_bf16 v[112:127], a[64:67], a[32:35], v[32:47]
    v_max_f32 v2, v2, v3
    v_mov_b32 v3, v2
    s_nop 1
    v_permlane32_swap_b32 v2, v3
    v_max_f32 v2, v2, v3
    v_mfma_f32_32x32x16_bf16 v[112:127], a[68:71], a[36:39], v[112:127]
    v_mul_f32 v68, s24, v2
    s_nop 0
    v_fma_f32 v74, v96, s24, -v68
    v_exp_f32 v74, v74
    v_fma_f32 v75, v97, s24, -v68
    v_mfma_f32_32x32x16_bf16 v[112:127], a[72:75], a[40:43], v[112:127]
    v_exp_f32 v75, v75
    v_add_f32 v71, v70, v74
    v_fma_f32 v76, v98, s24, -v68
    v_exp_f32 v76, v76
    v_mfma_f32_32x32x16_bf16 v[112:127], a[76:79], a[44:47], v[112:127]
    v_add_f32 v71, v71, v75
    v_cvt_pk_bf16_f32 v80, v74, v75
    v_fma_f32 v77, v99, s24, -v68
    v_exp_f32 v77, v77
    v_add_f32 v71, v71, v76
    v_mfma_f32_32x32x16_bf16 v[112:127], a[80:83], a[48:51], v[112:127]
    v_fma_f32 v74, v100, s24, -v68
    v_exp_f32 v74, v74
    v_add_f32 v71, v71, v77
    v_cvt_pk_bf16_f32 v81, v76, v77
    v_fma_f32 v75, v101, s24, -v68
    v_mfma_f32_32x32x16_bf16 v[112:127], a[84:87], a[52:55], v[112:127]
    v_exp_f32 v75, v75
    v_add_f32 v71, v71, v74
    v_fma_f32 v76, v102, s24, -v68
    v_exp_f32 v76, v76
    v_mfma_f32_32x32x16_bf16 v[112:127], a[88:91], a[56:59], v[112:127]
    v_add_f32 v71, v71, v75
    v_cvt_pk_bf16_f32 v82, v74, v75
    v_fma_f32 v77, v103, s24, -v68
    v_exp_f32 v77, v77
    v_add_f32 v71, v71, v76
    v_mfma_f32_32x32x16_bf16 v[112:127], a[92:95], a[60:63], v[112:127]
    v_fma_f32 v74, v104, s24, -v68
    v_exp_f32 v74, v74
    v_add_f32 v71, v71, v77
    v_cvt_pk_bf16_f32 v83, v76, v77
    v_fma_f32 v75, v105, s24, -v68
    s_waitcnt vmcnt(9)
    s_barrier
    v_mfma_f32_32x32x16_bf16 v[208:223], a[128:131], a[128:131], 0
    ds_read_b128 a[64:67], v60 offset:16384
    ds_read_b128 a[68:71], v61 offset:16384
    ds_read_b128 a[72:75], v62 offset:16384
    ds_read_b128 a[76:79], v63 offset:16384
    ds_read_b128 a[80:83], v64 offset:16384
    ds_read_b128 a[84:87], v65 offset:16384
    v_exp_f32 v75, v75
    v_add_f32 v71, v71, v74
    v_mfma_f32_32x32x16_bf16 v[224:239], a[128:131], a[128:131], 0
    ds_read_b128 a[88:91], v66 offset:16384
    ds_read_b128 a[92:95], v67 offset:16384
    s_cmp_gt_i32 s42, 2
    s_cselect_b32 s43, s45, s26
    s_cselect_b32 m0, s61, s76
    s_sub_u32 s42, s42, 1
    buffer_load_dwordx4 v0, s[12:15], s43 offen offset:0 lds
    buffer_load_dwordx4 v1, s[12:15], s43 offen offset:1024 lds
    s_cmp_gt_i32 s46, 0
    s_cselect_b32 s49, s47, s26
    s_cselect_b32 m0, s48, s76
    s_add_u32 s47, s47, 0x4000
    buffer_load_dwordx4 v8, s[8:11], s49 offen nt lds
    s_add_u32 s48, s48, 0x400
    ds_read_b64_tr_b16 a[96:97], v56 offset:40960
    ds_read_b64_tr_b16 a[98:99], v56 offset:43008
    ds_read_b64_tr_b16 a[100:101], v57 offset:40960
    ds_read_b64_tr_b16 a[102:103], v57 offset:43008
    v_mfma_f32_32x32x16_bf16 v[240:255], a[128:131], a[128:131], 0
    ds_read_b64_tr_b16 a[104:105], v58 offset:40960
    ds_read_b64_tr_b16 a[106:107], v58 offset:43008
    ds_read_b64_tr_b16 a[108:109], v59 offset:40960
    ds_read_b64_tr_b16 a[110:111], v59 offset:43008
    ds_read_b64_tr_b16 a[112:113], v56 offset:45056
    ds_read_b64_tr_b16 a[114:115], v56 offset:47104
    ds_read_b64_tr_b16 a[116:117], v57 offset:45056
    ds_read_b64_tr_b16 a[118:119], v57 offset:47104
    ds_read_b64_tr_b16 a[120:121], v58 offset:45056
    ds_read_b64_tr_b16 a[122:123], v58 offset:47104
    ds_read_b64_tr_b16 a[124:125], v59 offset:45056
    ds_read_b64_tr_b16 a[126:127], v59 offset:47104
    v_fma_f32 v76, v106, s24, -v68
    v_exp_f32 v76, v76
    v_add_f32 v71, v71, v75
    v_cvt_pk_bf16_f32 v84, v74, v75
    v_max3_f32 v4, v112, v113, v114
    v_max3_f32 v5, v115, v116, v117
    v_max3_f32 v4, v4, v118, v119
    v_max3_f32 v5, v5, v120, v121
    v_max3_f32 v4, v4, v122, v123
    v_max3_f32 v5, v5, v124, v125
    v_max3_f32 v4, v4, v126, v127
    v_max_f32 v4, v4, v5
    v_mov_b32 v5, v4
    s_nop 1
    v_permlane32_swap_b32 v4, v5
    v_max_f32 v4, v4, v5
    v_mul_f32 v69, s24, v4
    v_fma_f32 v77, v107, s24, -v68
    v_exp_f32 v77, v77
    v_add_f32 v71, v71, v76
    v_fma_f32 v74, v108, s24, -v68
    v_exp_f32 v74, v74
    v_add_f32 v71, v71, v77
    v_cvt_pk_bf16_f32 v85, v76, v77
    v_fma_f32 v75, v109, s24, -v68
    v_exp_f32 v75, v75
    v_add_f32 v71, v71, v74
    v_fma_f32 v76, v110, s24, -v68
    v_exp_f32 v76, v76
    v_add_f32 v71, v71, v75
    v_cvt_pk_bf16_f32 v86, v74, v75
    v_fma_f32 v77, v111, s24, -v68
    v_exp_f32 v77, v77
    v_add_f32 v71, v71, v76
    v_fma_f32 v74, v112, s24, -v69
    v_exp_f32 v74, v74
    v_add_f32 v71, v71, v77
    v_cvt_pk_bf16_f32 v87, v76, v77
    v_fma_f32 v75, v113, s24, -v69
    v_exp_f32 v75, v75
    v_add_f32 v73, v72, v74
    v_fma_f32 v76, v114, s24, -v69
    s_waitcnt lgkmcnt(0)
    s_cmp_ge_i32 s42, -1
    s_cbranch_scc0 L_tail_A_1
    s_branch L_loop_A_1
L_head_A_0:
    ds_read_b128 a[64:67], v60 offset:0
    ds_read_b128 a[68:71], v61 offset:0
    ds_read_b128 a[72:75], v62 offset:0
    ds_read_b128 a[76:79], v63 offset:0
    ds_read_b128 a[80:83], v64 offset:0
    ds_read_b128 a[84:87], v65 offset:0
    ds_read_b128 a[88:91], v66 offset:0
    ds_read_b128 a[92:95], v67 offset:0
    v_mfma_f32_32x32x16_bf16 v[128:143], a[128:131], a[128:131], 0
    s_sub_u32 s46, s46, 1
    s_cmp_eq_u32 s46, 8
    s_cselect_b32 s69, s70, 0
    s_cselect_b32 s48, s71, s48
    s_add_u32 s47, s47, s69
    s_cmp_gt_i32 s42, 0
    s_cselect_b32 s44, s41, s26
    s_cselect_b32 m0, s66, s76
    s_sub_u32 s45, s41, 0x10000
    s_sub_u32 s41, s41, 0x8000
    buffer_load_dwordx4 v78, s[16:19], s44 offen offset:0 lds
    buffer_load_dwordx4 v79, s[16:19], s44 offen offset:1024 lds
    v_mfma_f32_32x32x16_bf16 v[144:159], a[128:131], a[128:131], 0
    v_mov_b32 v71, 0
    v_mov_b32 v73, 0
    s_waitcnt lgkmcnt(0)
    v_mfma_f32_32x32x16_bf16 v[96:111], a[64:67], a[0:3], v[32:47]
    v_mfma_f32_32x32x16_bf16 v[96:111], a[68:71], a[4:7], v[96:111]
    v_mfma_f32_32x32x16_bf16 v[96:111], a[72:75], a[8:11], v[96:111]
    v_mfma_f32_32x32x16_bf16 v[96:111], a[76:79], a[12:15], v[96:111]
    v_mfma_f32_32x32x16_bf16 v[96:111], a[80:83], a[16:19], v[96:111]
    v_mfma_f32_32x32x16_bf16 v[96:111], a[84:87], a[20:23], v[96:111]
    v_mfma_f32_32x32x16_bf16 v[96:111], a[88:91], a[24:27], v[96:111]
    v_mfma_f32_32x32x16_bf16 v[96:111], a[92:95], a[28:31], v[96:111]
    v_mfma_f32_32x32x16_bf16 v[160:175], a[128:131], a[128:131], 0
    s_nop 5
    v_mfma_f32_32x32x16_bf16 v[176:191], a[128:131], a[128:131], 0
    s_nop 4
    v_max3_f32 v2, v96, v97, v98
    v_mfma_f32_32x32x16_bf16 v[192:207], a[128:131], a[128:131], 0
    v_max3_f32 v3, v99, v100, v101
    v_max3_f32 v2, v2, v102, v103
    v_max3_f32 v3, v3, v104, v105
    v_max3_f32 v2, v2, v106, v107
    v_max3_f32 v3, v3, v108, v109
    v_max3_f32 v2, v2, v110, v111
    s_cmp_lg_u32 s3, 0
    s_cbranch_scc1 L_cold7
L_back7:
    v_mfma_f32_32x32x16_bf16 v[112:127], a[64:67], a[32:35], v[32:47]
    v_max_f32 v2, v2, v3
    v_mov_b32 v3, v2
    s_nop 1
    v_permlane32_swap_b32 v2, v3
    v_max_f32 v2, v2, v3
    v_mfma_f32_32x32x16_bf16 v[112:127], a[68:71], a[36:39], v[112:127]
    v_mul_f32 v68, s24, v2
    s_nop 0
    v_fma_f32 v74, v96, s24, -v68
    v_exp_f32 v74, v74
    v_fma_f32 v75, v97, s24, -v68
    v_mfma_f32_32x32x16_bf16 v[112:127], a[72:75], a[40:43], v[112:127]
    v_exp_f32 v75, v75
    v_add_f32 v70, v71, v74
    v_fma_f32 v76, v98, s24, -v68
    v_exp_f32 v76, v76
    v_mfma_f32_32x32x16_bf16 v[112:127], a[76:79], a[44:47], v[112:127]
    v_add_f32 v70, v70, v75
    v_cvt_pk_bf16_f32 v80, v74, v75
    v_fma_f32 v77, v99, s24, -v68
    v_exp_f32 v77, v77
    v_add_f32 v70, v70, v76
    v_mfma_f32_32x32x16_bf16 v[112:127], a[80:83], a[48:51], v[112:127]
    v_fma_f32 v74, v100, s24, -v68
    v_exp_f32 v74, v74
    v_add_f32 v70, v70, v77
    v_cvt_pk_bf16_f32 v81, v76, v77
    v_fma_f32 v75, v101, s24, -v68
    v_mfma_f32_32x32x16_bf16 v[112:127], a[84:87], a[52:55], v[112:127]
    v_exp_f32 v75, v75
    v_add_f32 v70, v70, v74
    v_fma_f32 v76, v102, s24, -v68
    v_exp_f32 v76, v76
    v_mfma_f32_32x32x16_bf16 v[112:127], a[88:91], a[56:59], v[112:127]
    v_add_f32 v70, v70, v75
    v_cvt_pk_bf16_f32 v82, v74, v75
    v_fma_f32 v77, v103, s24, -v68
    v_exp_f32 v77, v77
    v_add_f32 v70, v70, v76
    v_mfma_f32_32x32x16_bf16 v[112:127], a[92:95], a[60:63], v[112:127]
    v_fma_f32 v74, v104, s24, -v68
    v_exp_f32 v74, v74
    v_add_f32 v70, v70, v77
    v_cvt_pk_bf16_f32 v83, v76, v77
    v_fma_f32 v75, v105, s24, -v68
    s_cmp_lg_u32 s3, 0
    s_cbranch_scc1 L_hb8
    s_waitcnt vmcnt(8)
L_hc8:
    s_barrier
    v_mfma_f32_32x32x16_bf16 v[208:223], a[128:131], a[128:131], 0
    ds_read_b128 a[64:67], v60 offset:8192
    ds_read_b128 a[68:71], v61 offset:8192
    ds_read_b128 a[72:75], v62 offset:8192
    ds_read_b128 a[76:79], v63 offset:8192
    ds_read_b128 a[80:83], v64 offset:8192
    ds_read_b128 a[84:87], v65 offset:8192
    v_exp_f32 v75, v75
    v_add_f32 v70, v70, v74
    v_mfma_f32_32x32x16_bf16 v[224:239], a[128:131], a[128:131], 0
    ds_read_b128 a[88:91], v66 offset:8192
    ds_read_b128 a[92:95], v67 offset:8192
    s_cmp_gt_i32 s42, 2
    s_cselect_b32 s43, s45, s26
    s_cselect_b32 m0, s60, s76
    s_sub_u32 s42, s42, 1
    buffer_load_dwordx4 v0, s[12:15], s43 offen offset:0 lds
    buffer_load_dwordx4 v1, s[12:15], s43 offen offset:1024 lds
    s_mov_b32 m0, s76
    s_mov_b32 s49, s26
    s_add_u32 s46, s46, 1
    buffer_load_dwordx4 v8, s[8:11], s49 offen nt lds
    ds_read_b64_tr_b16 a[96:97], v56 offset:32768
    ds_read_b64_tr_b16 a[98:99], v56 offset:34816
    ds_read_b64_tr_b16 a[100:101], v57 offset:32768
    ds_read_b64_tr_b16 a[102:103], v57 offset:34816
    v_mfma_f32_32x32x16_bf16 v[240:255], a[128:131], a[128:131], 0
    ds_read_b64_tr_b16 a[104:105], v58 offset:32768
    ds_read_b64_tr_b16 a[106:107], v58 offset:34816
    ds_read_b64_tr_b16 a[108:109], v59 offset:32768
    ds_read_b64_tr_b16 a[110:111], v59 offset:34816
    ds_read_b64_tr_b16 a[112:113], v56 offset:36864
    ds_read_b64_tr_b16 a[114:115], v56 offset:38912
    ds_read_b64_tr_b16 a[116:117], v57 offset:36864
    ds_read_b64_tr_b16 a[118:119], v57 offset:38912
    ds_read_b64_tr_b16 a[120:121], v58 offset:36864
    ds_read_b64_tr_b16 a[122:123], v58 offset:38912
    ds_read_b64_tr_b16 a[124:125], v59 offset:36864
    ds_read_b64_tr_b16 a[126:127], v59 offset:38912
    v_fma_f32 v76, v106, s24, -v68
    v_exp_f32 v76, v76
    v_add_f32 v70, v70, v75
    v_cvt_pk_bf16_f32 v84, v74, v75
    v_max3_f32 v4, v112, v113, v114
    v_max3_f32 v5, v115, v116, v117
    v_max3_f32 v4, v4, v118, v119
    v_max3_f32 v5, v5, v120, v121
    v_max3_f32 v4, v4, v122, v123
    v_max3_f32 v5, v5, v124, v125
    v_max3_f32 v4, v4, v126, v127
    v_max_f32 v4, v4, v5
    v_mov_b32 v5, v4
    s_nop 1
    v_permlane32_swap_b32 v4, v5
    v_max_f32 v4, v4, v5
    v_mul_f32 v69, s24, v4
    v_fma_f32 v77, v107, s24, -v68
    v_exp_f32 v77, v77
    v_add_f32 v70, v70, v76
    v_fma_f32 v74, v108, s24, -v68
    v_exp_f32 v74, v74
    v_add_f32 v70, v70, v77
    v_cvt_pk_bf16_f32 v85, v76, v77
    v_fma_f32 v75, v109, s24, -v68
    v_exp_f32 v75, v75
    v_add_f32 v70, v70, v74
    v_fma_f32 v76, v110, s24, -v68
    v_exp_f32 v76, v76
    v_add_f32 v70, v70, v75
    v_cvt_pk_bf16_f32 v86, v74, v75
    v_fma_f32 v77, v111, s24, -v68
    v_exp_f32 v77, v77
    v_add_f32 v70, v70, v76
    v_fma_f32 v74, v112, s24, -v69
    v_exp_f32 v74, v74
    v_add_f32 v70, v70, v77
    v_cvt_pk_bf16_f32 v87, v76, v77
    v_fma_f32 v75, v113, s24, -v69
    v_exp_f32 v75, v75
    v_add_f32 v72, v73, v74
    v_fma_f32 v76, v114, s24, -v69
    s_waitcnt lgkmcnt(0)
    s_cmp_ge_i32 s42, -1
    s_cbranch_scc0 L_tail_A_0
.p2align 6
    s_nop 0
    s_nop 0
    s_nop 0
    s_nop 0
L_loop_A_0:
    v_mfma_f32_32x32x16_bf16 v[96:111], a[64:67], a[0:3], 0
    s_cmp_gt_i32 s42, 0
    ds_read_b64_tr_b16 a[110:111], v59 offset:34816
    v_add_f32 v72, v72, v75
    v_cvt_pk_bf16_f32 v88, v74, v75
    v_fma_f32 v77, v115, s24, -v69
    v_exp_f32 v76, v76
    v_mfma_f32_32x32x16_bf16 v[96:111], a[68:71], a[4:7], v[96:111]
    s_cselect_b32 s44, s41, s26
    ds_read_b64_tr_b16 a[112:113], v56 offset:36864
    ds_read_b64_tr_b16 a[114:115], v56 offset:38912
    v_add_f32 v72, v72, v76
    v_fma_f32 v74, v116, s24, -v69
    v_exp_f32 v77, v77
    v_mfma_f32_32x32x16_bf16 v[96:111], a[72:75], a[8:11], v[96:111]
    s_cselect_b32 m0, s67, s76
    ds_read_b64_tr_b16 a[116:117], v57 offset:36864
    v_add_f32 v72, v72, v77
    v_cvt_pk_bf16_f32 v89, v76, v77
    v_fma_f32 v75, v117, s24, -v69
    v_exp_f32 v74, v74
    v_mfma_f32_32x32x16_bf16 v[96:111], a[76:79], a[12:15], v[96:111]
    s_sub_u32 s45, s41, 0x10000
    ds_read_b64_tr_b16 a[118:119], v57 offset:38912
    ds_read_b64_tr_b16 a[120:121], v58 offset:36864
    v_add_f32 v72, v72, v74
    v_fma_f32 v76, v118, s24, -v69
    v_exp_f32 v75, v75
    v_mfma_f32_32x32x16_bf16 v[96:111], a[80:83], a[16:19], v[96:111]
    s_sub_u32 s41, s41, 0x8000
    ds_read_b64_tr_b16 a[122:123], v58 offset:38912
    v_add_f32 v72, v72, v75
    v_cvt_pk_bf16_f32 v90, v74, v75
    v_fma_f32 v77, v119, s24, -v69
    v_exp_f32 v76, v76
    v_mfma_f32_32x32x16_bf16 v[96:111], a[84:87], a[20:23], v[96:111]
    s_sub_u32 s46, s46, 1
    ds_read_b64_tr_b16 a[124:125], v59 offset:36864
    ds_read_b64_tr_b16 a[126:127], v59 offset:38912
    v_add_f32 v72, v72, v76
    v_fma_f32 v74, v120, s24, -v69
    v_exp_f32 v77, v77
    v_mfma_f32_32x32x16_bf16 v[96:111], a[88:91], a[24:27], v[96:111]
    s_cmp_eq_u32 s46, 8
    v_add_f32 v72, v72, v77
    v_cvt_pk_bf16_f32 v91, v76, v77
    v_fma_f32 v75, v121, s24, -v69
    v_exp_f32 v74, v74
    v_mfma_f32_32x32x16_bf16 v[96:111], a[92:95], a[28:31], v[96:111]
    s_waitcnt lgkmcnt(8)
    v_add_f32 v72, v72, v74
    v_fma_f32 v76, v122, s24, -v69
    v_exp_f32 v75, v75
    v_mfma_f32_32x32x16_bf16 v[128:143], a[96:99], v[80:83], v[128:143]
    s_cselect_b32 s69, s70, 0
    v_add_f32 v72, v72, v75
    v_cvt_pk_bf16_f32 v92, v74, v75
    v_fma_f32 v77, v123, s24, -v69
    v_exp_f32 v76, v76
    v_mfma_f32_32x32x16_bf16 v[144:159], a[100:103], v[80:83], v[144:159]
    s_cselect_b32 s48, s71, s48
    buffer_load_dwordx4 v78, s[16:19], s44 offen offset:0 lds
    v_add_f32 v72, v72, v76
    v_fma_f32 v74, v124, s24, -v69
    v_exp_f32 v77, v77
    v_mfma_f32_32x32x16_bf16 v[160:175], a[104:107], v[80:83], v[160:175]
    s_cmp_gt_i32 s42, 2
    v_add_f32 v72, v72, v77
    v_cvt_pk_bf16_f32 v93, v76, v77
    v_fma_f32 v75, v125, s24, -v69
    v_exp_f32 v74, v74
    v_mfma_f32_32x32x16_bf16 v[176:191], a[108:111], v[80:83], v[176:191]
    s_waitcnt lgkmcnt(0)
    v_add_f32 v72, v72, v74
    v_fma_f32 v76, v126, s24, -v69
    v_exp_f32 v75, v75
    v_mfma_f32_32x32x16_bf16 v[128:143], a[112:115], v[84:87], v[128:143]
    s_cselect_b32 s43, s45, s26
    v_add_f32 v72, v72, v75
    v_cvt_pk_bf16_f32 v94, v74, v75
    v_fma_f32 v77, v127, s24, -v69
    v_exp_f32 v76, v76
    v_mfma_f32_32x32x16_bf16 v[144:159], a[116:119], v[84:87], v[144:159]
    buffer_load_dwordx4 v79, s[16:19], s44 offen offset:1024 lds
    v_add_f32 v72, v72, v76
    v_fma_f32 v74, v96, s24, -v68
    v_exp_f32 v77, v77
    v_mfma_f32_32x32x16_bf16 v[160:175], a[120:123], v[84:87], v[160:175]
    s_cselect_b32 m0, s61, s76
    v_add_f32 v72, v72, v77
    v_cvt_pk_bf16_f32 v95, v76, v77
    v_fma_f32 v75, v97, s24, -v68
    v_exp_f32 v74, v74
    v_mfma_f32_32x32x16_bf16 v[176:191], a[124:127], v[84:87], v[176:191]
    s_waitcnt vmcnt(10)
    v_cmp_nge_f32 vcc, s25, v72
    v_add_f32 v71, v70, v74
    v_fma_f32 v76, v98, s24, -v68
    v_exp_f32 v75, v75
    s_cbranch_vccnz L_stub12
L_ret12:
    v_mfma_f32_32x32x16_bf16 v[112:127], a[64:67], a[32:35], 0
    s_barrier
    ds_read_b128 a[64:67], v60 offset:16384
    v_add_f32 v71, v71, v75
    v_cvt_pk_bf16_f32 v80, v74, v75
    v_fma_f32 v77, v99, s24, -v68
    v_exp_f32 v76, v76
    v_mfma_f32_32x32x16_bf16 v[112:127], a[68:71], a[36:39], v[112:127]
    ds_read_b128 a[68:71], v61 offset:16384
    v_add_f32 v71, v71, v76
    v_fma_f32 v74, v100, s24, -v68
    v_exp_f32 v77, v77
    v_mfma_f32_32x32x16_bf16 v[112:127], a[72:75], a[40:43], v[112:127]
    s_sub_u32 s42, s42, 1
    ds_read_b128 a[72:75], v62 offset:16384
    v_add_f32 v71, v71, v77
    v_cvt_pk_bf16_f32 v81, v76, v77
    v_fma_f32 v75, v101, s24, -v68
    v_exp_f32 v74, v74
    v_mfma_f32_32x32x16_bf16 v[112:127], a[76:79], a[44:47], v[112:127]
    s_add_u32 s47, s47, s69
    buffer_load_dwordx4 v0, s[12:15], s43 offen offset:0 lds
    v_add_f32 v71, v71, v74
    v_fma_f32 v76, v102, s24, -v68
    v_exp_f32 v75, v75
    v_mfma_f32_32x32x16_bf16 v[112:127], a[80:83], a[48:51], v[112:127]
    s_cmp_gt_i32 s46, 0
    ds_read_b128 a[76:79], v63 offset:16384
    v_add_f32 v71, v71, v75
    v_cvt_pk_bf16_f32 v82, v74, v75
    v_fma_f32 v77, v103, s24, -v68
    v_exp_f32 v76, v76
    v_mfma_f32_32x32x16_bf16 v[112:127], a[84:87], a[52:55], v[112:127]
    ds_read_b128 a[80:83], v64 offset:16384
    ds_read_b128 a[84:87], v65 offset:16384
    v_add_f32 v71, v71, v76
    v_fma_f32 v74, v104, s24, -v68
    v_exp_f32 v77, v77
    v_mfma_f32_32x32x16_bf16 v[112:127], a[88:91], a[56:59], v[112:127]
    s_cselect_b32 s49, s47, s26
    ds_read_b128 a[88:91], v66 offset:16384
    v_add_f32 v71, v71, v77
    v_cvt_pk_bf16_f32 v83, v76, v77
    v_fma_f32 v75, v105, s24, -v68
    v_exp_f32 v74, v74
    v_mfma_f32_32x32x16_bf16 v[112:127], a[92:95], a[60:63], v[112:127]
    buffer_load_dwordx4 v1, s[12:15], s43 offen offset:1024 lds
    v_add_f32 v71, v71, v74
    v_fma_f32 v76, v106, s24, -v68
    v_exp_f32 v75, v75
    v_mfma_f32_32x32x16_bf16 v[192:207], a[96:99], v[88:91], v[192:207]
    s_cselect_b32 m0, s48, s76
    ds_read_b128 a[92:95], v67 offset:16384
    v_add_f32 v71, v71, v75
    v_cvt_pk_bf16_f32 v84, v74, v75
    v_fma_f32 v77, v107, s24, -v68
    v_exp_f32 v76, v76
    v_mfma_f32_32x32x16_bf16 v[208:223], a[100:103], v[88:91], v[208:223]
    ds_read_b64_tr_b16 a[96:97], v56 offset:40960
    ds_read_b64_tr_b16 a[98:99], v56 offset:43008
    v_add_f32 v71, v71, v76
    v_fma_f32 v74, v108, s24, -v68
    v_exp_f32 v77, v77
    v_mfma_f32_32x32x16_bf16 v[224:239], a[104:107], v[88:91], v[224:239]
    ds_read_b64_tr_b16 a[100:101], v57 offset:40960
    v_add_f32 v71, v71, v77
    v_cvt_pk_bf16_f32 v85, v76, v77
    v_fma_f32 v75, v109, s24, -v68
    v_exp_f32 v74, v74
    v_mfma_f32_32x32x16_bf16 v[240:255], a[108:111], v[88:91], v[240:255]
    buffer_load_dwordx4 v8, s[8:11], s49 offen nt lds
    v_add_f32 v71, v71, v74
    v_fma_f32 v76, v110, s24, -v68
    v_exp_f32 v75, v75
    v_mfma_f32_32x32x16_bf16 v[192:207], a[112:115], v[92:95], v[192:207]
    s_add_u32 s47, s47, 0x4000
    ds_read_b64_tr_b16 a[102:103], v57 offset:43008
    v_add_f32 v71, v71, v75
    v_cvt_pk_bf16_f32 v86, v74, v75
    v_fma_f32 v77, v111, s24, -v68
    v_exp_f32 v76, v76
    v_mfma_f32_32x32x16_bf16 v[208:223], a[116:119], v[92:95], v[208:223]
    s_add_u32 s48, s48, 0x400
    ds_read_b64_tr_b16 a[104:105], v58 offset:40960
    ds_read_b64_tr_b16 a[106:107], v58 offset:43008
    v_add_f32 v71, v71, v76
    v_fma_f32 v74, v112, s24, -v69
    v_exp_f32 v77, v77
    v_mfma_f32_32x32x16_bf16 v[224:239], a[120:123], v[92:95], v[224:239]
    s_cmp_ge_i32 s42, -1
    ds_read_b64_tr_b16 a[108:109], v59 offset:40960
    v_add_f32 v71, v71, v77
    v_cvt_pk_bf16_f32 v87, v76, v77
    v_fma_f32 v75, v113, s24, -v69
    v_exp_f32 v74, v74
    v_mfma_f32_32x32x16_bf16 v[240:255], a[124:127], v[92:95], v[240:255]
    s_waitcnt lgkmcnt(7)
    v_cmp_nge_f32 vcc, s25, v71
    v_add_f32 v73, v72, v74
    v_fma_f32 v76, v114, s24, -v69
    v_exp_f32 v75, v75
    s_cbranch_vccnz L_stub13
L_ret13:
    s_cbranch_scc0 L_tail_A_1
L_loop_A_1:
    v_mfma_f32_32x32x16_bf16 v[96:111], a[64:67], a[0:3], 0
    s_cmp_gt_i32 s42, 0
    ds_read_b64_tr_b16 a[110:111], v59 offset:43008
    v_add_f32 v73, v73, v75
    v_cvt_pk_bf16_f32 v88, v74, v75
    v_fma_f32 v77, v115, s24, -v69
    v_exp_f32 v76, v76
    v_mfma_f32_32x32x16_bf16 v[96:111], a[68:71], a[4:7], v[96:111]
    s_cselect_b32 s44, s41, s26
    ds_read_b64_tr_b16 a[112:113], v56 offset:45056
    ds_read_b64_tr_b16 a[114:115], v56 offset:47104
    v_add_f32 v73, v73, v76
    v_fma_f32 v74, v116, s24, -v69
    v_exp_f32 v77, v77
    v_mfma_f32_32x32x16_bf16 v[96:111], a[72:75], a[8:11], v[96:111]
    s_cselect_b32 m0, s64, s76
    ds_read_b64_tr_b16 a[116:117], v57 offset:45056
    v_add_f32 v73, v73, v77
    v_cvt_pk_bf16_f32 v89, v76, v77
    v_fma_f32 v75, v117, s24, -v69
    v_exp_f32 v74, v74
    v_mfma_f32_32x32x16_bf16 v[96:111], a[76:79], a[12:15], v[96:111]
    s_sub_u32 s45, s41, 0x10000
    ds_read_b64_tr_b16 a[118:119], v57 offset:47104
    ds_read_b64_tr_b16 a[120:121], v58 offset:45056
    v_add_f32 v73, v73, v74
    v_fma_f32 v76, v118, s24, -v69
    v_exp_f32 v75, v75
    v_mfma_f32_32x32x16_bf16 v[96:111], a[80:83], a[16:19], v[96:111]
    s_sub_u32 s41, s41, 0x8000
    ds_read_b64_tr_b16 a[122:123], v58 offset:47104
    v_add_f32 v73, v73, v75
    v_cvt_pk_bf16_f32 v90, v74, v75
    v_fma_f32 v77, v119, s24, -v69
    v_exp_f32 v76, v76
    v_mfma_f32_32x32x16_bf16 v[96:111], a[84:87], a[20:23], v[96:111]
    s_sub_u32 s46, s46, 1
    ds_read_b64_tr_b16 a[124:125], v59 offset:45056
    ds_read_b64_tr_b16 a[126:127], v59 offset:47104
    v_add_f32 v73, v73, v76
    v_fma_f32 v74, v120, s24, -v69
    v_exp_f32 v77, v77
    v_mfma_f32_32x32x16_bf16 v[96:111], a[88:91], a[24:27], v[96:111]
    s_cmp_eq_u32 s46, 8
    v_add_f32 v73, v73, v77
    v_cvt_pk_bf16_f32 v91, v76, v77
    v_fma_f32 v75, v121, s24, -v69
    v_exp_f32 v74, v74
    v_mfma_f32_32x32x16_bf16 v[96:111], a[92:95], a[28:31], v[96:111]
    s_waitcnt lgkmcnt(8)
    v_add_f32 v73, v73, v74
    v_fma_f32 v76, v122, s24, -v69
    v_exp_f32 v75, v75
    v_mfma_f32_32x32x16_bf16 v[128:143], a[96:99], v[80:83], v[128:143]
    s_cselect_b32 s69, s70, 0
    v_add_f32 v73, v73, v75
    v_cvt_pk_bf16_f32 v92, v74, v75
    v_fma_f32 v77, v123, s24, -v69
    v_exp_f32 v76, v76
    v_mfma_f32_32x32x16_bf16 v[144:159], a[100:103], v[80:83], v[144:159]
    s_cselect_b32 s48, s71, s48
    buffer_load_dwordx4 v78, s[16:19], s44 offen offset:0 lds
    v_add_f32 v73, v73, v76
    v_fma_f32 v74, v124, s24, -v69
    v_exp_f32 v77, v77
    v_mfma_f32_32x32x16_bf16 v[160:175], a[104:107], v[80:83], v[160:175]
    s_cmp_gt_i32 s42, 2
    v_add_f32 v73, v73, v77
    v_cvt_pk_bf16_f32 v93, v76, v77
    v_fma_f32 v75, v125, s24, -v69
    v_exp_f32 v74, v74
    v_mfma_f32_32x32x16_bf16 v[176:191], a[108:111], v[80:83], v[176:191]
    s_waitcnt lgkmcnt(0)
    v_add_f32 v73, v73, v74
    v_fma_f32 v76, v126, s24, -v69
    v_exp_f32 v75, v75
    v_mfma_f32_32x32x16_bf16 v[128:143], a[112:115], v[84:87], v[128:143]
    s_cselect_b32 s43, s45, s26
    v_add_f32 v73, v73, v75
    v_cvt_pk_bf16_f32 v94, v74, v75
    v_fma_f32 v77, v127, s24, -v69
    v_exp_f32 v76, v76
    v_mfma_f32_32x32x16_bf16 v[144:159], a[116:119], v[84:87], v[144:159]
    buffer_load_dwordx4 v79, s[16:19], s44 offen offset:1024 lds
    v_add_f32 v73, v73, v76
    v_fma_f32 v74, v96, s24, -v68
    v_exp_f32 v77, v77
    v_mfma_f32_32x32x16_bf16 v[160:175], a[120:123], v[84:87], v[160:175]
    s_cselect_b32 m0, s62, s76
    v_add_f32 v73, v73, v77
    v_cvt_pk_bf16_f32 v95, v76, v77
    v_fma_f32 v75, v97, s24, -v68
    v_exp_f32 v74, v74
    v_mfma_f32_32x32x16_bf16 v[176:191], a[124:127], v[84:87], v[176:191]
    s_waitcnt vmcnt(10)
    v_cmp_nge_f32 vcc, s25, v73
    v_add_f32 v70, v71, v74
    v_fma_f32 v76, v98, s24, -v68
    v_exp_f32 v75, v75
    s_cbranch_vccnz L_stub14
L_ret14:
    v_mfma_f32_32x32x16_bf16 v[112:127], a[64:67], a[32:35], 0
    s_barrier
    ds_read_b128 a[64:67], v60 offset:24576
    v_add_f32 v70, v70, v75
    v_cvt_pk_bf16_f32 v80, v74, v75
    v_fma_f32 v77, v99, s24, -v68
    v_exp_f32 v76, v76
    v_mfma_f32_32x32x16_bf16 v[112:127], a[68:71], a[36:39], v[112:127]
    ds_read_b128 a[68:71], v61 offset:24576
    v_add_f32 v70, v70, v76
    v_fma_f32 v74, v100, s24, -v68
    v_exp_f32 v77, v77
    v_mfma_f32_32x32x16_bf16 v[112:127], a[72:75], a[40:43], v[112:127]
    s_sub_u32 s42, s42, 1
    ds_read_b128 a[72:75], v62 offset:24576
    v_add_f32 v70, v70, v77
    v_cvt_pk_bf16_f32 v81, v76, v77
    v_fma_f32 v75, v101, s24, -v68
    v_exp_f32 v74, v74
    v_mfma_f32_32x32x16_bf16 v[112:127], a[76:79], a[44:47], v[112:127]
    s_add_u32 s47, s47, s69
    buffer_load_dwordx4 v0, s[12:15], s43 offen offset:0 lds
    v_add_f32 v70, v70, v74
    v_fma_f32 v76, v102, s24, -v68
    v_exp_f32 v75, v75
    v_mfma_f32_32x32x16_bf16 v[112:127], a[80:83], a[48:51], v[112:127]
    s_cmp_gt_i32 s46, 0
    ds_read_b128 a[76:79], v63 offset:24576
    v_add_f32 v70, v70, v75
    v_cvt_pk_bf16_f32 v82, v74, v75
    v_fma_f32 v77, v103, s24, -v68
    v_exp_f32 v76, v76
    v_mfma_f32_32x32x16_bf16 v[112:127], a[84:87], a[52:55], v[112:127]
    ds_read_b128 a[80:83], v64 offset:24576
    ds_read_b128 a[84:87], v65 offset:24576
    v_add_f32 v70, v70, v76
    v_fma_f32 v74, v104, s24, -v68
    v_exp_f32 v77, v77
    v_mfma_f32_32x32x16_bf16 v[112:127], a[88:91], a[56:59], v[112:127]
    s_cselect_b32 s49, s47, s26
    ds_read_b128 a[88:91], v66 offset:24576
    v_add_f32 v70, v70, v77
    v_cvt_pk_bf16_f32 v83, v76, v77
    v_fma_f32 v75, v105, s24, -v68
    v_exp_f32 v74, v74
    v_mfma_f32_32x32x16_bf16 v[112:127], a[92:95], a[60:63], v[112:127]
    buffer_load_dwordx4 v1, s[12:15], s43 offen offset:1024 lds
    v_add_f32 v70, v70, v74
    v_fma_f32 v76, v106, s24, -v68
    v_exp_f32 v75, v75
    v_mfma_f32_32x32x16_bf16 v[192:207], a[96:99], v[88:91], v[192:207]
    s_cselect_b32 m0, s48, s76
    ds_read_b128 a[92:95], v67 offset:24576
    v_add_f32 v70, v70, v75
    v_cvt_pk_bf16_f32 v84, v74, v75
    v_fma_f32 v77, v107, s24, -v68
    v_exp_f32 v76, v76
    v_mfma_f32_32x32x16_bf16 v[208:223], a[100:103], v[88:91], v[208:223]
    ds_read_b64_tr_b16 a[96:97], v56 offset:49152
    ds_read_b64_tr_b16 a[98:99], v56 offset:51200
    v_add_f32 v70, v70, v76
    v_fma_f32 v74, v108, s24, -v68
    v_exp_f32 v77, v77
    v_mfma_f32_32x32x16_bf16 v[224:239], a[104:107], v[88:91], v[224:239]
    ds_read_b64_tr_b16 a[100:101], v57 offset:49152
    v_add_f32 v70, v70, v77
    v_cvt_pk_bf16_f32 v85, v76, v77
    v_fma_f32 v75, v109, s24, -v68
    v_exp_f32 v74, v74
    v_mfma_f32_32x32x16_bf16 v[240:255], a[108:111], v[88:91], v[240:255]
    buffer_load_dwordx4 v9, s[8:11], s49 offen nt lds
    v_add_f32 v70, v70, v74
    v_fma_f32 v76, v110, s24, -v68
    v_exp_f32 v75, v75
    v_mfma_f32_32x32x16_bf16 v[192:207], a[112:115], v[92:95], v[192:207]
    s_add_u32 s47, s47, 0x4000
    ds_read_b64_tr_b16 a[102:103], v57 offset:51200
    v_add_f32 v70, v70, v75
    v_cvt_pk_bf16_f32 v86, v74, v75
    v_fma_f32 v77, v111, s24, -v68
    v_exp_f32 v76, v76
    v_mfma_f32_32x32x16_bf16 v[208:223], a[116:119], v[92:95], v[208:223]
    s_add_u32 s48, s48, 0x400
    ds_read_b64_tr_b16 a[104:105], v58 offset:49152
    ds_read_b64_tr_b16 a[106:107], v58 offset:51200
    v_add_f32 v70, v70, v76
    v_fma_f32 v74, v112, s24, -v69
    v_exp_f32 v77, v77
    v_mfma_f32_32x32x16_bf16 v[224:239], a[120:123], v[92:95], v[224:239]
    s_cmp_ge_i32 s42, -1
    ds_read_b64_tr_b16 a[108:109], v59 offset:49152
    v_add_f32 v70, v70, v77
    v_cvt_pk_bf16_f32 v87, v76, v77
    v_fma_f32 v75, v113, s24, -v69
    v_exp_f32 v74, v74
    v_mfma_f32_32x32x16_bf16 v[240:255], a[124:127], v[92:95], v[240:255]
    s_waitcnt lgkmcnt(7)
    v_cmp_nge_f32 vcc, s25, v70
    v_add_f32 v72, v73, v74
    v_fma_f32 v76, v114, s24, -v69
    v_exp_f32 v75, v75
    s_cbranch_vccnz L_stub15
L_ret15:
    s_cbranch_scc0 L_tail_A_2
L_loop_A_2:
    v_mfma_f32_32x32x16_bf16 v[96:111], a[64:67], a[0:3], 0
    s_cmp_gt_i32 s42, 0
    ds_read_b64_tr_b16 a[110:111], v59 offset:51200
    v_add_f32 v72, v72, v75
    v_cvt_pk_bf16_f32 v88, v74, v75
    v_fma_f32 v77, v115, s24, -v69
    v_exp_f32 v76, v76
    v_mfma_f32_32x32x16_bf16 v[96:111], a[68:71], a[4:7], v[96:111]
    s_cselect_b32 s44, s41, s26
    ds_read_b64_tr_b16 a[112:113], v56 offset:53248
    ds_read_b64_tr_b16 a[114:115], v56 offset:55296
    v_add_f32 v72, v72, v76
    v_fma_f32 v74, v116, s24, -v69
    v_exp_f32 v77, v77
    v_mfma_f32_32x32x16_bf16 v[96:111], a[72:75], a[8:11], v[96:111]
    s_cselect_b32 m0, s65, s76
    ds_read_b64_tr_b16 a[116:117], v57 offset:53248
    v_add_f32 v72, v72, v77
    v_cvt_pk_bf16_f32 v89, v76, v77
    v_fma_f32 v75, v117, s24, -v69
    v_exp_f32 v74, v74
    v_mfma_f32_32x32x16_bf16 v[96:111], a[76:79], a[12:15], v[96:111]
    s_sub_u32 s45, s41, 0x10000
    ds_read_b64_tr_b16 a[118:119], v57 offset:55296
    ds_read_b64_tr_b16 a[120:121], v58 offset:53248
    v_add_f32 v72, v72, v74
    v_fma_f32 v76, v118, s24, -v69
    v_exp_f32 v75, v75
    v_mfma_f32_32x32x16_bf16 v[96:111], a[80:83], a[16:19], v[96:111]
    s_sub_u32 s41, s41, 0x8000
    ds_read_b64_tr_b16 a[122:123], v58 offset:55296
    v_add_f32 v72, v72, v75
    v_cvt_pk_bf16_f32 v90, v74, v75
    v_fma_f32 v77, v119, s24, -v69
    v_exp_f32 v76, v76
    v_mfma_f32_32x32x16_bf16 v[96:111], a[84:87], a[20:23], v[96:111]
    s_sub_u32 s46, s46, 1
    ds_read_b64_tr_b16 a[124:125], v59 offset:53248
    ds_read_b64_tr_b16 a[126:127], v59 offset:55296
    v_add_f32 v72, v72, v76
    v_fma_f32 v74, v120, s24, -v69
    v_exp_f32 v77, v77
    v_mfma_f32_32x32x16_bf16 v[96:111], a[88:91], a[24:27], v[96:111]
    s_cmp_eq_u32 s46, 8
    v_add_f32 v72, v72, v77
    v_cvt_pk_bf16_f32 v91, v76, v77
    v_fma_f32 v75, v121, s24, -v69
    v_exp_f32 v74, v74
    v_mfma_f32_32x32x16_bf16 v[96:111], a[92:95], a[28:31], v[96:111]
    s_waitcnt lgkmcnt(8)
    v_add_f32 v72, v72, v74
    v_fma_f32 v76, v122, s24, -v69
    v_exp_f32 v75, v75
    v_mfma_f32_32x32x16_bf16 v[128:143], a[96:99], v[80:83], v[128:143]
    s_cselect_b32 s69, s70, 0
    v_add_f32 v72, v72, v75
    v_cvt_pk_bf16_f32 v92, v74, v75
    v_fma_f32 v77, v123, s24, -v69
    v_exp_f32 v76, v76
    v_mfma_f32_32x32x16_bf16 v[144:159], a[100:103], v[80:83], v[144:159]
    s_cselect_b32 s48, s71, s48
    buffer_load_dwordx4 v78, s[16:19], s44 offen offset:0 lds
    v_add_f32 v72, v72, v76
    v_fma_f32 v74, v124, s24, -v69
    v_exp_f32 v77, v77
    v_mfma_f32_32x32x16_bf16 v[160:175], a[104:107], v[80:83], v[160:175]
    s_cmp_gt_i32 s42, 2
    v_add_f32 v72, v72, v77
    v_cvt_pk_bf16_f32 v93, v76, v77
    v_fma_f32 v75, v125, s24, -v69
    v_exp_f32 v74, v74
    v_mfma_f32_32x32x16_bf16 v[176:191], a[108:111], v[80:83], v[176:191]
    s_waitcnt lgkmcnt(0)
    v_add_f32 v72, v72, v74
    v_fma_f32 v76, v126, s24, -v69
    v_exp_f32 v75, v75
    v_mfma_f32_32x32x16_bf16 v[128:143], a[112:115], v[84:87], v[128:143]
    s_cselect_b32 s43, s45, s26
    v_add_f32 v72, v72, v75
    v_cvt_pk_bf16_f32 v94, v74, v75
    v_fma_f32 v77, v127, s24, -v69
    v_exp_f32 v76, v76
    v_mfma_f32_32x32x16_bf16 v[144:159], a[116:119], v[84:87], v[144:159]
    buffer_load_dwordx4 v79, s[16:19], s44 offen offset:1024 lds
    v_add_f32 v72, v72, v76
    v_fma_f32 v74, v96, s24, -v68
    v_exp_f32 v77, v77
    v_mfma_f32_32x32x16_bf16 v[160:175], a[120:123], v[84:87], v[160:175]
    s_cselect_b32 m0, s63, s76
    v_add_f32 v72, v72, v77
    v_cvt_pk_bf16_f32 v95, v76, v77
    v_fma_f32 v75, v97, s24, -v68
    v_exp_f32 v74, v74
    v_mfma_f32_32x32x16_bf16 v[176:191], a[124:127], v[84:87], v[176:191]
    s_waitcnt vmcnt(10)
    v_cmp_nge_f32 vcc, s25, v72
    v_add_f32 v71, v70, v74
    v_fma_f32 v76, v98, s24, -v68
    v_exp_f32 v75, v75
    s_cbranch_vccnz L_stub16
L_ret16:
    v_mfma_f32_32x32x16_bf16 v[112:127], a[64:67], a[32:35], 0
    s_barrier
    ds_read_b128 a[64:67], v60 offset:0
    v_add_f32 v71, v71, v75
    v_cvt_pk_bf16_f32 v80, v74, v75
    v_fma_f32 v77, v99, s24, -v68
    v_exp_f32 v76, v76
    v_mfma_f32_32x32x16_bf16 v[112:127], a[68:71], a[36:39], v[112:127]
    ds_read_b128 a[68:71], v61 offset:0
    v_add_f32 v71, v71, v76
    v_fma_f32 v74, v100, s24, -v68
    v_exp_f32 v77, v77
    v_mfma_f32_32x32x16_bf16 v[112:127], a[72:75], a[40:43], v[112:127]
    s_sub_u32 s42, s42, 1
    ds_read_b128 a[72:75], v62 offset:0
    v_add_f32 v71, v71, v77
    v_cvt_pk_bf16_f32 v81, v76, v77
    v_fma_f32 v75, v101, s24, -v68
    v_exp_f32 v74, v74
    v_mfma_f32_32x32x16_bf16 v[112:127], a[76:79], a[44:47], v[112:127]
    s_add_u32 s47, s47, s69
    buffer_load_dwordx4 v0, s[12:15], s43 offen offset:0 lds
    v_add_f32 v71, v71, v74
    v_fma_f32 v76, v102, s24, -v68
    v_exp_f32 v75, v75
    v_mfma_f32_32x32x16_bf16 v[112:127], a[80:83], a[48:51], v[112:127]
    s_cmp_gt_i32 s46, 0
    ds_read_b128 a[76:79], v63 offset:0
    v_add_f32 v71, v71, v75
    v_cvt_pk_bf16_f32 v82, v74, v75
    v_fma_f32 v77, v103, s24, -v68
    v_exp_f32 v76, v76
    v_mfma_f32_32x32x16_bf16 v[112:127], a[84:87], a[52:55], v[112:127]
    ds_read_b128 a[80:83], v64 offset:0
    ds_read_b128 a[84:87], v65 offset:0
    v_add_f32 v71, v71, v76
    v_fma_f32 v74, v104, s24, -v68
    v_exp_f32 v77, v77
    v_mfma_f32_32x32x16_bf16 v[112:127], a[88:91], a[56:59], v[112:127]
    s_cselect_b32 s49, s47, s26
    ds_read_b128 a[88:91], v66 offset:0
    v_add_f32 v71, v71, v77
    v_cvt_pk_bf16_f32 v83, v76, v77
    v_fma_f32 v75, v105, s24, -v68
    v_exp_f32 v74, v74
    v_mfma_f32_32x32x16_bf16 v[112:127], a[92:95], a[60:63], v[112:127]
    buffer_load_dwordx4 v1, s[12:15], s43 offen offset:1024 lds
    v_add_f32 v71, v71, v74
    v_fma_f32 v76, v106, s24, -v68
    v_exp_f32 v75, v75
    v_mfma_f32_32x32x16_bf16 v[192:207], a[96:99], v[88:91], v[192:207]
    s_cselect_b32 m0, s48, s76
    ds_read_b128 a[92:95], v67 offset:0
    v_add_f32 v71, v71, v75
    v_cvt_pk_bf16_f32 v84, v74, v75
    v_fma_f32 v77, v107, s24, -v68
    v_exp_f32 v76, v76
    v_mfma_f32_32x32x16_bf16 v[208:223], a[100:103], v[88:91], v[208:223]
    ds_read_b64_tr_b16 a[96:97], v56 offset:57344
    ds_read_b64_tr_b16 a[98:99], v56 offset:59392
    v_add_f32 v71, v71, v76
    v_fma_f32 v74, v108, s24, -v68
    v_exp_f32 v77, v77
    v_mfma_f32_32x32x16_bf16 v[224:239], a[104:107], v[88:91], v[224:239]
    ds_read_b64_tr_b16 a[100:101], v57 offset:57344
    v_add_f32 v71, v71, v77
    v_cvt_pk_bf16_f32 v85, v76, v77
    v_fma_f32 v75, v109, s24, -v68
    v_exp_f32 v74, v74
    v_mfma_f32_32x32x16_bf16 v[240:255], a[108:111], v[88:91], v[240:255]
    buffer_load_dwordx4 v10, s[8:11], s49 offen nt lds
    v_add_f32 v71, v71, v74
    v_fma_f32 v76, v110, s24, -v68
    v_exp_f32 v75, v75
    v_mfma_f32_32x32x16_bf16 v[192:207], a[112:115], v[92:95], v[192:207]
    s_add_u32 s47, s47, 0x4000
    ds_read_b64_tr_b16 a[102:103], v57 offset:59392
    v_add_f32 v71, v71, v75
    v_cvt_pk_bf16_f32 v86, v74, v75
    v_fma_f32 v77, v111, s24, -v68
    v_exp_f32 v76, v76
    v_mfma_f32_32x32x16_bf16 v[208:223], a[116:119], v[92:95], v[208:223]
    s_add_u32 s48, s48, 0x400
    ds_read_b64_tr_b16 a[104:105], v58 offset:57344
    ds_read_b64_tr_b16 a[106:107], v58 offset:59392
    v_add_f32 v71, v71, v76
    v_fma_f32 v74, v112, s24, -v69
    v_exp_f32 v77, v77
    v_mfma_f32_32x32x16_bf16 v[224:239], a[120:123], v[92:95], v[224:239]
    s_cmp_ge_i32 s42, -1
    ds_read_b64_tr_b16 a[108:109], v59 offset:57344
    v_add_f32 v71, v71, v77
    v_cvt_pk_bf16_f32 v87, v76, v77
    v_fma_f32 v75, v113, s24, -v69
    v_exp_f32 v74, v74
    v_mfma_f32_32x32x16_bf16 v[240:255], a[124:127], v[92:95], v[240:255]
    s_waitcnt lgkmcnt(7)
    v_cmp_nge_f32 vcc, s25, v71
    v_add_f32 v73, v72, v74
    v_fma_f32 v76, v114, s24, -v69
    v_exp_f32 v75, v75
    s_cbranch_vccnz L_stub17
L_ret17:
    s_cbranch_scc0 L_tail_A_3
L_loop_A_3:
    v_mfma_f32_32x32x16_bf16 v[96:111], a[64:67], a[0:3], 0
    s_cmp_gt_i32 s42, 0
    ds_read_b64_tr_b16 a[110:111], v59 offset:59392
    v_add_f32 v73, v73, v75
    v_cvt_pk_bf16_f32 v88, v74, v75
    v_fma_f32 v77, v115, s24, -v69
    v_exp_f32 v76, v76
    v_mfma_f32_32x32x16_bf16 v[96:111], a[68:71], a[4:7], v[96:111]
    s_cselect_b32 s44, s41, s26
    ds_read_b64_tr_b16 a[112:113], v56 offset:61440
    ds_read_b64_tr_b16 a[114:115], v56 offset:63488
    v_add_f32 v73, v73, v76
    v_fma_f32 v74, v116, s24, -v69
    v_exp_f32 v77, v77
    v_mfma_f32_32x32x16_bf16 v[96:111], a[72:75], a[8:11], v[96:111]
    s_cselect_b32 m0, s66, s76
    ds_read_b64_tr_b16 a[116:117], v57 offset:61440
    v_add_f32 v73, v73, v77
    v_cvt_pk_bf16_f32 v89, v76, v77
    v_fma_f32 v75, v117, s24, -v69
    v_exp_f32 v74, v74
    v_mfma_f32_32x32x16_bf16 v[96:111], a[76:79], a[12:15], v[96:111]
    s_sub_u32 s45, s41, 0x10000
    ds_read_b64_tr_b16 a[118:119], v57 offset:63488
    ds_read_b64_tr_b16 a[120:121], v58 offset:61440
    v_add_f32 v73, v73, v74
    v_fma_f32 v76, v118, s24, -v69
    v_exp_f32 v75, v75
    v_mfma_f32_32x32x16_bf16 v[96:111], a[80:83], a[16:19], v[96:111]
    s_sub_u32 s41, s41, 0x8000
    ds_read_b64_tr_b16 a[122:123], v58 offset:63488
    v_add_f32 v73, v73, v75
    v_cvt_pk_bf16_f32 v90, v74, v75
    v_fma_f32 v77, v119, s24, -v69
    v_exp_f32 v76, v76
    v_mfma_f32_32x32x16_bf16 v[96:111], a[84:87], a[20:23], v[96:111]
    s_sub_u32 s46, s46, 1
    ds_read_b64_tr_b16 a[124:125], v59 offset:61440
    ds_read_b64_tr_b16 a[126:127], v59 offset:63488
    v_add_f32 v73, v73, v76
    v_fma_f32 v74, v120, s24, -v69
    v_exp_f32 v77, v77
    v_mfma_f32_32x32x16_bf16 v[96:111], a[88:91], a[24:27], v[96:111]
    s_cmp_eq_u32 s46, 8
    v_add_f32 v73, v73, v77
    v_cvt_pk_bf16_f32 v91, v76, v77
    v_fma_f32 v75, v121, s24, -v69
    v_exp_f32 v74, v74
    v_mfma_f32_32x32x16_bf16 v[96:111], a[92:95], a[28:31], v[96:111]
    s_waitcnt lgkmcnt(8)
    v_add_f32 v73, v73, v74
    v_fma_f32 v76, v122, s24, -v69
    v_exp_f32 v75, v75
    v_mfma_f32_32x32x16_bf16 v[128:143], a[96:99], v[80:83], v[128:143]
    s_cselect_b32 s69, s70, 0
    v_add_f32 v73, v73, v75
    v_cvt_pk_bf16_f32 v92, v74, v75
    v_fma_f32 v77, v123, s24, -v69
    v_exp_f32 v76, v76
    v_mfma_f32_32x32x16_bf16 v[144:159], a[100:103], v[80:83], v[144:159]
    s_cselect_b32 s48, s71, s48
    buffer_load_dwordx4 v78, s[16:19], s44 offen offset:0 lds
    v_add_f32 v73, v73, v76
    v_fma_f32 v74, v124, s24, -v69
    v_exp_f32 v77, v77
    v_mfma_f32_32x32x16_bf16 v[160:175], a[104:107], v[80:83], v[160:175]
    s_cmp_gt_i32 s42, 2
    v_add_f32 v73, v73, v77
    v_cvt_pk_bf16_f32 v93, v76, v77
    v_fma_f32 v75, v125, s24, -v69
    v_exp_f32 v74, v74
    v_mfma_f32_32x32x16_bf16 v[176:191], a[108:111], v[80:83], v[176:191]
    s_waitcnt lgkmcnt(0)
    v_add_f32 v73, v73, v74
    v_fma_f32 v76, v126, s24, -v69
    v_exp_f32 v75, v75
    v_mfma_f32_32x32x16_bf16 v[128:143], a[112:115], v[84:87], v[128:143]
    s_cselect_b32 s43, s45, s26
    v_add_f32 v73, v73, v75
    v_cvt_pk_bf16_f32 v94, v74, v75
    v_fma_f32 v77, v127, s24, -v69
    v_exp_f32 v76, v76
    v_mfma_f32_32x32x16_bf16 v[144:159], a[116:119], v[84:87], v[144:159]
    buffer_load_dwordx4 v79, s[16:19], s44 offen offset:1024 lds
    v_add_f32 v73, v73, v76
    v_fma_f32 v74, v96, s24, -v68
    v_exp_f32 v77, v77
    v_mfma_f32_32x32x16_bf16 v[160:175], a[120:123], v[84:87], v[160:175]
    s_cselect_b32 m0, s60, s76
    v_add_f32 v73, v73, v77
    v_cvt_pk_bf16_f32 v95, v76, v77
    v_fma_f32 v75, v97, s24, -v68
    v_exp_f32 v74, v74
    v_mfma_f32_32x32x16_bf16 v[176:191], a[124:127], v[84:87], v[176:191]
    s_waitcnt vmcnt(10)
    v_cmp_nge_f32 vcc, s25, v73
    v_add_f32 v70, v71, v74
    v_fma_f32 v76, v98, s24, -v68
    v_exp_f32 v75, v75
    s_cbranch_vccnz L_stub18
L_ret18:
    v_mfma_f32_32x32x16_bf16 v[112:127], a[64:67], a[32:35], 0
    s_barrier
    ds_read_b128 a[64:67], v60 offset:8192
    v_add_f32 v70, v70, v75
    v_cvt_pk_bf16_f32 v80, v74, v75
    v_fma_f32 v77, v99, s24, -v68
    v_exp_f32 v76, v76
    v_mfma_f32_32x32x16_bf16 v[112:127], a[68:71], a[36:39], v[112:127]
    ds_read_b128 a[68:71], v61 offset:8192
    v_add_f32 v70, v70, v76
    v_fma_f32 v74, v100, s24, -v68
    v_exp_f32 v77, v77
    v_mfma_f32_32x32x16_bf16 v[112:127], a[72:75], a[40:43], v[112:127]
    s_sub_u32 s42, s42, 1
    ds_read_b128 a[72:75], v62 offset:8192
    v_add_f32 v70, v70, v77
    v_cvt_pk_bf16_f32 v81, v76, v77
    v_fma_f32 v75, v101, s24, -v68
    v_exp_f32 v74, v74
    v_mfma_f32_32x32x16_bf16 v[112:127], a[76:79], a[44:47], v[112:127]
    s_add_u32 s47, s47, s69
    buffer_load_dwordx4 v0, s[12:15], s43 offen offset:0 lds
    v_add_f32 v70, v70, v74
    v_fma_f32 v76, v102, s24, -v68
    v_exp_f32 v75, v75
    v_mfma_f32_32x32x16_bf16 v[112:127], a[80:83], a[48:51], v[112:127]
    s_cmp_gt_i32 s46, 0
    ds_read_b128 a[76:79], v63 offset:8192
    v_add_f32 v70, v70, v75
    v_cvt_pk_bf16_f32 v82, v74, v75
    v_fma_f32 v77, v103, s24, -v68
    v_exp_f32 v76, v76
    v_mfma_f32_32x32x16_bf16 v[112:127], a[84:87], a[52:55], v[112:127]
    ds_read_b128 a[80:83], v64 offset:8192
    ds_read_b128 a[84:87], v65 offset:8192
    v_add_f32 v70, v70, v76
    v_fma_f32 v74, v104, s24, -v68
    v_exp_f32 v77, v77
    v_mfma_f32_32x32x16_bf16 v[112:127], a[88:91], a[56:59], v[112:127]
    s_cselect_b32 s49, s47, s26
    ds_read_b128 a[88:91], v66 offset:8192
    v_add_f32 v70, v70, v77
    v_cvt_pk_bf16_f32 v83, v76, v77
    v_fma_f32 v75, v105, s24, -v68
    v_exp_f32 v74, v74
    v_mfma_f32_32x32x16_bf16 v[112:127], a[92:95], a[60:63], v[112:127]
    buffer_load_dwordx4 v1, s[12:15], s43 offen offset:1024 lds
    v_add_f32 v70, v70, v74
    v_fma_f32 v76, v106, s24, -v68
    v_exp_f32 v75, v75
    v_mfma_f32_32x32x16_bf16 v[192:207], a[96:99], v[88:91], v[192:207]
    s_cselect_b32 m0, s48, s76
    ds_read_b128 a[92:95], v67 offset:8192
    v_add_f32 v70, v70, v75
    v_cvt_pk_bf16_f32 v84, v74, v75
    v_fma_f32 v77, v107, s24, -v68
    v_exp_f32 v76, v76
    v_mfma_f32_32x32x16_bf16 v[208:223], a[100:103], v[88:91], v[208:223]
    ds_read_b64_tr_b16 a[96:97], v56 offset:32768
    ds_read_b64_tr_b16 a[98:99], v56 offset:34816
    v_add_f32 v70, v70, v76
    v_fma_f32 v74, v108, s24, -v68
    v_exp_f32 v77, v77
    v_mfma_f32_32x32x16_bf16 v[224:239], a[104:107], v[88:91], v[224:239]
    ds_read_b64_tr_b16 a[100:101], v57 offset:32768
    v_add_f32 v70, v70, v77
    v_cvt_pk_bf16_f32 v85, v76, v77
    v_fma_f32 v75, v109, s24, -v68
    v_exp_f32 v74, v74
    v_mfma_f32_32x32x16_bf16 v[240:255], a[108:111], v[88:91], v[240:255]
    buffer_load_dwordx4 v11, s[8:11], s49 offen nt lds
    v_add_f32 v70, v70, v74
    v_fma_f32 v76, v110, s24, -v68
    v_exp_f32 v75, v75
    v_mfma_f32_32x32x16_bf16 v[192:207], a[112:115], v[92:95], v[192:207]
    s_add_u32 s47, s47, 0x4000
    ds_read_b64_tr_b16 a[102:103], v57 offset:34816
    v_add_f32 v70, v70, v75
    v_cvt_pk_bf16_f32 v86, v74, v75
    v_fma_f32 v77, v111, s24, -v68
    v_exp_f32 v76, v76
    v_mfma_f32_32x32x16_bf16 v[208:223], a[116:119], v[92:95], v[208:223]
    s_add_u32 s48, s48, 0x400
    ds_read_b64_tr_b16 a[104:105], v58 offset:32768
    ds_read_b64_tr_b16 a[106:107], v58 offset:34816
    v_add_f32 v70, v70, v76
    v_fma_f32 v74, v112, s24, -v69
    v_exp_f32 v77, v77
    v_mfma_f32_32x32x16_bf16 v[224:239], a[120:123], v[92:95], v[224:239]
    s_cmp_ge_i32 s42, -1
    ds_read_b64_tr_b16 a[108:109], v59 offset:32768
    v_add_f32 v70, v70, v77
    v_cvt_pk_bf16_f32 v87, v76, v77
    v_fma_f32 v75, v113, s24, -v69
    v_exp_f32 v74, v74
    v_mfma_f32_32x32x16_bf16 v[240:255], a[124:127], v[92:95], v[240:255]
    s_waitcnt lgkmcnt(7)
    v_cmp_nge_f32 vcc, s25, v70
    v_add_f32 v72, v73, v74
    v_fma_f32 v76, v114, s24, -v69
    v_exp_f32 v75, v75
    s_cbranch_vccnz L_stub19
L_ret19:
    s_cbranch_scc0 L_tail_A_0
    s_branch L_loop_A_0
L_tail_A_0:
    ds_read_b64_tr_b16 a[110:111], v59 offset:34816
    ds_read_b64_tr_b16 a[112:113], v56 offset:36864
    ds_read_b64_tr_b16 a[114:115], v56 offset:38912
    ds_read_b64_tr_b16 a[116:117], v57 offset:36864
    ds_read_b64_tr_b16 a[118:119], v57 offset:38912
    ds_read_b64_tr_b16 a[120:121], v58 offset:36864
    ds_read_b64_tr_b16 a[122:123], v58 offset:38912
    ds_read_b64_tr_b16 a[124:125], v59 offset:36864
    ds_read_b64_tr_b16 a[126:127], v59 offset:38912
    s_lshl_b32 s50, s5, 4
    s_max_i32 s50, s50, s46
    s_cmp_gt_i32 s50, 1
    s_cbranch_scc1 L_cold21
L_back21:
    v_exp_f32 v76, v76
    v_add_f32 v72, v72, v75
    v_cvt_pk_bf16_f32 v88, v74, v75
    v_fma_f32 v77, v115, s24, -v69
    v_exp_f32 v77, v77
    v_add_f32 v72, v72, v76
    v_fma_f32 v74, v116, s24, -v69
    v_exp_f32 v74, v74
    v_add_f32 v72, v72, v77
    v_cvt_pk_bf16_f32 v89, v76, v77
    s_waitcnt lgkmcnt(0)
    v_mfma_f32_32x32x16_bf16 v[128:143], a[96:99], v[80:83], v[128:143]
    s_barrier
    s_lshl_b32 s50, s28, 16
    s_bitcmp1_b32 s75, 10
    s_cselect_b32 s68, s50, 0
    s_cselect_b32 s50, s97, s96
    v_fma_f32 v75, v117, s24, -v69
    v_exp_f32 v75, v75
    v_mfma_f32_32x32x16_bf16 v[144:159], a[100:103], v[80:83], v[144:159]
    s_add_u32 s60, s50, 0
    s_add_u32 s64, s50, 32768
    s_add_u32 s61, s50, 8192
    s_add_u32 s65, s50, 40960
    v_add_f32 v72, v72, v74
    v_fma_f32 v76, v118, s24, -v69
    v_exp_f32 v76, v76
    v_mfma_f32_32x32x16_bf16 v[160:175], a[104:107], v[80:83], v[160:175]
    s_add_u32 s62, s50, 16384
    s_add_u32 s66, s50, 49152
    s_add_u32 s63, s50, 24576
    s_add_u32 s67, s50, 57344
    v_add_f32 v72, v72, v75
    v_cvt_pk_bf16_f32 v90, v74, v75
    v_fma_f32 v77, v119, s24, -v69
    v_mfma_f32_32x32x16_bf16 v[176:191], a[108:111], v[80:83], v[176:191]
    s_sub_u32 s54, s73, 0
    s_cmp_gt_i32 s74, 0
    s_cselect_b32 s54, s54, s26
    s_cselect_b32 m0, s60, s76
    s_bitcmp1_b32 s75, 10
    s_cbranch_scc1 L_pfb22
    buffer_load_dwordx4 v0, s[12:15], s54 offen offset:0 nt lds
    buffer_load_dwordx4 v1, s[12:15], s54 offen offset:1024 nt lds
L_pfe22:
    v_mfma_f32_32x32x16_bf16 v[128:143], a[112:115], v[84:87], v[128:143]
    v_exp_f32 v77, v77
    v_add_f32 v72, v72, v76
    v_fma_f32 v74, v120, s24, -v69
    v_exp_f32 v74, v74
    v_add_f32 v72, v72, v77
    v_cvt_pk_bf16_f32 v91, v76, v77
    v_mfma_f32_32x32x16_bf16 v[144:159], a[116:119], v[84:87], v[144:159]
    v_fma_f32 v75, v121, s24, -v69
    v_exp_f32 v75, v75
    v_add_f32 v72, v72, v74
    v_fma_f32 v76, v122, s24, -v69
    v_exp_f32 v76, v76
    v_add_f32 v72, v72, v75
    v_mfma_f32_32x32x16_bf16 v[160:175], a[120:123], v[84:87], v[160:175]
    s_sub_u32 s54, s73, 32768
    s_cmp_gt_i32 s74, 1
    s_cselect_b32 s54, s54, s26
    s_cselect_b32 m0, s61, s76
    s_bitcmp1_b32 s75, 10
    s_cbranch_scc1 L_pfb23
    buffer_load_dwordx4 v0, s[12:15], s54 offen offset:0 nt lds
    buffer_load_dwordx4 v1, s[12:15], s54 offen offset:1024 nt lds
L_pfe23:
    v_mfma_f32_32x32x16_bf16 v[176:191], a[124:127], v[84:87], v[176:191]
    v_cvt_pk_bf16_f32 v92, v74, v75
    v_fma_f32 v77, v123, s24, -v69
    v_exp_f32 v77, v77
    v_add_f32 v72, v72, v76
    v_fma_f32 v74, v124, s24, -v69
    v_exp_f32 v74, v74
    v_add_f32 v72, v72, v77
    v_cvt_pk_bf16_f32 v93, v76, v77
    v_fma_f32 v75, v125, s24, -v69
    v_exp_f32 v75, v75
    v_add_f32 v72, v72, v74
    v_fma_f32 v76, v126, s24, -v69
    v_exp_f32 v76, v76
    v_add_f32 v72, v72, v75
    v_cvt_pk_bf16_f32 v94, v74, v75
    v_fma_f32 v77, v127, s24, -v69
    v_exp_f32 v77, v77
    v_add_f32 v72, v72, v76
    s_nop 0
    v_add_f32 v72, v72, v77
    v_cvt_pk_bf16_f32 v95, v76, v77
    v_cmp_nge_f32 vcc, s25, v72
    s_nop 1
    s_cbranch_vccnz L_stub24
L_ret24:
    v_mfma_f32_32x32x16_bf16 v[192:207], a[96:99], v[88:91], v[192:207]
    v_mov_b32 v2, v70
    v_mov_b32 v3, v70
    v_mov_b32 v4, v72
    v_mov_b32 v5, v72
    s_and_b32 s50, s39, 63
    v_and_b32 v6, 31, v15
    v_mfma_f32_32x32x16_bf16 v[208:223], a[100:103], v[88:91], v[208:223]
    v_lshrrev_b32 v7, 5, v15
    v_lshlrev_b32 v36, 7, v6
    v_bfe_u32 v42, v15, 3, 1
    v_xor_b32 v7, v7, v42
    v_lshl_add_u32 v36, v7, 3, v36
    v_and_b32 v6, 7, v15
    v_mfma_f32_32x32x16_bf16 v[224:239], a[104:107], v[88:91], v[224:239]
    v_lshl_add_u32 v36, v6, 4, v36
    v_add_u32 v36, s78, v36
    v_permlane32_swap_b32 v2, v3
    v_permlane32_swap_b32 v4, v5
    v_lshrrev_b32 v6, 3, v15
    v_and_b32 v7, 7, v15
    v_mfma_f32_32x32x16_bf16 v[240:255], a[108:111], v[88:91], v[240:255]
    v_add_f32 v2, v2, v3
    v_add_f32 v4, v4, v5
    v_xor_b32 v37, v6, v7
    v_lshlrev_b32 v37, 4, v37
    v_lshl_add_u32 v37, v6, 7, v37
    v_add_u32 v37, s78, v37
    v_mfma_f32_32x32x16_bf16 v[192:207], a[112:115], v[92:95], v[192:207]
    v_lshlrev_b32 v7, 4, v7
    v_lshl_add_u32 v7, v6, 12, v7
    v_mov_b32 v43, s26
    v_add_u32 v42, 0, v6
    v_cmp_gt_u32 vcc, s50, v42
    v_add_u32 v42, 0, v7
    v_mfma_f32_32x32x16_bf16 v[208:223], a[116:119], v[92:95], v[208:223]
    s_nop 0
    v_cndmask_b32 v32, v43, v42, vcc
    v_add_u32 v42, 8, v6
    v_cmp_gt_u32 vcc, s50, v42
    v_add_u32 v42, 32768, v7
    s_nop 0
    v_mfma_f32_32x32x16_bf16 v[224:239], a[120:123], v[92:95], v[224:239]
    v_cndmask_b32 v33, v43, v42, vcc
    v_add_u32 v42, 16, v6
    v_cmp_gt_u32 vcc, s50, v42
    v_add_u32 v42, 65536, v7
    s_nop 0
    v_cndmask_b32 v34, v43, v42, vcc
    v_mfma_f32_32x32x16_bf16 v[240:255], a[124:127], v[92:95], v[240:255]
    v_add_u32 v42, 24, v6
    v_cmp_gt_u32 vcc, s50, v42
    v_add_u32 v42, 98304, v7
    s_nop 0
    v_cndmask_b32 v35, v43, v42, vcc
    v_rcp_f32 v2, v2
    v_rcp_f32 v4, v4
    s_branch L_epi_A
L_cold21:
    s_call_b64 s[30:31], L_qrem_0
    s_branch L_back21
L_pfb22:
    buffer_load_dwordx4 v48, s[12:15], s54 offen offset:0 nt lds
    buffer_load_dwordx4 v49, s[12:15], s54 offen offset:1024 nt lds
    buffer_load_dwordx4 v50, s[12:15], s54 offen offset:2048 nt lds
    buffer_load_dwordx4 v51, s[12:15], s54 offen offset:3072 nt lds
    s_branch L_pfe22
L_pfb23:
    buffer_load_dwordx4 v48, s[12:15], s54 offen offset:0 nt lds
    buffer_load_dwordx4 v49, s[12:15], s54 offen offset:1024 nt lds
    buffer_load_dwordx4 v50, s[12:15], s54 offen offset:2048 nt lds
    buffer_load_dwordx4 v51, s[12:15], s54 offen offset:3072 nt lds
    s_branch L_pfe23
L_tail_A_1:
    ds_read_b64_tr_b16 a[110:111], v59 offset:43008
    ds_read_b64_tr_b16 a[112:113], v56 offset:45056
    ds_read_b64_tr_b16 a[114:115], v56 offset:47104
    ds_read_b64_tr_b16 a[116:117], v57 offset:45056
    ds_read_b64_tr_b16 a[118:119], v57 offset:47104
    ds_read_b64_tr_b16 a[120:121], v58 offset:45056
    ds_read_b64_tr_b16 a[122:123], v58 offset:47104
    ds_read_b64_tr_b16 a[124:125], v59 offset:45056
    ds_read_b64_tr_b16 a[126:127], v59 offset:47104
    s_lshl_b32 s50, s5, 4
    s_max_i32 s50, s50, s46
    s_cmp_gt_i32 s50, 1
    s_cbranch_scc1 L_cold26
L_back26:
    v_exp_f32 v76, v76
    v_add_f32 v73, v73, v75
    v_cvt_pk_bf16_f32 v88, v74, v75
    v_fma_f32 v77, v115, s24, -v69
    v_exp_f32 v77, v77
    v_add_f32 v73, v73, v76
    v_fma_f32 v74, v116, s24, -v69
    v_exp_f32 v74, v74
    v_add_f32 v73, v73, v77
    v_cvt_pk_bf16_f32 v89, v76, v77
    s_waitcnt lgkmcnt(0)
    v_mfma_f32_32x32x16_bf16 v[128:143], a[96:99], v[80:83], v[128:143]
    s_barrier
    s_lshl_b32 s50, s28, 16
    s_bitcmp1_b32 s75, 10
    s_cselect_b32 s68, s50, 0
    s_cselect_b32 s50, s97, s96
    v_fma_f32 v75, v117, s24, -v69
    v_exp_f32 v75, v75
    v_mfma_f32_32x32x16_bf16 v[144:159], a[100:103], v[80:83], v[144:159]
    s_add_u32 s60, s50, 0
    s_add_u32 s64, s50, 32768
    s_add_u32 s61, s50, 8192
    s_add_u32 s65, s50, 40960
    v_add_f32 v73, v73, v74
    v_fma_f32 v76, v118, s24, -v69
    v_exp_f32 v76, v76
    v_mfma_f32_32x32x16_bf16 v[160:175], a[104:107], v[80:83], v[160:175]
    s_add_u32 s62, s50, 16384
    s_add_u32 s66, s50, 49152
    s_add_u32 s63, s50, 24576
    s_add_u32 s67, s50, 57344
    v_add_f32 v73, v73, v75
    v_cvt_pk_bf16_f32 v90, v74, v75
    v_fma_f32 v77, v119, s24, -v69
    v_mfma_f32_32x32x16_bf16 v[176:191], a[108:111], v[80:83], v[176:191]
    s_sub_u32 s54, s73, 0
    s_cmp_gt_i32 s74, 0
    s_cselect_b32 s54, s54, s26
    s_cselect_b32 m0, s60, s76
    s_bitcmp1_b32 s75, 10
    s_cbranch_scc1 L_pfb27
    buffer_load_dwordx4 v0, s[12:15], s54 offen offset:0 nt lds
    buffer_load_dwordx4 v1, s[12:15], s54 offen offset:1024 nt lds
L_pfe27:
    v_mfma_f32_32x32x16_bf16 v[128:143], a[112:115], v[84:87], v[128:143]
    v_exp_f32 v77, v77
    v_add_f32 v73, v73, v76
    v_fma_f32 v74, v120, s24, -v69
    v_exp_f32 v74, v74
    v_add_f32 v73, v73, v77
    v_cvt_pk_bf16_f32 v91, v76, v77
    v_mfma_f32_32x32x16_bf16 v[144:159], a[116:119], v[84:87], v[144:159]
    v_fma_f32 v75, v121, s24, -v69
    v_exp_f32 v75, v75
    v_add_f32 v73, v73, v74
    v_fma_f32 v76, v122, s24, -v69
    v_exp_f32 v76, v76
    v_add_f32 v73, v73, v75
    v_mfma_f32_32x32x16_bf16 v[160:175], a[120:123], v[84:87], v[160:175]
    s_sub_u32 s54, s73, 32768
    s_cmp_gt_i32 s74, 1
    s_cselect_b32 s54, s54, s26
    s_cselect_b32 m0, s61, s76
    s_bitcmp1_b32 s75, 10
    s_cbranch_scc1 L_pfb28
    buffer_load_dwordx4 v0, s[12:15], s54 offen offset:0 nt lds
    buffer_load_dwordx4 v1, s[12:15], s54 offen offset:1024 nt lds
L_pfe28:
    v_mfma_f32_32x32x16_bf16 v[176:191], a[124:127], v[84:87], v[176:191]
    v_cvt_pk_bf16_f32 v92, v74, v75
    v_fma_f32 v77, v123, s24, -v69
    v_exp_f32 v77, v77
    v_add_f32 v73, v73, v76
    v_fma_f32 v74, v124, s24, -v69
    v_exp_f32 v74, v74
    v_add_f32 v73, v73, v77
    v_cvt_pk_bf16_f32 v93, v76, v77
    v_fma_f32 v75, v125, s24, -v69
    v_exp_f32 v75, v75
    v_add_f32 v73, v73, v74
    v_fma_f32 v76, v126, s24, -v69
    v_exp_f32 v76, v76
    v_add_f32 v73, v73, v75
    v_cvt_pk_bf16_f32 v94, v74, v75
    v_fma_f32 v77, v127, s24, -v69
    v_exp_f32 v77, v77
    v_add_f32 v73, v73, v76
    s_nop 0
    v_add_f32 v73, v73, v77
    v_cvt_pk_bf16_f32 v95, v76, v77
    v_cmp_nge_f32 vcc, s25, v73
    s_nop 1
    s_cbranch_vccnz L_stub29
L_ret29:
    v_mfma_f32_32x32x16_bf16 v[192:207], a[96:99], v[88:91], v[192:207]
    v_mov_b32 v2, v71
    v_mov_b32 v3, v71
    v_mov_b32 v4, v73
    v_mov_b32 v5, v73
    s_and_b32 s50, s39, 63
    v_and_b32 v6, 31, v15
    v_mfma_f32_32x32x16_bf16 v[208:223], a[100:103], v[88:91], v[208:223]
    v_lshrrev_b32 v7, 5, v15
    v_lshlrev_b32 v36, 7, v6
    v_bfe_u32 v42, v15, 3, 1
    v_xor_b32 v7, v7, v42
    v_lshl_add_u32 v36, v7, 3, v36
    v_and_b32 v6, 7, v15
    v_mfma_f32_32x32x16_bf16 v[224:239], a[104:107], v[88:91], v[224:239]
    v_lshl_add_u32 v36, v6, 4, v36
    v_add_u32 v36, s78, v36
    v_permlane32_swap_b32 v2, v3
    v_permlane32_swap_b32 v4, v5
    v_lshrrev_b32 v6, 3, v15
    v_and_b32 v7, 7, v15
    v_mfma_f32_32x32x16_bf16 v[240:255], a[108:111], v[88:91], v[240:255]
    v_add_f32 v2, v2, v3
    v_add_f32 v4, v4, v5
    v_xor_b32 v37, v6, v7
    v_lshlrev_b32 v37, 4, v37
    v_lshl_add_u32 v37, v6, 7, v37
    v_add_u32 v37, s78, v37
    v_mfma_f32_32x32x16_bf16 v[192:207], a[112:115], v[92:95], v[192:207]
    v_lshlrev_b32 v7, 4, v7
    v_lshl_add_u32 v7, v6, 12, v7
    v_mov_b32 v43, s26
    v_add_u32 v42, 0, v6
    v_cmp_gt_u32 vcc, s50, v42
    v_add_u32 v42, 0, v7
    v_mfma_f32_32x32x16_bf16 v[208:223], a[116:119], v[92:95], v[208:223]
    s_nop 0
    v_cndmask_b32 v32, v43, v42, vcc
    v_add_u32 v42, 8, v6
    v_cmp_gt_u32 vcc, s50, v42
    v_add_u32 v42, 32768, v7
    s_nop 0
    v_mfma_f32_32x32x16_bf16 v[224:239], a[120:123], v[92:95], v[224:239]
    v_cndmask_b32 v33, v43, v42, vcc
    v_add_u32 v42, 16, v6
    v_cmp_gt_u32 vcc, s50, v42
    v_add_u32 v42, 65536, v7
    s_nop 0
    v_cndmask_b32 v34, v43, v42, vcc
    v_mfma_f32_32x32x16_bf16 v[240:255], a[124:127], v[92:95], v[240:255]
    v_add_u32 v42, 24, v6
    v_cmp_gt_u32 vcc, s50, v42
    v_add_u32 v42, 98304, v7
    s_nop 0
    v_cndmask_b32 v35, v43, v42, vcc
    v_rcp_f32 v2, v2
    v_rcp_f32 v4, v4
    s_branch L_epi_A
L_cold26:
    s_call_b64 s[30:31], L_qrem_1
    s_branch L_back26
L_pfb27:
    buffer_load_dwordx4 v48, s[12:15], s54 offen offset:0 nt lds
    buffer_load_dwordx4 v49, s[12:15], s54 offen offset:1024 nt lds
    buffer_load_dwordx4 v50, s[12:15], s54 offen offset:2048 nt lds
    buffer_load_dwordx4 v51, s[12:15], s54 offen offset:3072 nt lds
    s_branch L_pfe27
L_pfb28:
    buffer_load_dwordx4 v48, s[12:15], s54 offen offset:0 nt lds
    buffer_load_dwordx4 v49, s[12:15], s54 offen offset:1024 nt lds
    buffer_load_dwordx4 v50, s[12:15], s54 offen offset:2048 nt lds
    buffer_load_dwordx4 v51, s[12:15], s54 offen offset:3072 nt lds
    s_branch L_pfe28
L_tail_A_2:
    ds_read_b64_tr_b16 a[110:111], v59 offset:51200
    ds_read_b64_tr_b16 a[112:113], v56 offset:53248
    ds_read_b64_tr_b16 a[114:115], v56 offset:55296
    ds_read_b64_tr_b16 a[116:117], v57 offset:53248
    ds_read_b64_tr_b16 a[118:119], v57 offset:55296
    ds_read_b64_tr_b16 a[120:121], v58 offset:53248
    ds_read_b64_tr_b16 a[122:123], v58 offset:55296
    ds_read_b64_tr_b16 a[124:125], v59 offset:53248
    ds_read_b64_tr_b16 a[126:127], v59 offset:55296
    s_lshl_b32 s50, s5, 4
    s_max_i32 s50, s50, s46
    s_cmp_gt_i32 s50, 1
    s_cbranch_scc1 L_cold31
L_back31:
    v_exp_f32 v76, v76
    v_add_f32 v72, v72, v75
    v_cvt_pk_bf16_f32 v88, v74, v75
    v_fma_f32 v77, v115, s24, -v69
    v_exp_f32 v77, v77
    v_add_f32 v72, v72, v76
    v_fma_f32 v74, v116, s24, -v69
    v_exp_f32 v74, v74
    v_add_f32 v72, v72, v77
    v_cvt_pk_bf16_f32 v89, v76, v77
    s_waitcnt lgkmcnt(0)
    v_mfma_f32_32x32x16_bf16 v[128:143], a[96:99], v[80:83], v[128:143]
    s_barrier
    s_lshl_b32 s50, s28, 16
    s_bitcmp1_b32 s75, 10
    s_cselect_b32 s68, s50, 0
    s_cselect_b32 s50, s97, s96
    v_fma_f32 v75, v117, s24, -v69
    v_exp_f32 v75, v75
    v_mfma_f32_32x32x16_bf16 v[144:159], a[100:103], v[80:83], v[144:159]
    s_add_u32 s60, s50, 0
    s_add_u32 s64, s50, 32768
    s_add_u32 s61, s50, 8192
    s_add_u32 s65, s50, 40960
    v_add_f32 v72, v72, v74
    v_fma_f32 v76, v118, s24, -v69
    v_exp_f32 v76, v76
    v_mfma_f32_32x32x16_bf16 v[160:175], a[104:107], v[80:83], v[160:175]
    s_add_u32 s62, s50, 16384
    s_add_u32 s66, s50, 49152
    s_add_u32 s63, s50, 24576
    s_add_u32 s67, s50, 57344
    v_add_f32 v72, v72, v75
    v_cvt_pk_bf16_f32 v90, v74, v75
    v_fma_f32 v77, v119, s24, -v69
    v_mfma_f32_32x32x16_bf16 v[176:191], a[108:111], v[80:83], v[176:191]
    s_sub_u32 s54, s73, 0
    s_cmp_gt_i32 s74, 0
    s_cselect_b32 s54, s54, s26
    s_cselect_b32 m0, s60, s76
    s_bitcmp1_b32 s75, 10
    s_cbranch_scc1 L_pfb32
    buffer_load_dwordx4 v0, s[12:15], s54 offen offset:0 nt lds
    buffer_load_dwordx4 v1, s[12:15], s54 offen offset:1024 nt lds
L_pfe32:
    v_mfma_f32_32x32x16_bf16 v[128:143], a[112:115], v[84:87], v[128:143]
    v_exp_f32 v77, v77
    v_add_f32 v72, v72, v76
    v_fma_f32 v74, v120, s24, -v69
    v_exp_f32 v74, v74
    v_add_f32 v72, v72, v77
    v_cvt_pk_bf16_f32 v91, v76, v77
    v_mfma_f32_32x32x16_bf16 v[144:159], a[116:119], v[84:87], v[144:159]
    v_fma_f32 v75, v121, s24, -v69
    v_exp_f32 v75, v75
    v_add_f32 v72, v72, v74
    v_fma_f32 v76, v122, s24, -v69
    v_exp_f32 v76, v76
    v_add_f32 v72, v72, v75
    v_mfma_f32_32x32x16_bf16 v[160:175], a[120:123], v[84:87], v[160:175]
    s_sub_u32 s54, s73, 32768
    s_cmp_gt_i32 s74, 1
    s_cselect_b32 s54, s54, s26
    s_cselect_b32 m0, s61, s76
    s_bitcmp1_b32 s75, 10
    s_cbranch_scc1 L_pfb33
    buffer_load_dwordx4 v0, s[12:15], s54 offen offset:0 nt lds
    buffer_load_dwordx4 v1, s[12:15], s54 offen offset:1024 nt lds
L_pfe33:
    v_mfma_f32_32x32x16_bf16 v[176:191], a[124:127], v[84:87], v[176:191]
    v_cvt_pk_bf16_f32 v92, v74, v75
    v_fma_f32 v77, v123, s24, -v69
    v_exp_f32 v77, v77
    v_add_f32 v72, v72, v76
    v_fma_f32 v74, v124, s24, -v69
    v_exp_f32 v74, v74
    v_add_f32 v72, v72, v77
    v_cvt_pk_bf16_f32 v93, v76, v77
    v_fma_f32 v75, v125, s24, -v69
    v_exp_f32 v75, v75
    v_add_f32 v72, v72, v74
    v_fma_f32 v76, v126, s24, -v69
    v_exp_f32 v76, v76
    v_add_f32 v72, v72, v75
    v_cvt_pk_bf16_f32 v94, v74, v75
    v_fma_f32 v77, v127, s24, -v69
    v_exp_f32 v77, v77
    v_add_f32 v72, v72, v76
    s_nop 0
    v_add_f32 v72, v72, v77
    v_cvt_pk_bf16_f32 v95, v76, v77
    v_cmp_nge_f32 vcc, s25, v72
    s_nop 1
    s_cbranch_vccnz L_stub34
L_ret34:
    v_mfma_f32_32x32x16_bf16 v[192:207], a[96:99], v[88:91], v[192:207]
    v_mov_b32 v2, v70
    v_mov_b32 v3, v70
    v_mov_b32 v4, v72
    v_mov_b32 v5, v72
    s_and_b32 s50, s39, 63
    v_and_b32 v6, 31, v15
    v_mfma_f32_32x32x16_bf16 v[208:223], a[100:103], v[88:91], v[208:223]
    v_lshrrev_b32 v7, 5, v15
    v_lshlrev_b32 v36, 7, v6
    v_bfe_u32 v42, v15, 3, 1
    v_xor_b32 v7, v7, v42
    v_lshl_add_u32 v36, v7, 3, v36
    v_and_b32 v6, 7, v15
    v_mfma_f32_32x32x16_bf16 v[224:239], a[104:107], v[88:91], v[224:239]
    v_lshl_add_u32 v36, v6, 4, v36
    v_add_u32 v36, s78, v36
    v_permlane32_swap_b32 v2, v3
    v_permlane32_swap_b32 v4, v5
    v_lshrrev_b32 v6, 3, v15
    v_and_b32 v7, 7, v15
    v_mfma_f32_32x32x16_bf16 v[240:255], a[108:111], v[88:91], v[240:255]
    v_add_f32 v2, v2, v3
    v_add_f32 v4, v4, v5
    v_xor_b32 v37, v6, v7
    v_lshlrev_b32 v37, 4, v37
    v_lshl_add_u32 v37, v6, 7, v37
    v_add_u32 v37, s78, v37
    v_mfma_f32_32x32x16_bf16 v[192:207], a[112:115], v[92:95], v[192:207]
    v_lshlrev_b32 v7, 4, v7
    v_lshl_add_u32 v7, v6, 12, v7
    v_mov_b32 v43, s26
    v_add_u32 v42, 0, v6
    v_cmp_gt_u32 vcc, s50, v42
    v_add_u32 v42, 0, v7
    v_mfma_f32_32x32x16_bf16 v[208:223], a[116:119], v[92:95], v[208:223]
    s_nop 0
    v_cndmask_b32 v32, v43, v42, vcc
    v_add_u32 v42, 8, v6
    v_cmp_gt_u32 vcc, s50, v42
    v_add_u32 v42, 32768, v7
    s_nop 0
    v_mfma_f32_32x32x16_bf16 v[224:239], a[120:123], v[92:95], v[224:239]
    v_cndmask_b32 v33, v43, v42, vcc
    v_add_u32 v42, 16, v6
    v_cmp_gt_u32 vcc, s50, v42
    v_add_u32 v42, 65536, v7
    s_nop 0
    v_cndmask_b32 v34, v43, v42, vcc
    v_mfma_f32_32x32x16_bf16 v[240:255], a[124:127], v[92:95], v[240:255]
    v_add_u32 v42, 24, v6
    v_cmp_gt_u32 vcc, s50, v42
    v_add_u32 v42, 98304, v7
    s_nop 0
    v_cndmask_b32 v35, v43, v42, vcc
    v_rcp_f32 v2, v2
    v_rcp_f32 v4, v4
    s_branch L_epi_A
L_cold31:
    s_call_b64 s[30:31], L_qrem_2
    s_branch L_back31
L_pfb32:
    buffer_load_dwordx4 v48, s[12:15], s54 offen offset:0 nt lds
    buffer_load_dwordx4 v49, s[12:15], s54 offen offset:1024 nt lds
    buffer_load_dwordx4 v50, s[12:15], s54 offen offset:2048 nt lds
    buffer_load_dwordx4 v51, s[12:15], s54 offen offset:3072 nt lds
    s_branch L_pfe32
L_pfb33:
    buffer_load_dwordx4 v48, s[12:15], s54 offen offset:0 nt lds
    buffer_load_dwordx4 v49, s[12:15], s54 offen offset:1024 nt lds
    buffer_load_dwordx4 v50, s[12:15], s54 offen offset:2048 nt lds
    buffer_load_dwordx4 v51, s[12:15], s54 offen offset:3072 nt lds
    s_branch L_pfe33
L_tail_A_3:
    ds_read_b64_tr_b16 a[110:111], v59 offset:59392
    ds_read_b64_tr_b16 a[112:113], v56 offset:61440
    ds_read_b64_tr_b16 a[114:115], v56 offset:63488
    ds_read_b64_tr_b16 a[116:117], v57 offset:61440
    ds_read_b64_tr_b16 a[118:119], v57 offset:63488
    ds_read_b64_tr_b16 a[120:121], v58 offset:61440
    ds_read_b64_tr_b16 a[122:123], v58 offset:63488
    ds_read_b64_tr_b16 a[124:125], v59 offset:61440
    ds_read_b64_tr_b16 a[126:127], v59 offset:63488
    s_lshl_b32 s50, s5, 4
    s_max_i32 s50, s50, s46
    s_cmp_gt_i32 s50, 1
    s_cbranch_scc1 L_cold36
L_back36:
    v_exp_f32 v76, v76
    v_add_f32 v73, v73, v75
    v_cvt_pk_bf16_f32 v88, v74, v75
    v_fma_f32 v77, v115, s24, -v69
    v_exp_f32 v77, v77
    v_add_f32 v73, v73, v76
    v_fma_f32 v74, v116, s24, -v69
    v_exp_f32 v74, v74
    v_add_f32 v73, v73, v77
    v_cvt_pk_bf16_f32 v89, v76, v77
    s_waitcnt lgkmcnt(0)
    v_mfma_f32_32x32x16_bf16 v[128:143], a[96:99], v[80:83], v[128:143]
    s_barrier
    s_lshl_b32 s50, s28, 16
    s_bitcmp1_b32 s75, 10
    s_cselect_b32 s68, s50, 0
    s_cselect_b32 s50, s97, s96
    v_fma_f32 v75, v117, s24, -v69
    v_exp_f32 v75, v75
    v_mfma_f32_32x32x16_bf16 v[144:159], a[100:103], v[80:83], v[144:159]
    s_add_u32 s60, s50, 0
    s_add_u32 s64, s50, 32768
    s_add_u32 s61, s50, 8192
    s_add_u32 s65, s50, 40960
    v_add_f32 v73, v73, v74
    v_fma_f32 v76, v118, s24, -v69
    v_exp_f32 v76, v76
    v_mfma_f32_32x32x16_bf16 v[160:175], a[104:107], v[80:83], v[160:175]
    s_add_u32 s62, s50, 16384
    s_add_u32 s66, s50, 49152
    s_add_u32 s63, s50, 24576
    s_add_u32 s67, s50, 57344
    v_add_f32 v73, v73, v75
    v_cvt_pk_bf16_f32 v90, v74, v75
    v_fma_f32 v77, v119, s24, -v69
    v_mfma_f32_32x32x16_bf16 v[176:191], a[108:111], v[80:83], v[176:191]
    s_sub_u32 s54, s73, 0
    s_cmp_gt_i32 s74, 0
    s_cselect_b32 s54, s54, s26
    s_cselect_b32 m0, s60, s76
    s_bitcmp1_b32 s75, 10
    s_cbranch_scc1 L_pfb37
    buffer_load_dwordx4 v0, s[12:15], s54 offen offset:0 nt lds
    buffer_load_dwordx4 v1, s[12:15], s54 offen offset:1024 nt lds
L_pfe37:
    v_mfma_f32_32x32x16_bf16 v[128:143], a[112:115], v[84:87], v[128:143]
    v_exp_f32 v77, v77
    v_add_f32 v73, v73, v76
    v_fma_f32 v74, v120, s24, -v69
    v_exp_f32 v74, v74
    v_add_f32 v73, v73, v77
    v_cvt_pk_bf16_f32 v91, v76, v77
    v_mfma_f32_32x32x16_bf16 v[144:159], a[116:119], v[84:87], v[144:159]
    v_fma_f32 v75, v121, s24, -v69
    v_exp_f32 v75, v75
    v_add_f32 v73, v73, v74
    v_fma_f32 v76, v122, s24, -v69
    v_exp_f32 v76, v76
    v_add_f32 v73, v73, v75
    v_mfma_f32_32x32x16_bf16 v[160:175], a[120:123], v[84:87], v[160:175]
    s_sub_u32 s54, s73, 32768
    s_cmp_gt_i32 s74, 1
    s_cselect_b32 s54, s54, s26
    s_cselect_b32 m0, s61, s76
    s_bitcmp1_b32 s75, 10
    s_cbranch_scc1 L_pfb38
    buffer_load_dwordx4 v0, s[12:15], s54 offen offset:0 nt lds
    buffer_load_dwordx4 v1, s[12:15], s54 offen offset:1024 nt lds
L_pfe38:
    v_mfma_f32_32x32x16_bf16 v[176:191], a[124:127], v[84:87], v[176:191]
    v_cvt_pk_bf16_f32 v92, v74, v75
    v_fma_f32 v77, v123, s24, -v69
    v_exp_f32 v77, v77
    v_add_f32 v73, v73, v76
    v_fma_f32 v74, v124, s24, -v69
    v_exp_f32 v74, v74
    v_add_f32 v73, v73, v77
    v_cvt_pk_bf16_f32 v93, v76, v77
    v_fma_f32 v75, v125, s24, -v69
    v_exp_f32 v75, v75
    v_add_f32 v73, v73, v74
    v_fma_f32 v76, v126, s24, -v69
    v_exp_f32 v76, v76
    v_add_f32 v73, v73, v75
    v_cvt_pk_bf16_f32 v94, v74, v75
    v_fma_f32 v77, v127, s24, -v69
    v_exp_f32 v77, v77
    v_add_f32 v73, v73, v76
    s_nop 0
    v_add_f32 v73, v73, v77
    v_cvt_pk_bf16_f32 v95, v76, v77
    v_cmp_nge_f32 vcc, s25, v73
    s_nop 1
    s_cbranch_vccnz L_stub39
L_ret39:
    v_mfma_f32_32x32x16_bf16 v[192:207], a[96:99], v[88:91], v[192:207]
    v_mov_b32 v2, v71
    v_mov_b32 v3, v71
    v_mov_b32 v4, v73
    v_mov_b32 v5, v73
    s_and_b32 s50, s39, 63
    v_and_b32 v6, 31, v15
    v_mfma_f32_32x32x16_bf16 v[208:223], a[100:103], v[88:91], v[208:223]
    v_lshrrev_b32 v7, 5, v15
    v_lshlrev_b32 v36, 7, v6
    v_bfe_u32 v42, v15, 3, 1
    v_xor_b32 v7, v7, v42
    v_lshl_add_u32 v36, v7, 3, v36
    v_and_b32 v6, 7, v15
    v_mfma_f32_32x32x16_bf16 v[224:239], a[104:107], v[88:91], v[224:239]
    v_lshl_add_u32 v36, v6, 4, v36
    v_add_u32 v36, s78, v36
    v_permlane32_swap_b32 v2, v3
    v_permlane32_swap_b32 v4, v5
    v_lshrrev_b32 v6, 3, v15
    v_and_b32 v7, 7, v15
    v_mfma_f32_32x32x16_bf16 v[240:255], a[108:111], v[88:91], v[240:255]
    v_add_f32 v2, v2, v3
    v_add_f32 v4, v4, v5
    v_xor_b32 v37, v6, v7
    v_lshlrev_b32 v37, 4, v37
    v_lshl_add_u32 v37, v6, 7, v37
    v_add_u32 v37, s78, v37
    v_mfma_f32_32x32x16_bf16 v[192:207], a[112:115], v[92:95], v[192:207]
    v_lshlrev_b32 v7, 4, v7
    v_lshl_add_u32 v7, v6, 12, v7
    v_mov_b32 v43, s26
    v_add_u32 v42, 0, v6
    v_cmp_gt_u32 vcc, s50, v42
    v_add_u32 v42, 0, v7
    v_mfma_f32_32x32x16_bf16 v[208:223], a[116:119], v[92:95], v[208:223]
    s_nop 0
    v_cndmask_b32 v32, v43, v42, vcc
    v_add_u32 v42, 8, v6
    v_cmp_gt_u32 vcc, s50, v42
    v_add_u32 v42, 32768, v7
    s_nop 0
    v_mfma_f32_32x32x16_bf16 v[224:239], a[120:123], v[92:95], v[224:239]
    v_cndmask_b32 v33, v43, v42, vcc
    v_add_u32 v42, 16, v6
    v_cmp_gt_u32 vcc, s50, v42
    v_add_u32 v42, 65536, v7
    s_nop 0
    v_cndmask_b32 v34, v43, v42, vcc
    v_mfma_f32_32x32x16_bf16 v[240:255], a[124:127], v[92:95], v[240:255]
    v_add_u32 v42, 24, v6
    v_cmp_gt_u32 vcc, s50, v42
    v_add_u32 v42, 98304, v7
    s_nop 0
    v_cndmask_b32 v35, v43, v42, vcc
    v_rcp_f32 v2, v2
    v_rcp_f32 v4, v4
    s_branch L_epi_A
L_cold36:
    s_call_b64 s[30:31], L_qrem_3
    s_branch L_back36
L_pfb37:
    buffer_load_dwordx4 v48, s[12:15], s54 offen offset:0 nt lds
    buffer_load_dwordx4 v49, s[12:15], s54 offen offset:1024 nt lds
    buffer_load_dwordx4 v50, s[12:15], s54 offen offset:2048 nt lds
    buffer_load_dwordx4 v51, s[12:15], s54 offen offset:3072 nt lds
    s_branch L_pfe37
L_pfb38:
    buffer_load_dwordx4 v48, s[12:15], s54 offen offset:0 nt lds
    buffer_load_dwordx4 v49, s[12:15], s54 offen offset:1024 nt lds
    buffer_load_dwordx4 v50, s[12:15], s54 offen offset:2048 nt lds
    buffer_load_dwordx4 v51, s[12:15], s54 offen offset:3072 nt lds
    s_branch L_pfe38
L_epi_A:
    v_xor_b32 v88, 0, v36
    v_xor_b32 v89, 16, v36
    v_xor_b32 v90, 32, v36
    v_xor_b32 v91, 48, v36
    v_xor_b32 v92, 64, v36
    v_xor_b32 v93, 80, v36
    v_xor_b32 v94, 96, v36
    v_xor_b32 v95, 112, v36
    s_nop 0
    v_pk_mul_f32 v[80:81], v[128:129], v[2:3] op_sel_hi:[1,0]
    v_pk_mul_f32 v[82:83], v[130:131], v[2:3] op_sel_hi:[1,0]
    v_cvt_pk_bf16_f32 v96, v80, v81
    v_cvt_pk_bf16_f32 v97, v82, v83
    v_pk_mul_f32 v[84:85], v[132:133], v[2:3] op_sel_hi:[1,0]
    v_pk_mul_f32 v[86:87], v[134:135], v[2:3] op_sel_hi:[1,0]
    v_cvt_pk_bf16_f32 v98, v84, v85
    v_cvt_pk_bf16_f32 v99, v86, v87
    s_sub_u32 s54, s73, 0
    s_cmp_gt_i32 s74, 0
    s_cselect_b32 s54, s54, s26
    s_cselect_b32 m0, s64, s76
    s_bitcmp1_b32 s75, 10
    s_cbranch_scc1 L_pfb40
    buffer_load_dwordx4 v78, s[16:19], s54 offen offset:0 nt lds
    buffer_load_dwordx4 v79, s[16:19], s54 offen offset:1024 nt lds
L_pfe40:
    v_pk_mul_f32 v[80:81], v[136:137], v[2:3] op_sel_hi:[1,0]
    v_pk_mul_f32 v[82:83], v[138:139], v[2:3] op_sel_hi:[1,0]
    v_cvt_pk_bf16_f32 v100, v80, v81
    v_cvt_pk_bf16_f32 v101, v82, v83
    v_pk_mul_f32 v[84:85], v[140:141], v[2:3] op_sel_hi:[1,0]
    v_pk_mul_f32 v[86:87], v[142:143], v[2:3] op_sel_hi:[1,0]
    v_cvt_pk_bf16_f32 v102, v84, v85
    v_cvt_pk_bf16_f32 v103, v86, v87
    v_pk_mul_f32 v[80:81], v[144:145], v[2:3] op_sel_hi:[1,0]
    v_pk_mul_f32 v[82:83], v[146:147], v[2:3] op_sel_hi:[1,0]
    v_cvt_pk_bf16_f32 v104, v80, v81
    v_cvt_pk_bf16_f32 v105, v82, v83
    v_pk_mul_f32 v[84:85], v[148:149], v[2:3] op_sel_hi:[1,0]
    v_pk_mul_f32 v[86:87], v[150:151], v[2:3] op_sel_hi:[1,0]
    v_cvt_pk_bf16_f32 v106, v84, v85
    v_cvt_pk_bf16_f32 v107, v86, v87
    s_sub_u32 s54, s73, 65536
    s_cmp_gt_i32 s74, 2
    s_cselect_b32 s54, s54, s26
    s_cselect_b32 m0, s62, s76
    s_bitcmp1_b32 s75, 10
    s_cbranch_scc1 L_pfb41
    buffer_load_dwordx4 v0, s[12:15], s54 offen offset:0 nt lds
    buffer_load_dwordx4 v1, s[12:15], s54 offen offset:1024 nt lds
L_pfe41:
    v_pk_mul_f32 v[80:81], v[152:153], v[2:3] op_sel_hi:[1,0]
    v_pk_mul_f32 v[82:83], v[154:155], v[2:3] op_sel_hi:[1,0]
    v_cvt_pk_bf16_f32 v108, v80, v81
    v_cvt_pk_bf16_f32 v109, v82, v83
    v_pk_mul_f32 v[84:85], v[156:157], v[2:3] op_sel_hi:[1,0]
    v_pk_mul_f32 v[86:87], v[158:159], v[2:3] op_sel_hi:[1,0]
    v_cvt_pk_bf16_f32 v110, v84, v85
    v_cvt_pk_bf16_f32 v111, v86, v87
    ds_write_b64 v88, v[96:97] offset:0
    ds_write_b64 v89, v[98:99] offset:0
    ds_write_b64 v90, v[100:101] offset:0
    ds_write_b64 v91, v[102:103] offset:0
    ds_write_b64 v92, v[104:105] offset:0
    ds_write_b64 v93, v[106:107] offset:0
    ds_write_b64 v94, v[108:109] offset:0
    ds_write_b64 v95, v[110:111] offset:0
    v_pk_mul_f32 v[80:81], v[160:161], v[2:3] op_sel_hi:[1,0]
    v_pk_mul_f32 v[82:83], v[162:163], v[2:3] op_sel_hi:[1,0]
    v_cvt_pk_bf16_f32 v96, v80, v81
    v_cvt_pk_bf16_f32 v97, v82, v83
    v_pk_mul_f32 v[84:85], v[164:165], v[2:3] op_sel_hi:[1,0]
    v_pk_mul_f32 v[86:87], v[166:167], v[2:3] op_sel_hi:[1,0]
    v_cvt_pk_bf16_f32 v98, v84, v85
    v_cvt_pk_bf16_f32 v99, v86, v87
    s_sub_u32 s54, s73, 32768
    s_cmp_gt_i32 s74, 1
    s_cselect_b32 s54, s54, s26
    s_cselect_b32 m0, s65, s76
    s_bitcmp1_b32 s75, 10
    s_cbranch_scc1 L_pfb42
    buffer_load_dwordx4 v78, s[16:19], s54 offen offset:0 nt lds
    buffer_load_dwordx4 v79, s[16:19], s54 offen offset:1024 nt lds
L_pfe42:
    v_pk_mul_f32 v[80:81], v[168:169], v[2:3] op_sel_hi:[1,0]
    v_pk_mul_f32 v[82:83], v[170:171], v[2:3] op_sel_hi:[1,0]
    v_cvt_pk_bf16_f32 v100, v80, v81
    v_cvt_pk_bf16_f32 v101, v82, v83
    v_pk_mul_f32 v[84:85], v[172:173], v[2:3] op_sel_hi:[1,0]
    v_pk_mul_f32 v[86:87], v[174:175], v[2:3] op_sel_hi:[1,0]
    v_cvt_pk_bf16_f32 v102, v84, v85
    v_cvt_pk_bf16_f32 v103, v86, v87
    v_pk_mul_f32 v[80:81], v[176:177], v[2:3] op_sel_hi:[1,0]
    v_pk_mul_f32 v[82:83], v[178:179], v[2:3] op_sel_hi:[1,0]
    v_cvt_pk_bf16_f32 v104, v80, v81
    v_cvt_pk_bf16_f32 v105, v82, v83
    v_pk_mul_f32 v[84:85], v[180:181], v[2:3] op_sel_hi:[1,0]
    v_pk_mul_f32 v[86:87], v[182:183], v[2:3] op_sel_hi:[1,0]
    v_cvt_pk_bf16_f32 v106, v84, v85
    v_cvt_pk_bf16_f32 v107, v86, v87
    s_sub_u32 s54, s73, 98304
    s_cmp_gt_i32 s74, 3
    s_cselect_b32 s54, s54, s26
    s_cselect_b32 m0, s63, s76
    s_bitcmp1_b32 s75, 10
    s_cbranch_scc1 L_pfb43
    buffer_load_dwordx4 v0, s[12:15], s54 offen offset:0 nt lds
    buffer_load_dwordx4 v1, s[12:15], s54 offen offset:1024 nt lds
L_pfe43:
    v_pk_mul_f32 v[80:81], v[184:185], v[2:3] op_sel_hi:[1,0]
    v_pk_mul_f32 v[82:83], v[186:187], v[2:3] op_sel_hi:[1,0]
    v_cvt_pk_bf16_f32 v108, v80, v81
    v_cvt_pk_bf16_f32 v109, v82, v83
    v_pk_mul_f32 v[84:85], v[188:189], v[2:3] op_sel_hi:[1,0]
    v_pk_mul_f32 v[86:87], v[190:191], v[2:3] op_sel_hi:[1,0]
    v_cvt_pk_bf16_f32 v110, v84, v85
    v_cvt_pk_bf16_f32 v111, v86, v87
    ds_read_b128 v[112:115], v37 offset:0
    ds_read_b64 v[116:117], v37 offset:1032
    ds_read_b64 v[118:119], v37 offset:1024
    ds_read_b128 v[120:123], v37 offset:2048
    ds_read_b64 v[124:125], v37 offset:3080
    ds_read_b64 v[126:127], v37 offset:3072
    ds_write_b64 v88, v[96:97] offset:4096
    ds_write_b64 v89, v[98:99] offset:4096
    ds_write_b64 v90, v[100:101] offset:4096
    ds_write_b64 v91, v[102:103] offset:4096
    ds_write_b64 v92, v[104:105] offset:4096
    ds_write_b64 v93, v[106:107] offset:4096
    ds_write_b64 v94, v[108:109] offset:4096
    ds_write_b64 v95, v[110:111] offset:4096
    s_waitcnt lgkmcnt(8)
    v_pk_mul_f32 v[80:81], v[192:193], v[4:5] op_sel_hi:[1,0]
    v_pk_mul_f32 v[82:83], v[194:195], v[4:5] op_sel_hi:[1,0]
    v_cvt_pk_bf16_f32 v96, v80, v81
    v_cvt_pk_bf16_f32 v97, v82, v83
    buffer_store_dwordx4 v[112:115], v32, s[20:23], s40 offen offset:0 sc0 sc1
    v_pk_mul_f32 v[84:85], v[196:197], v[4:5] op_sel_hi:[1,0]
    v_pk_mul_f32 v[86:87], v[198:199], v[4:5] op_sel_hi:[1,0]
    v_cvt_pk_bf16_f32 v98, v84, v85
    v_cvt_pk_bf16_f32 v99, v86, v87
    v_pk_mul_f32 v[80:81], v[200:201], v[4:5] op_sel_hi:[1,0]
    v_pk_mul_f32 v[82:83], v[202:203], v[4:5] op_sel_hi:[1,0]
    v_cvt_pk_bf16_f32 v100, v80, v81
    v_cvt_pk_bf16_f32 v101, v82, v83
    buffer_store_dwordx4 v[116:119], v33, s[20:23], s40 offen offset:0 sc0 sc1
    v_pk_mul_f32 v[84:85], v[204:205], v[4:5] op_sel_hi:[1,0]
    v_pk_mul_f32 v[86:87], v[206:207], v[4:5] op_sel_hi:[1,0]
    v_cvt_pk_bf16_f32 v102, v84, v85
    v_cvt_pk_bf16_f32 v103, v86, v87
    v_pk_mul_f32 v[80:81], v[208:209], v[4:5] op_sel_hi:[1,0]
    v_pk_mul_f32 v[82:83], v[210:211], v[4:5] op_sel_hi:[1,0]
    v_cvt_pk_bf16_f32 v104, v80, v81
    v_cvt_pk_bf16_f32 v105, v82, v83
    buffer_store_dwordx4 v[120:123], v34, s[20:23], s40 offen offset:0 sc0 sc1
    v_pk_mul_f32 v[84:85], v[212:213], v[4:5] op_sel_hi:[1,0]
    v_pk_mul_f32 v[86:87], v[214:215], v[4:5] op_sel_hi:[1,0]
    v_cvt_pk_bf16_f32 v106, v84, v85
    v_cvt_pk_bf16_f32 v107, v86, v87
    v_pk_mul_f32 v[80:81], v[216:217], v[4:5] op_sel_hi:[1,0]
    v_pk_mul_f32 v[82:83], v[218:219], v[4:5] op_sel_hi:[1,0]
    v_cvt_pk_bf16_f32 v108, v80, v81
    v_cvt_pk_bf16_f32 v109, v82, v83
    buffer_store_dwordx4 v[124:127], v35, s[20:23], s40 offen offset:0 sc0 sc1
    v_pk_mul_f32 v[84:85], v[220:221], v[4:5] op_sel_hi:[1,0]
    v_pk_mul_f32 v[86:87], v[222:223], v[4:5] op_sel_hi:[1,0]
    v_cvt_pk_bf16_f32 v110, v84, v85
    v_cvt_pk_bf16_f32 v111, v86, v87
    ds_read_b128 v[112:115], v37 offset:4096
    ds_read_b64 v[116:117], v37 offset:5128
    ds_read_b64 v[118:119], v37 offset:5120
    ds_read_b128 v[120:123], v37 offset:6144
    ds_read_b64 v[124:125], v37 offset:7176
    ds_read_b64 v[126:127], v37 offset:7168
    ds_write_b64 v88, v[96:97] offset:0
    ds_write_b64 v89, v[98:99] offset:0
    ds_write_b64 v90, v[100:101] offset:0
    ds_write_b64 v91, v[102:103] offset:0
    ds_write_b64 v92, v[104:105] offset:0
    ds_write_b64 v93, v[106:107] offset:0
    ds_write_b64 v94, v[108:109] offset:0
    ds_write_b64 v95, v[110:111] offset:0
    s_waitcnt lgkmcnt(8)
    v_pk_mul_f32 v[80:81], v[224:225], v[4:5] op_sel_hi:[1,0]
    v_pk_mul_f32 v[82:83], v[226:227], v[4:5] op_sel_hi:[1,0]
    v_cvt_pk_bf16_f32 v96, v80, v81
    v_cvt_pk_bf16_f32 v97, v82, v83
    buffer_store_dwordx4 v[112:115], v32, s[20:23], s40 offen offset:128 sc0 sc1
    v_pk_mul_f32 v[84:85], v[228:229], v[4:5] op_sel_hi:[1,0]
    v_pk_mul_f32 v[86:87], v[230:231], v[4:5] op_sel_hi:[1,0]
    v_cvt_pk_bf16_f32 v98, v84, v85
    v_cvt_pk_bf16_f32 v99, v86, v87
    v_pk_mul_f32 v[80:81], v[232:233], v[4:5] op_sel_hi:[1,0]
    v_pk_mul_f32 v[82:83], v[234:235], v[4:5] op_sel_hi:[1,0]
    v_cvt_pk_bf16_f32 v100, v80, v81
    v_cvt_pk_bf16_f32 v101, v82, v83
    buffer_store_dwordx4 v[116:119], v33, s[20:23], s40 offen offset:128 sc0 sc1
    v_pk_mul_f32 v[84:85], v[236:237], v[4:5] op_sel_hi:[1,0]
    v_pk_mul_f32 v[86:87], v[238:239], v[4:5] op_sel_hi:[1,0]
    v_cvt_pk_bf16_f32 v102, v84, v85
    v_cvt_pk_bf16_f32 v103, v86, v87
    v_pk_mul_f32 v[80:81], v[240:241], v[4:5] op_sel_hi:[1,0]
    v_pk_mul_f32 v[82:83], v[242:243], v[4:5] op_sel_hi:[1,0]
    v_cvt_pk_bf16_f32 v104, v80, v81
    v_cvt_pk_bf16_f32 v105, v82, v83
    buffer_store_dwordx4 v[120:123], v34, s[20:23], s40 offen offset:128 sc0 sc1
    v_pk_mul_f32 v[84:85], v[244:245], v[4:5] op_sel_hi:[1,0]
    v_pk_mul_f32 v[86:87], v[246:247], v[4:5] op_sel_hi:[1,0]
    v_cvt_pk_bf16_f32 v106, v84, v85
    v_cvt_pk_bf16_f32 v107, v86, v87
    v_pk_mul_f32 v[80:81], v[248:249], v[4:5] op_sel_hi:[1,0]
    v_pk_mul_f32 v[82:83], v[250:251], v[4:5] op_sel_hi:[1,0]
    v_cvt_pk_bf16_f32 v108, v80, v81
    v_cvt_pk_bf16_f32 v109, v82, v83
    buffer_store_dwordx4 v[124:127], v35, s[20:23], s40 offen offset:128 sc0 sc1
    v_pk_mul_f32 v[84:85], v[252:253], v[4:5] op_sel_hi:[1,0]
    v_pk_mul_f32 v[86:87], v[254:255], v[4:5] op_sel_hi:[1,0]
    v_cvt_pk_bf16_f32 v110, v84, v85
    v_cvt_pk_bf16_f32 v111, v86, v87
    ds_read_b128 v[112:115], v37 offset:0
    ds_read_b64 v[116:117], v37 offset:1032
    ds_read_b64 v[118:119], v37 offset:1024
    ds_read_b128 v[120:123], v37 offset:2048
    ds_read_b64 v[124:125], v37 offset:3080
    ds_read_b64 v[126:127], v37 offset:3072
    ds_write_b64 v88, v[96:97] offset:4096
    ds_write_b64 v89, v[98:99] offset:4096
    ds_write_b64 v90, v[100:101] offset:4096
    ds_write_b64 v91, v[102:103] offset:4096
    ds_write_b64 v92, v[104:105] offset:4096
    ds_write_b64 v93, v[106:107] offset:4096
    ds_write_b64 v94, v[108:109] offset:4096
    ds_write_b64 v95, v[110:111] offset:4096
    s_waitcnt lgkmcnt(8)
    buffer_store_dwordx4 v[112:115], v32, s[20:23], s40 offen offset:256 sc0 sc1
    buffer_store_dwordx4 v[116:119], v33, s[20:23], s40 offen offset:256 sc0 sc1
    buffer_store_dwordx4 v[120:123], v34, s[20:23], s40 offen offset:256 sc0 sc1
    buffer_store_dwordx4 v[124:127], v35, s[20:23], s40 offen offset:256 sc0 sc1
    ds_read_b128 v[112:115], v37 offset:4096
    ds_read_b64 v[116:117], v37 offset:5128
    ds_read_b64 v[118:119], v37 offset:5120
    ds_read_b128 v[120:123], v37 offset:6144
    ds_read_b64 v[124:125], v37 offset:7176
    ds_read_b64 v[126:127], v37 offset:7168
    s_waitcnt lgkmcnt(0)
    buffer_store_dwordx4 v[112:115], v32, s[20:23], s40 offen offset:384 sc0 sc1
    buffer_store_dwordx4 v[116:119], v33, s[20:23], s40 offen offset:384 sc0 sc1
    buffer_store_dwordx4 v[120:123], v34, s[20:23], s40 offen offset:384 sc0 sc1
    buffer_store_dwordx4 v[124:127], v35, s[20:23], s40 offen offset:384 sc0 sc1
    s_mov_b32 s4, 0
    s_branch L_job
L_pfb40:
    buffer_load_dwordx4 v52, s[16:19], s54 offen offset:0 nt lds
    buffer_load_dwordx4 v53, s[16:19], s54 offen offset:1024 nt lds
    buffer_load_dwordx4 v54, s[16:19], s54 offen offset:2048 nt lds
    buffer_load_dwordx4 v55, s[16:19], s54 offen offset:3072 nt lds
    s_branch L_pfe40
L_pfb41:
    buffer_load_dwordx4 v48, s[12:15], s54 offen offset:0 nt lds
    buffer_load_dwordx4 v49, s[12:15], s54 offen offset:1024 nt lds
    buffer_load_dwordx4 v50, s[12:15], s54 offen offset:2048 nt lds
    buffer_load_dwordx4 v51, s[12:15], s54 offen offset:3072 nt lds
    s_branch L_pfe41
L_pfb42:
    buffer_load_dwordx4 v52, s[16:19], s54 offen offset:0 nt lds
    buffer_load_dwordx4 v53, s[16:19], s54 offen offset:1024 nt lds
    buffer_load_dwordx4 v54, s[16:19], s54 offen offset:2048 nt lds
    buffer_load_dwordx4 v55, s[16:19], s54 offen offset:3072 nt lds
    s_branch L_pfe42
L_pfb43:
    buffer_load_dwordx4 v48, s[12:15], s54 offen offset:0 nt lds
    buffer_load_dwordx4 v49, s[12:15], s54 offen offset:1024 nt lds
    buffer_load_dwordx4 v50, s[12:15], s54 offen offset:2048 nt lds
    buffer_load_dwordx4 v51, s[12:15], s54 offen offset:3072 nt lds
    s_branch L_pfe43
L_pfb45:
    buffer_load_dwordx4 v48, s[12:15], s54 offen offset:0 nt lds
    buffer_load_dwordx4 v49, s[12:15], s54 offen offset:1024 nt lds
    buffer_load_dwordx4 v50, s[12:15], s54 offen offset:2048 nt lds
    buffer_load_dwordx4 v51, s[12:15], s54 offen offset:3072 nt lds
    s_branch L_pfe45
L_pfb46:
    buffer_load_dwordx4 v52, s[16:19], s54 offen offset:0 nt lds
    buffer_load_dwordx4 v53, s[16:19], s54 offen offset:1024 nt lds
    buffer_load_dwordx4 v54, s[16:19], s54 offen offset:2048 nt lds
    buffer_load_dwordx4 v55, s[16:19], s54 offen offset:3072 nt lds
    s_branch L_pfe46
L_pfb47:
    buffer_load_dwordx4 v48, s[12:15], s54 offen offset:0 nt lds
    buffer_load_dwordx4 v49, s[12:15], s54 offen offset:1024 nt lds
    buffer_load_dwordx4 v50, s[12:15], s54 offen offset:2048 nt lds
    buffer_load_dwordx4 v51, s[12:15], s54 offen offset:3072 nt lds
    s_branch L_pfe47
L_hb44:
    s_sub_u32 s54, s37, 65536
    s_cmp_gt_i32 s38, 2
    s_cselect_b32 s54, s54, s26
    s_cselect_b32 m0, s62, s76
    s_bitcmp1_b32 s39, 10
    s_cbranch_scc1 L_pfb45
    buffer_load_dwordx4 v0, s[12:15], s54 offen offset:0 nt lds
    buffer_load_dwordx4 v1, s[12:15], s54 offen offset:1024 nt lds
L_pfe45:
    s_sub_u32 s54, s37, 32768
    s_cmp_gt_i32 s38, 1
    s_cselect_b32 s54, s54, s26
    s_cselect_b32 m0, s65, s76
    s_bitcmp1_b32 s39, 10
    s_cbranch_scc1 L_pfb46
    buffer_load_dwordx4 v78, s[16:19], s54 offen offset:0 nt lds
    buffer_load_dwordx4 v79, s[16:19], s54 offen offset:1024 nt lds
L_pfe46:
    s_sub_u32 s54, s37, 98304
    s_cmp_gt_i32 s38, 3
    s_cselect_b32 s54, s54, s26
    s_cselect_b32 m0, s63, s76
    s_bitcmp1_b32 s39, 10
    s_cbranch_scc1 L_pfb47
    buffer_load_dwordx4 v0, s[12:15], s54 offen offset:0 nt lds
    buffer_load_dwordx4 v1, s[12:15], s54 offen offset:1024 nt lds
L_pfe47:
    s_mov_b32 m0, s76
    s_mov_b32 s49, s26
    buffer_load_dwordx4 v8, s[8:11], s49 offen nt lds
    buffer_load_dwordx4 v8, s[8:11], s49 offen nt lds
    buffer_load_dwordx4 v8, s[8:11], s49 offen nt lds
    buffer_load_dwordx4 v8, s[8:11], s49 offen nt lds
    buffer_load_dwordx4 v8, s[8:11], s49 offen nt lds
    s_mov_b32 s3, 0
    s_waitcnt vmcnt(21)
    s_branch L_hc44
L_pfb49:
    buffer_load_dwordx4 v48, s[12:15], s54 offen offset:0 nt lds
    buffer_load_dwordx4 v49, s[12:15], s54 offen offset:1024 nt lds
    buffer_load_dwordx4 v50, s[12:15], s54 offen offset:2048 nt lds
    buffer_load_dwordx4 v51, s[12:15], s54 offen offset:3072 nt lds
    s_branch L_pfe49
L_pfb50:
    buffer_load_dwordx4 v52, s[16:19], s54 offen offset:0 nt lds
    buffer_load_dwordx4 v53, s[16:19], s54 offen offset:1024 nt lds
    buffer_load_dwordx4 v54, s[16:19], s54 offen offset:2048 nt lds
    buffer_load_dwordx4 v55, s[16:19], s54 offen offset:3072 nt lds
    s_branch L_pfe50
L_pfb51:
    buffer_load_dwordx4 v48, s[12:15], s54 offen offset:0 nt lds
    buffer_load_dwordx4 v49, s[12:15], s54 offen offset:1024 nt lds
    buffer_load_dwordx4 v50, s[12:15], s54 offen offset:2048 nt lds
    buffer_load_dwordx4 v51, s[12:15], s54 offen offset:3072 nt lds
    s_branch L_pfe51
L_hb48:
    s_sub_u32 s54, s37, 65536
    s_cmp_gt_i32 s38, 2
    s_cselect_b32 s54, s54, s26
    s_cselect_b32 m0, s62, s76
    s_bitcmp1_b32 s39, 10
    s_cbranch_scc1 L_pfb49
    buffer_load_dwordx4 v0, s[12:15], s54 offen offset:0 nt lds
    buffer_load_dwordx4 v1, s[12:15], s54 offen offset:1024 nt lds
L_pfe49:
    s_sub_u32 s54, s37, 32768
    s_cmp_gt_i32 s38, 1
    s_cselect_b32 s54, s54, s26
    s_cselect_b32 m0, s65, s76
    s_bitcmp1_b32 s39, 10
    s_cbranch_scc1 L_pfb50
    buffer_load_dwordx4 v78, s[16:19], s54 offen offset:0 nt lds
    buffer_load_dwordx4 v79, s[16:19], s54 offen offset:1024 nt lds
L_pfe50:
    s_sub_u32 s54, s37, 98304
    s_cmp_gt_i32 s38, 3
    s_cselect_b32 s54, s54, s26
    s_cselect_b32 m0, s63, s76
    s_bitcmp1_b32 s39, 10
    s_cbranch_scc1 L_pfb51
    buffer_load_dwordx4 v0, s[12:15], s54 offen offset:0 nt lds
    buffer_load_dwordx4 v1, s[12:15], s54 offen offset:1024 nt lds
L_pfe51:
    s_mov_b32 m0, s76
    s_mov_b32 s49, s26
    buffer_load_dwordx4 v8, s[8:11], s49 offen nt lds
    buffer_load_dwordx4 v8, s[8:11], s49 offen nt lds
    buffer_load_dwordx4 v8, s[8:11], s49 offen nt lds
    buffer_load_dwordx4 v8, s[8:11], s49 offen nt lds
    buffer_load_dwordx4 v8, s[8:11], s49 offen nt lds
    s_mov_b32 s3, 0
    s_waitcnt vmcnt(21)
    s_branch L_hc48
L_pre_B:
    s_bitcmp1_b32 s39, 9
    s_cbranch_scc0 L_head_B_0
L_idle_B:
    s_sub_u32 s46, s46, 1
    s_cmp_eq_u32 s46, 8
    s_cselect_b32 s69, s70, 0
    s_cselect_b32 s48, s71, s48
    s_add_u32 s47, s47, s69
    s_cmp_gt_i32 s42, 0
    s_cselect_b32 s44, s41, s26
    s_cselect_b32 m0, s66, s76
    s_sub_u32 s45, s41, 0x10000
    s_sub_u32 s41, s41, 0x8000
    buffer_load_dwordx4 v52, s[16:19], s44 offen offset:0 lds
    buffer_load_dwordx4 v53, s[16:19], s44 offen offset:1024 lds
    buffer_load_dwordx4 v54, s[16:19], s44 offen offset:2048 lds
    buffer_load_dwordx4 v55, s[16:19], s44 offen offset:3072 lds
    s_cmp_lg_u32 s3, 0
    s_cbranch_scc1 L_hb44
    s_waitcnt vmcnt(16)
L_hc44:
    s_barrier
    s_cmp_gt_i32 s42, 2
    s_cselect_b32 s43, s45, s26
    s_cselect_b32 m0, s60, s76
    s_sub_u32 s42, s42, 1
    buffer_load_dwordx4 v48, s[12:15], s43 offen offset:0 lds
    buffer_load_dwordx4 v49, s[12:15], s43 offen offset:1024 lds
    buffer_load_dwordx4 v50, s[12:15], s43 offen offset:2048 lds
    buffer_load_dwordx4 v51, s[12:15], s43 offen offset:3072 lds
    s_mov_b32 m0, s76
    s_mov_b32 s49, s26
    s_add_u32 s46, s46, 1
    buffer_load_dwordx4 v8, s[8:11], s49 offen nt lds
L_head_B_1:
    ds_read_b128 a[64:67], v60 offset:8192
    ds_read_b128 a[68:71], v61 offset:8192
    ds_read_b128 a[72:75], v62 offset:8192
    ds_read_b128 a[76:79], v63 offset:8192
    ds_read_b128 a[80:83], v64 offset:8192
    ds_read_b128 a[84:87], v65 offset:8192
    ds_read_b128 a[88:91], v66 offset:8192
    ds_read_b128 a[92:95], v67 offset:8192
    v_mfma_f32_32x32x16_bf16 v[128:143], a[128:131], a[128:131], 0
    s_sub_u32 s46, s46, 1
    s_cmp_eq_u32 s46, 8
    s_cselect_b32 s69, s70, 0
    s_cselect_b32 s48, s71, s48
    s_add_u32 s47, s47, s69
    s_cmp_gt_i32 s42, 0
    s_cselect_b32 s44, s41, s26
    s_cselect_b32 m0, s67, s76
    s_sub_u32 s45, s41, 0x10000
    s_sub_u32 s41, s41, 0x8000
    buffer_load_dwordx4 v52, s[16:19], s44 offen offset:0 lds
    buffer_load_dwordx4 v53, s[16:19], s44 offen offset:1024 lds
    buffer_load_dwordx4 v54, s[16:19], s44 offen offset:2048 lds
    buffer_load_dwordx4 v55, s[16:19], s44 offen offset:3072 lds
    v_mfma_f32_32x32x16_bf16 v[144:159], a[128:131], a[128:131], 0
    v_mov_b32 v70, 0
    v_mov_b32 v72, 0
    s_waitcnt lgkmcnt(0)
    v_mfma_f32_32x32x16_bf16 v[96:111], a[64:67], a[0:3], v[32:47]
    v_mfma_f32_32x32x16_bf16 v[96:111], a[68:71], a[4:7], v[96:111]
    v_mfma_f32_32x32x16_bf16 v[96:111], a[72:75], a[8:11], v[96:111]
    v_mfma_f32_32x32x16_bf16 v[96:111], a[76:79], a[12:15], v[96:111]
    v_mfma_f32_32x32x16_bf16 v[96:111], a[80:83], a[16:19], v[96:111]
    v_mfma_f32_32x32x16_bf16 v[96:111], a[84:87], a[20:23], v[96:111]
    v_mfma_f32_32x32x16_bf16 v[96:111], a[88:91], a[24:27], v[96:111]
    v_mfma_f32_32x32x16_bf16 v[96:111], a[92:95], a[28:31], v[96:111]
    v_mfma_f32_32x32x16_bf16 v[160:175], a[128:131], a[128:131], 0
    s_nop 5
    v_mfma_f32_32x32x16_bf16 v[176:191], a[128:131], a[128:131], 0
    s_nop 4
    v_max3_f32 v2, v96, v97, v98
    v_mfma_f32_32x32x16_bf16 v[192:207], a[128:131], a[128:131], 0
    v_max3_f32 v3, v99, v100, v101
    v_max3_f32 v2, v2, v102, v103
    v_max3_f32 v3, v3, v104, v105
    v_max3_f32 v2, v2, v106, v107
    v_max3_f32 v3, v3, v108, v109
    v_max3_f32 v2, v2, v110, v111
    v_mfma_f32_32x32x16_bf16 v[112:127], a[64:67], a[32:35], v[32:47]
    v_max_f32 v2, v2, v3
    v_mov_b32 v3, v2
    s_nop 1
    v_permlane32_swap_b32 v2, v3
    v_max_f32 v2, v2, v3
    v_mfma_f32_32x32x16_bf16 v[112:127], a[68:71], a[36:39], v[112:127]
    v_mul_f32 v68, s24, v2
    s_nop 0
    v_fma_f32 v74, v96, s24, -v68
    v_exp_f32 v74, v74
    v_fma_f32 v75, v97, s24, -v68
    v_mfma_f32_32x32x16_bf16 v[112:127], a[72:75], a[40:43], v[112:127]
    v_exp_f32 v75, v75
    v_add_f32 v71, v70, v74
    v_fma_f32 v76, v98, s24, -v68
    v_exp_f32 v76, v76
    v_mfma_f32_32x32x16_bf16 v[112:127], a[76:79], a[44:47], v[112:127]
    v_add_f32 v71, v71, v75
    v_cvt_pk_bf16_f32 v80, v74, v75
    v_fma_f32 v77, v99, s24, -v68
    v_exp_f32 v77, v77
    v_add_f32 v71, v71, v76
    v_mfma_f32_32x32x16_bf16 v[112:127], a[80:83], a[48:51], v[112:127]
    v_fma_f32 v74, v100, s24, -v68
    v_exp_f32 v74, v74
    v_add_f32 v71, v71, v77
    v_cvt_pk_bf16_f32 v81, v76, v77
    v_fma_f32 v75, v101, s24, -v68
    v_mfma_f32_32x32x16_bf16 v[112:127], a[84:87], a[52:55], v[112:127]
    v_exp_f32 v75, v75
    v_add_f32 v71, v71, v74
    v_fma_f32 v76, v102, s24, -v68
    v_exp_f32 v76, v76
    v_mfma_f32_32x32x16_bf16 v[112:127], a[88:91], a[56:59], v[112:127]
    v_add_f32 v71, v71, v75
    v_cvt_pk_bf16_f32 v82, v74, v75
    v_fma_f32 v77, v103, s24, -v68
    v_exp_f32 v77, v77
    v_add_f32 v71, v71, v76
    v_mfma_f32_32x32x16_bf16 v[112:127], a[92:95], a[60:63], v[112:127]
    v_fma_f32 v74, v104, s24, -v68
    v_exp_f32 v74, v74
    v_add_f32 v71, v71, v77
    v_cvt_pk_bf16_f32 v83, v76, v77
    v_fma_f32 v75, v105, s24, -v68
    s_waitcnt vmcnt(17)
    s_barrier
    v_mfma_f32_32x32x16_bf16 v[208:223], a[128:131], a[128:131], 0
    ds_read_b128 a[64:67], v60 offset:16384
    ds_read_b128 a[68:71], v61 offset:16384
    ds_read_b128 a[72:75], v62 offset:16384
    ds_read_b128 a[76:79], v63 offset:16384
    ds_read_b128 a[80:83], v64 offset:16384
    ds_read_b128 a[84:87], v65 offset:16384
    v_exp_f32 v75, v75
    v_add_f32 v71, v71, v74
    v_mfma_f32_32x32x16_bf16 v[224:239], a[128:131], a[128:131], 0
    ds_read_b128 a[88:91], v66 offset:16384
    ds_read_b128 a[92:95], v67 offset:16384
    s_cmp_gt_i32 s42, 2
    s_cselect_b32 s43, s45, s26
    s_cselect_b32 m0, s61, s76
    s_sub_u32 s42, s42, 1
    buffer_load_dwordx4 v48, s[12:15], s43 offen offset:0 lds
    buffer_load_dwordx4 v49, s[12:15], s43 offen offset:1024 lds
    buffer_load_dwordx4 v50, s[12:15], s43 offen offset:2048 lds
    buffer_load_dwordx4 v51, s[12:15], s43 offen offset:3072 lds
    s_cmp_gt_i32 s46, 0
    s_cselect_b32 s49, s47, s26
    s_cselect_b32 m0, s48, s76
    s_add_u32 s47, s47, 0x4000
    buffer_load_dwordx4 v8, s[8:11], s49 offen nt lds
    s_add_u32 s48, s48, 0x400
    ds_read_b64_tr_b16 a[96:97], v56 offset:40960
    ds_read_b64_tr_b16 a[98:99], v56 offset:43008
    ds_read_b64_tr_b16 a[100:101], v57 offset:40960
    ds_read_b64_tr_b16 a[102:103], v57 offset:43008
    v_mfma_f32_32x32x16_bf16 v[240:255], a[128:131], a[128:131], 0
    ds_read_b64_tr_b16 a[104:105], v58 offset:40960
    ds_read_b64_tr_b16 a[106:107], v58 offset:43008
    ds_read_b64_tr_b16 a[108:109], v59 offset:40960
    ds_read_b64_tr_b16 a[110:111], v59 offset:43008
    ds_read_b64_tr_b16 a[112:113], v56 offset:45056
    ds_read_b64_tr_b16 a[114:115], v56 offset:47104
    ds_read_b64_tr_b16 a[116:117], v57 offset:45056
    ds_read_b64_tr_b16 a[118:119], v57 offset:47104
    ds_read_b64_tr_b16 a[120:121], v58 offset:45056
    ds_read_b64_tr_b16 a[122:123], v58 offset:47104
    ds_read_b64_tr_b16 a[124:125], v59 offset:45056
    ds_read_b64_tr_b16 a[126:127], v59 offset:47104
    v_fma_f32 v76, v106, s24, -v68
    v_exp_f32 v76, v76
    v_add_f32 v71, v71, v75
    v_cvt_pk_bf16_f32 v84, v74, v75
    v_max3_f32 v4, v112, v113, v114
    v_max3_f32 v5, v115, v116, v117
    v_max3_f32 v4, v4, v118, v119
    v_max3_f32 v5, v5, v120, v121
    v_max3_f32 v4, v4, v122, v123
    v_max3_f32 v5, v5, v124, v125
    v_max3_f32 v4, v4, v126, v127
    v_max_f32 v4, v4, v5
    v_mov_b32 v5, v4
    s_nop 1
    v_permlane32_swap_b32 v4, v5
    v_max_f32 v4, v4, v5
    v_mul_f32 v69, s24, v4
    v_fma_f32 v77, v107, s24, -v68
    v_exp_f32 v77, v77
    v_add_f32 v71, v71, v76
    v_fma_f32 v74, v108, s24, -v68
    v_exp_f32 v74, v74
    v_add_f32 v71, v71, v77
    v_cvt_pk_bf16_f32 v85, v76, v77
    v_fma_f32 v75, v109, s24, -v68
    v_exp_f32 v75, v75
    v_add_f32 v71, v71, v74
    v_fma_f32 v76, v110, s24, -v68
    v_exp_f32 v76, v76
    v_add_f32 v71, v71, v75
    v_cvt_pk_bf16_f32 v86, v74, v75
    v_fma_f32 v77, v111, s24, -v68
    v_exp_f32 v77, v77
    v_add_f32 v71, v71, v76
    v_fma_f32 v74, v112, s24, -v69
    v_exp_f32 v74, v74
    v_add_f32 v71, v71, v77
    v_cvt_pk_bf16_f32 v87, v76, v77
    v_fma_f32 v75, v113, s24, -v69
    v_exp_f32 v75, v75
    v_add_f32 v73, v72, v74
    v_fma_f32 v76, v114, s24, -v69
    s_waitcnt lgkmcnt(0)
    s_cmp_ge_i32 s42, -1
    s_cbranch_scc0 L_tail_B_1
    s_branch L_loop_B_1
L_head_B_0:
    ds_read_b128 a[64:67], v60 offset:0
    ds_read_b128 a[68:71], v61 offset:0
    ds_read_b128 a[72:75], v62 offset:0
    ds_read_b128 a[76:79], v63 offset:0
    ds_read_b128 a[80:83], v64 offset:0
    ds_read_b128 a[84:87], v65 offset:0
    ds_read_b128 a[88:91], v66 offset:0
    ds_read_b128 a[92:95], v67 offset:0
    v_mfma_f32_32x32x16_bf16 v[128:143], a[128:131], a[128:131], 0
    s_sub_u32 s46, s46, 1
    s_cmp_eq_u32 s46, 8
    s_cselect_b32 s69, s70, 0
    s_cselect_b32 s48, s71, s48
    s_add_u32 s47, s47, s69
    s_cmp_gt_i32 s42, 0
    s_cselect_b32 s44, s41, s26
    s_cselect_b32 m0, s66, s76
    s_sub_u32 s45, s41, 0x10000
    s_sub_u32 s41, s41, 0x8000
    buffer_load_dwordx4 v52, s[16:19], s44 offen offset:0 lds
    buffer_load_dwordx4 v53, s[16:19], s44 offen offset:1024 lds
    buffer_load_dwordx4 v54, s[16:19], s44 offen offset:2048 lds
    buffer_load_dwordx4 v55, s[16:19], s44 offen offset:3072 lds
    v_mfma_f32_32x32x16_bf16 v[144:159], a[128:131], a[128:131], 0
    v_mov_b32 v71, 0
    v_mov_b32 v73, 0
    s_waitcnt lgkmcnt(0)
    v_mfma_f32_32x32x16_bf16 v[96:111], a[64:67], a[0:3], v[32:47]
    v_mfma_f32_32x32x16_bf16 v[96:111], a[68:71], a[4:7], v[96:111]
    v_mfma_f32_32x32x16_bf16 v[96:111], a[72:75], a[8:11], v[96:111]
    v_mfma_f32_32x32x16_bf16 v[96:111], a[76:79], a[12:15], v[96:111]
    v_mfma_f32_32x32x16_bf16 v[96:111], a[80:83], a[16:19], v[96:111]
    v_mfma_f32_32x32x16_bf16 v[96:111], a[84:87], a[20:23], v[96:111]
    v_mfma_f32_32x32x16_bf16 v[96:111], a[88:91], a[24:27], v[96:111]
    v_mfma_f32_32x32x16_bf16 v[96:111], a[92:95], a[28:31], v[96:111]
    v_mfma_f32_32x32x16_bf16 v[160:175], a[128:131], a[128:131], 0
    s_nop 5
    v_mfma_f32_32x32x16_bf16 v[176:191], a[128:131], a[128:131], 0
    s_nop 4
    v_max3_f32 v2, v96, v97, v98
    v_mfma_f32_32x32x16_bf16 v[192:207], a[128:131], a[128:131], 0
    v_max3_f32 v3, v99, v100, v101
    v_max3_f32 v2, v2, v102, v103
    v_max3_f32 v3, v3, v104, v105
    v_max3_f32 v2, v2, v106, v107
    v_max3_f32 v3, v3, v108, v109
    v_max3_f32 v2, v2, v110, v111
    v_mfma_f32_32x32x16_bf16 v[112:127], a[64:67], a[32:35], v[32:47]
    v_max_f32 v2, v2, v3
    v_mov_b32 v3, v2
    s_nop 1
    v_permlane32_swap_b32 v2, v3
    v_max_f32 v2, v2, v3
    v_mfma_f32_32x32x16_bf16 v[112:127], a[68:71], a[36:39], v[112:127]
    v_mul_f32 v68, s24, v2
    s_nop 0
    v_fma_f32 v74, v96, s24, -v68
    v_exp_f32 v74, v74
    v_fma_f32 v75, v97, s24, -v68
    v_mfma_f32_32x32x16_bf16 v[112:127], a[72:75], a[40:43], v[112:127]
    v_exp_f32 v75, v75
    v_add_f32 v70, v71, v74
    v_fma_f32 v76, v98, s24, -v68
    v_exp_f32 v76, v76
    v_mfma_f32_32x32x16_bf16 v[112:127], a[76:79], a[44:47], v[112:127]
    v_add_f32 v70, v70, v75
    v_cvt_pk_bf16_f32 v80, v74, v75
    v_fma_f32 v77, v99, s24, -v68
    v_exp_f32 v77, v77
    v_add_f32 v70, v70, v76
    v_mfma_f32_32x32x16_bf16 v[112:127], a[80:83], a[48:51], v[112:127]
    v_fma_f32 v74, v100, s24, -v68
    v_exp_f32 v74, v74
    v_add_f32 v70, v70, v77
    v_cvt_pk_bf16_f32 v81, v76, v77
    v_fma_f32 v75, v101, s24, -v68
    v_mfma_f32_32x32x16_bf16 v[112:127], a[84:87], a[52:55], v[112:127]
    v_exp_f32 v75, v75
    v_add_f32 v70, v70, v74
    v_fma_f32 v76, v102, s24, -v68
    v_exp_f32 v76, v76
    v_mfma_f32_32x32x16_bf16 v[112:127], a[88:91], a[56:59], v[112:127]
    v_add_f32 v70, v70, v75
    v_cvt_pk_bf16_f32 v82, v74, v75
    v_fma_f32 v77, v103, s24, -v68
    v_exp_f32 v77, v77
    v_add_f32 v70, v70, v76
    v_mfma_f32_32x32x16_bf16 v[112:127], a[92:95], a[60:63], v[112:127]
    v_fma_f32 v74, v104, s24, -v68
    v_exp_f32 v74, v74
    v_add_f32 v70, v70, v77
    v_cvt_pk_bf16_f32 v83, v76, v77
    v_fma_f32 v75, v105, s24, -v68
    s_cmp_lg_u32 s3, 0
    s_cbranch_scc1 L_hb48
    s_waitcnt vmcnt(16)
L_hc48:
    s_barrier
    v_mfma_f32_32x32x16_bf16 v[208:223], a[128:131], a[128:131], 0
    ds_read_b128 a[64:67], v60 offset:8192
    ds_read_b128 a[68:71], v61 offset:8192
    ds_read_b128 a[72:75], v62 offset:8192
    ds_read_b128 a[76:79], v63 offset:8192
    ds_read_b128 a[80:83], v64 offset:8192
    ds_read_b128 a[84:87], v65 offset:8192
    v_exp_f32 v75, v75
    v_add_f32 v70, v70, v74
    v_mfma_f32_32x32x16_bf16 v[224:239], a[128:131], a[128:131], 0
    ds_read_b128 a[88:91], v66 offset:8192
    ds_read_b128 a[92:95], v67 offset:8192
    s_cmp_gt_i32 s42, 2
    s_cselect_b32 s43, s45, s26
    s_cselect_b32 m0, s60, s76
    s_sub_u32 s42, s42, 1
    buffer_load_dwordx4 v48, s[12:15], s43 offen offset:0 lds
    buffer_load_dwordx4 v49, s[12:15], s43 offen offset:1024 lds
    buffer_load_dwordx4 v50, s[12:15], s43 offen offset:2048 lds
    buffer_load_dwordx4 v51, s[12:15], s43 offen offset:3072 lds
    s_mov_b32 m0, s76
    s_mov_b32 s49, s26
    s_add_u32 s46, s46, 1
    buffer_load_dwordx4 v8, s[8:11], s49 offen nt lds
    ds_read_b64_tr_b16 a[96:97], v56 offset:32768
    ds_read_b64_tr_b16 a[98:99], v56 offset:34816
    ds_read_b64_tr_b16 a[100:101], v57 offset:32768
    ds_read_b64_tr_b16 a[102:103], v57 offset:34816
    v_mfma_f32_32x32x16_bf16 v[240:255], a[128:131], a[128:131], 0
    ds_read_b64_tr_b16 a[104:105], v58 offset:32768
    ds_read_b64_tr_b16 a[106:107], v58 offset:34816
    ds_read_b64_tr_b16 a[108:109], v59 offset:32768
    ds_read_b64_tr_b16 a[110:111], v59 offset:34816
    ds_read_b64_tr_b16 a[112:113], v56 offset:36864
    ds_read_b64_tr_b16 a[114:115], v56 offset:38912
    ds_read_b64_tr_b16 a[116:117], v57 offset:36864
    ds_read_b64_tr_b16 a[118:119], v57 offset:38912
    ds_read_b64_tr_b16 a[120:121], v58 offset:36864
    ds_read_b64_tr_b16 a[122:123], v58 offset:38912
    ds_read_b64_tr_b16 a[124:125], v59 offset:36864
    ds_read_b64_tr_b16 a[126:127], v59 offset:38912
    v_fma_f32 v76, v106, s24, -v68
    v_exp_f32 v76, v76
    v_add_f32 v70, v70, v75
    v_cvt_pk_bf16_f32 v84, v74, v75
    v_max3_f32 v4, v112, v113, v114
    v_max3_f32 v5, v115, v116, v117
    v_max3_f32 v4, v4, v118, v119
    v_max3_f32 v5, v5, v120, v121
    v_max3_f32 v4, v4, v122, v123
    v_max3_f32 v5, v5, v124, v125
    v_max3_f32 v4, v4, v126, v127
    v_max_f32 v4, v4, v5
    v_mov_b32 v5, v4
    s_nop 1
    v_permlane32_swap_b32 v4, v5
    v_max_f32 v4, v4, v5
    v_mul_f32 v69, s24, v4
    v_fma_f32 v77, v107, s24, -v68
    v_exp_f32 v77, v77
    v_add_f32 v70, v70, v76
    v_fma_f32 v74, v108, s24, -v68
    v_exp_f32 v74, v74
    v_add_f32 v70, v70, v77
    v_cvt_pk_bf16_f32 v85, v76, v77
    v_fma_f32 v75, v109, s24, -v68
    v_exp_f32 v75, v75
    v_add_f32 v70, v70, v74
    v_fma_f32 v76, v110, s24, -v68
    v_exp_f32 v76, v76
    v_add_f32 v70, v70, v75
    v_cvt_pk_bf16_f32 v86, v74, v75
    v_fma_f32 v77, v111, s24, -v68
    v_exp_f32 v77, v77
    v_add_f32 v70, v70, v76
    v_fma_f32 v74, v112, s24, -v69
    v_exp_f32 v74, v74
    v_add_f32 v70, v70, v77
    v_cvt_pk_bf16_f32 v87, v76, v77
    v_fma_f32 v75, v113, s24, -v69
    v_exp_f32 v75, v75
    v_add_f32 v72, v73, v74
    v_fma_f32 v76, v114, s24, -v69
    s_waitcnt lgkmcnt(0)
    s_cmp_ge_i32 s42, -1
    s_cbranch_scc0 L_tail_B_0
.p2align 6
    s_nop 0
    s_nop 0
L_loop_B_0:
    v_mfma_f32_32x32x16_bf16 v[96:111], a[64:67], a[0:3], 0
    s_cmp_gt_i32 s42, 0
    ds_read_b64_tr_b16 a[104:105], v58 offset:32768
    v_add_f32 v72, v72, v75
    v_cvt_pk_bf16_f32 v88, v74, v75
    v_fma_f32 v77, v115, s24, -v69
    v_exp_f32 v76, v76
    v_mfma_f32_32x32x16_bf16 v[96:111], a[68:71], a[4:7], v[96:111]
    s_cselect_b32 s44, s41, s26
    ds_read_b64_tr_b16 a[106:107], v58 offset:34816
    ds_read_b64_tr_b16 a[108:109], v59 offset:32768
    v_add_f32 v72, v72, v76
    v_fma_f32 v74, v116, s24, -v69
    v_exp_f32 v77, v77
    v_mfma_f32_32x32x16_bf16 v[96:111], a[72:75], a[8:11], v[96:111]
    s_cselect_b32 m0, s67, s76
    ds_read_b64_tr_b16 a[110:111], v59 offset:34816
    v_add_f32 v72, v72, v77
    v_cvt_pk_bf16_f32 v89, v76, v77
    v_fma_f32 v75, v117, s24, -v69
    v_exp_f32 v74, v74
    v_mfma_f32_32x32x16_bf16 v[96:111], a[76:79], a[12:15], v[96:111]
    s_sub_u32 s45, s41, 0x10000
    ds_read_b64_tr_b16 a[112:113], v56 offset:36864
    ds_read_b64_tr_b16 a[114:115], v56 offset:38912
    v_add_f32 v72, v72, v74
    v_fma_f32 v76, v118, s24, -v69
    v_exp_f32 v75, v75
    v_mfma_f32_32x32x16_bf16 v[96:111], a[80:83], a[16:19], v[96:111]
    s_sub_u32 s41, s41, 0x8000
    ds_read_b64_tr_b16 a[116:117], v57 offset:36864
    v_add_f32 v72, v72, v75
    v_cvt_pk_bf16_f32 v90, v74, v75
    v_fma_f32 v77, v119, s24, -v69
    v_exp_f32 v76, v76
    v_mfma_f32_32x32x16_bf16 v[96:111], a[84:87], a[20:23], v[96:111]
    s_sub_u32 s46, s46, 1
    ds_read_b64_tr_b16 a[118:119], v57 offset:38912
    ds_read_b64_tr_b16 a[120:121], v58 offset:36864
    v_add_f32 v72, v72, v76
    v_fma_f32 v74, v120, s24, -v69
    v_exp_f32 v77, v77
    v_mfma_f32_32x32x16_bf16 v[96:111], a[88:91], a[24:27], v[96:111]
    s_cmp_eq_u32 s46, 8
    ds_read_b64_tr_b16 a[122:123], v58 offset:38912
    v_add_f32 v72, v72, v77
    v_cvt_pk_bf16_f32 v91, v76, v77
    v_fma_f32 v75, v121, s24, -v69
    v_exp_f32 v74, v74
    v_mfma_f32_32x32x16_bf16 v[96:111], a[92:95], a[28:31], v[96:111]
    s_waitcnt lgkmcnt(6)
    buffer_load_dwordx4 v52, s[16:19], s44 offen offset:0 lds
    v_add_f32 v72, v72, v74
    v_fma_f32 v76, v122, s24, -v69
    v_exp_f32 v75, v75
    v_mfma_f32_32x32x16_bf16 v[128:143], a[96:99], v[80:83], v[128:143]
    s_cselect_b32 s69, s70, 0
    ds_read_b64_tr_b16 a[124:125], v59 offset:36864
    v_add_f32 v72, v72, v75
    v_cvt_pk_bf16_f32 v92, v74, v75
    v_fma_f32 v77, v123, s24, -v69
    v_exp_f32 v76, v76
    v_mfma_f32_32x32x16_bf16 v[144:159], a[100:103], v[80:83], v[144:159]
    s_cselect_b32 s48, s71, s48
    buffer_load_dwordx4 v53, s[16:19], s44 offen offset:1024 lds
    v_add_f32 v72, v72, v76
    v_fma_f32 v74, v124, s24, -v69
    v_exp_f32 v77, v77
    v_mfma_f32_32x32x16_bf16 v[160:175], a[104:107], v[80:83], v[160:175]
    s_cmp_gt_i32 s42, 2
    ds_read_b64_tr_b16 a[126:127], v59 offset:38912
    v_add_f32 v72, v72, v77
    v_cvt_pk_bf16_f32 v93, v76, v77
    v_fma_f32 v75, v125, s24, -v69
    v_exp_f32 v74, v74
    v_mfma_f32_32x32x16_bf16 v[176:191], a[108:111], v[80:83], v[176:191]
    s_waitcnt lgkmcnt(0)
    buffer_load_dwordx4 v54, s[16:19], s44 offen offset:2048 lds
    v_add_f32 v72, v72, v74
    v_fma_f32 v76, v126, s24, -v69
    v_exp_f32 v75, v75
    v_mfma_f32_32x32x16_bf16 v[128:143], a[112:115], v[84:87], v[128:143]
    s_cselect_b32 s43, s45, s26
    v_add_f32 v72, v72, v75
    v_cvt_pk_bf16_f32 v94, v74, v75
    v_fma_f32 v77, v127, s24, -v69
    v_exp_f32 v76, v76
    v_mfma_f32_32x32x16_bf16 v[144:159], a[116:119], v[84:87], v[144:159]
    buffer_load_dwordx4 v55, s[16:19], s44 offen offset:3072 lds
    v_add_f32 v72, v72, v76
    v_fma_f32 v74, v96, s24, -v68
    v_exp_f32 v77, v77
    v_mfma_f32_32x32x16_bf16 v[160:175], a[120:123], v[84:87], v[160:175]
    s_cselect_b32 m0, s61, s76
    v_add_f32 v72, v72, v77
    v_cvt_pk_bf16_f32 v95, v76, v77
    v_fma_f32 v75, v97, s24, -v68
    v_exp_f32 v74, v74
    v_mfma_f32_32x32x16_bf16 v[176:191], a[124:127], v[84:87], v[176:191]
    s_waitcnt vmcnt(18)
    v_cmp_nge_f32 vcc, s25, v72
    v_add_f32 v71, v70, v74
    v_fma_f32 v76, v98, s24, -v68
    v_exp_f32 v75, v75
    s_cbranch_vccnz L_stub52
L_ret52:
    v_mfma_f32_32x32x16_bf16 v[112:127], a[64:67], a[32:35], 0
    s_barrier
    ds_read_b128 a[64:67], v60 offset:16384
    v_add_f32 v71, v71, v75
    v_cvt_pk_bf16_f32 v80, v74, v75
    v_fma_f32 v77, v99, s24, -v68
    v_exp_f32 v76, v76
    v_mfma_f32_32x32x16_bf16 v[112:127], a[68:71], a[36:39], v[112:127]
    buffer_load_dwordx4 v48, s[12:15], s43 offen offset:0 lds
    v_add_f32 v71, v71, v76
    v_fma_f32 v74, v100, s24, -v68
    v_exp_f32 v77, v77
    v_mfma_f32_32x32x16_bf16 v[112:127], a[72:75], a[40:43], v[112:127]
    s_sub_u32 s42, s42, 1
    ds_read_b128 a[68:71], v61 offset:16384
    v_add_f32 v71, v71, v77
    v_cvt_pk_bf16_f32 v81, v76, v77
    v_fma_f32 v75, v101, s24, -v68
    v_exp_f32 v74, v74
    v_mfma_f32_32x32x16_bf16 v[112:127], a[76:79], a[44:47], v[112:127]
    s_add_u32 s47, s47, s69
    buffer_load_dwordx4 v49, s[12:15], s43 offen offset:1024 lds
    v_add_f32 v71, v71, v74
    v_fma_f32 v76, v102, s24, -v68
    v_exp_f32 v75, v75
    v_mfma_f32_32x32x16_bf16 v[112:127], a[80:83], a[48:51], v[112:127]
    s_cmp_gt_i32 s46, 0
    ds_read_b128 a[72:75], v62 offset:16384
    v_add_f32 v71, v71, v75
    v_cvt_pk_bf16_f32 v82, v74, v75
    v_fma_f32 v77, v103, s24, -v68
    v_exp_f32 v76, v76
    v_mfma_f32_32x32x16_bf16 v[112:127], a[84:87], a[52:55], v[112:127]
    buffer_load_dwordx4 v50, s[12:15], s43 offen offset:2048 lds
    v_add_f32 v71, v71, v76
    v_fma_f32 v74, v104, s24, -v68
    v_exp_f32 v77, v77
    v_mfma_f32_32x32x16_bf16 v[112:127], a[88:91], a[56:59], v[112:127]
    s_cselect_b32 s49, s47, s26
    ds_read_b128 a[76:79], v63 offset:16384
    v_add_f32 v71, v71, v77
    v_cvt_pk_bf16_f32 v83, v76, v77
    v_fma_f32 v75, v105, s24, -v68
    v_exp_f32 v74, v74
    v_mfma_f32_32x32x16_bf16 v[112:127], a[92:95], a[60:63], v[112:127]
    buffer_load_dwordx4 v51, s[12:15], s43 offen offset:3072 lds
    v_add_f32 v71, v71, v74
    v_fma_f32 v76, v106, s24, -v68
    v_exp_f32 v75, v75
    v_mfma_f32_32x32x16_bf16 v[192:207], a[96:99], v[88:91], v[192:207]
    s_cselect_b32 m0, s48, s76
    ds_read_b128 a[80:83], v64 offset:16384
    v_add_f32 v71, v71, v75
    v_cvt_pk_bf16_f32 v84, v74, v75
    v_fma_f32 v77, v107, s24, -v68
    v_exp_f32 v76, v76
    v_mfma_f32_32x32x16_bf16 v[208:223], a[100:103], v[88:91], v[208:223]
    ds_read_b128 a[84:87], v65 offset:16384
    ds_read_b128 a[88:91], v66 offset:16384
    v_add_f32 v71, v71, v76
    v_fma_f32 v74, v108, s24, -v68
    v_exp_f32 v77, v77
    v_mfma_f32_32x32x16_bf16 v[224:239], a[104:107], v[88:91], v[224:239]
    ds_read_b128 a[92:95], v67 offset:16384
    v_add_f32 v71, v71, v77
    v_cvt_pk_bf16_f32 v85, v76, v77
    v_fma_f32 v75, v109, s24, -v68
    v_exp_f32 v74, v74
    v_mfma_f32_32x32x16_bf16 v[240:255], a[108:111], v[88:91], v[240:255]
    buffer_load_dwordx4 v8, s[8:11], s49 offen nt lds
    v_add_f32 v71, v71, v74
    v_fma_f32 v76, v110, s24, -v68
    v_exp_f32 v75, v75
    v_mfma_f32_32x32x16_bf16 v[192:207], a[112:115], v[92:95], v[192:207]
    s_add_u32 s47, s47, 0x4000
    ds_read_b64_tr_b16 a[96:97], v56 offset:40960
    v_add_f32 v71, v71, v75
    v_cvt_pk_bf16_f32 v86, v74, v75
    v_fma_f32 v77, v111, s24, -v68
    v_exp_f32 v76, v76
    v_mfma_f32_32x32x16_bf16 v[208:223], a[116:119], v[92:95], v[208:223]
    s_add_u32 s48, s48, 0x400
    ds_read_b64_tr_b16 a[98:99], v56 offset:43008
    ds_read_b64_tr_b16 a[100:101], v57 offset:40960
    v_add_f32 v71, v71, v76
    v_fma_f32 v74, v112, s24, -v69
    v_exp_f32 v77, v77
    v_mfma_f32_32x32x16_bf16 v[224:239], a[120:123], v[92:95], v[224:239]
    s_cmp_ge_i32 s42, -1
    ds_read_b64_tr_b16 a[102:103], v57 offset:43008
    v_add_f32 v71, v71, v77
    v_cvt_pk_bf16_f32 v87, v76, v77
    v_fma_f32 v75, v113, s24, -v69
    v_exp_f32 v74, v74
    v_mfma_f32_32x32x16_bf16 v[240:255], a[124:127], v[92:95], v[240:255]
    s_waitcnt lgkmcnt(4)
    v_cmp_nge_f32 vcc, s25, v71
    v_add_f32 v73, v72, v74
    v_fma_f32 v76, v114, s24, -v69
    v_exp_f32 v75, v75
    s_cbranch_vccnz L_stub53
L_ret53:
    s_cbranch_scc0 L_tail_B_1
L_loop_B_1:
    v_mfma_f32_32x32x16_bf16 v[96:111], a[64:67], a[0:3], 0
    s_cmp_gt_i32 s42, 0
    ds_read_b64_tr_b16 a[104:105], v58 offset:40960
    v_add_f32 v73, v73, v75
    v_cvt_pk_bf16_f32 v88, v74, v75
    v_fma_f32 v77, v115, s24, -v69
    v_exp_f32 v76, v76
    v_mfma_f32_32x32x16_bf16 v[96:111], a[68:71], a[4:7], v[96:111]
    s_cselect_b32 s44, s41, s26
    ds_read_b64_tr_b16 a[106:107], v58 offset:43008
    ds_read_b64_tr_b16 a[108:109], v59 offset:40960
    v_add_f32 v73, v73, v76
    v_fma_f32 v74, v116, s24, -v69
    v_exp_f32 v77, v77
    v_mfma_f32_32x32x16_bf16 v[96:111], a[72:75], a[8:11], v[96:111]
    s_cselect_b32 m0, s64, s76
    ds_read_b64_tr_b16 a[110:111], v59 offset:43008
    v_add_f32 v73, v73, v77
    v_cvt_pk_bf16_f32 v89, v76, v77
    v_fma_f32 v75, v117, s24, -v69
    v_exp_f32 v74, v74
    v_mfma_f32_32x32x16_bf16 v[96:111], a[76:79], a[12:15], v[96:111]
    s_sub_u32 s45, s41, 0x10000
    ds_read_b64_tr_b16 a[112:113], v56 offset:45056
    ds_read_b64_tr_b16 a[114:115], v56 offset:47104
    v_add_f32 v73, v73, v74
    v_fma_f32 v76, v118, s24, -v69
    v_exp_f32 v75, v75
    v_mfma_f32_32x32x16_bf16 v[96:111], a[80:83], a[16:19], v[96:111]
    s_sub_u32 s41, s41, 0x8000
    ds_read_b64_tr_b16 a[116:117], v57 offset:45056
    v_add_f32 v73, v73, v75
    v_cvt_pk_bf16_f32 v90, v74, v75
    v_fma_f32 v77, v119, s24, -v69
    v_exp_f32 v76, v76
    v_mfma_f32_32x32x16_bf16 v[96:111], a[84:87], a[20:23], v[96:111]
    s_sub_u32 s46, s46, 1
    ds_read_b64_tr_b16 a[118:119], v57 offset:47104
    ds_read_b64_tr_b16 a[120:121], v58 offset:45056
    v_add_f32 v73, v73, v76
    v_fma_f32 v74, v120, s24, -v69
    v_exp_f32 v77, v77
    v_mfma_f32_32x32x16_bf16 v[96:111], a[88:91], a[24:27], v[96:111]
    s_cmp_eq_u32 s46, 8
    ds_read_b64_tr_b16 a[122:123], v58 offset:47104
    v_add_f32 v73, v73, v77
    v_cvt_pk_bf16_f32 v91, v76, v77
    v_fma_f32 v75, v121, s24, -v69
    v_exp_f32 v74, v74
    v_mfma_f32_32x32x16_bf16 v[96:111], a[92:95], a[28:31], v[96:111]
    s_waitcnt lgkmcnt(6)
    buffer_load_dwordx4 v52, s[16:19], s44 offen offset:0 lds
    v_add_f32 v73, v73, v74
    v_fma_f32 v76, v122, s24, -v69
    v_exp_f32 v75, v75
    v_mfma_f32_32x32x16_bf16 v[128:143], a[96:99], v[80:83], v[128:143]
    s_cselect_b32 s69, s70, 0
    ds_read_b64_tr_b16 a[124:125], v59 offset:45056
    v_add_f32 v73, v73, v75
    v_cvt_pk_bf16_f32 v92, v74, v75
    v_fma_f32 v77, v123, s24, -v69
    v_exp_f32 v76, v76
    v_mfma_f32_32x32x16_bf16 v[144:159], a[100:103], v[80:83], v[144:159]
    s_cselect_b32 s48, s71, s48
    buffer_load_dwordx4 v53, s[16:19], s44 offen offset:1024 lds
    v_add_f32 v73, v73, v76
    v_fma_f32 v74, v124, s24, -v69
    v_exp_f32 v77, v77
    v_mfma_f32_32x32x16_bf16 v[160:175], a[104:107], v[80:83], v[160:175]
    s_cmp_gt_i32 s42, 2
    ds_read_b64_tr_b16 a[126:127], v59 offset:47104
    v_add_f32 v73, v73, v77
    v_cvt_pk_bf16_f32 v93, v76, v77
    v_fma_f32 v75, v125, s24, -v69
    v_exp_f32 v74, v74
    v_mfma_f32_32x32x16_bf16 v[176:191], a[108:111], v[80:83], v[176:191]
    s_waitcnt lgkmcnt(0)
    buffer_load_dwordx4 v54, s[16:19], s44 offen offset:2048 lds
    v_add_f32 v73, v73, v74
    v_fma_f32 v76, v126, s24, -v69
    v_exp_f32 v75, v75
    v_mfma_f32_32x32x16_bf16 v[128:143], a[112:115], v[84:87], v[128:143]
    s_cselect_b32 s43, s45, s26
    v_add_f32 v73, v73, v75
    v_cvt_pk_bf16_f32 v94, v74, v75
    v_fma_f32 v77, v127, s24, -v69
    v_exp_f32 v76, v76
    v_mfma_f32_32x32x16_bf16 v[144:159], a[116:119], v[84:87], v[144:159]
    buffer_load_dwordx4 v55, s[16:19], s44 offen offset:3072 lds
    v_add_f32 v73, v73, v76
    v_fma_f32 v74, v96, s24, -v68
    v_exp_f32 v77, v77
    v_mfma_f32_32x32x16_bf16 v[160:175], a[120:123], v[84:87], v[160:175]
    s_cselect_b32 m0, s62, s76
    v_add_f32 v73, v73, v77
    v_cvt_pk_bf16_f32 v95, v76, v77
    v_fma_f32 v75, v97, s24, -v68
    v_exp_f32 v74, v74
    v_mfma_f32_32x32x16_bf16 v[176:191], a[124:127], v[84:87], v[176:191]
    s_waitcnt vmcnt(18)
    v_cmp_nge_f32 vcc, s25, v73
    v_add_f32 v70, v71, v74
    v_fma_f32 v76, v98, s24, -v68
    v_exp_f32 v75, v75
    s_cbranch_vccnz L_stub54
L_ret54:
    v_mfma_f32_32x32x16_bf16 v[112:127], a[64:67], a[32:35], 0
    s_barrier
    ds_read_b128 a[64:67], v60 offset:24576
    v_add_f32 v70, v70, v75
    v_cvt_pk_bf16_f32 v80, v74, v75
    v_fma_f32 v77, v99, s24, -v68
    v_exp_f32 v76, v76
    v_mfma_f32_32x32x16_bf16 v[112:127], a[68:71], a[36:39], v[112:127]
    buffer_load_dwordx4 v48, s[12:15], s43 offen offset:0 lds
    v_add_f32 v70, v70, v76
    v_fma_f32 v74, v100, s24, -v68
    v_exp_f32 v77, v77
    v_mfma_f32_32x32x16_bf16 v[112:127], a[72:75], a[40:43], v[112:127]
    s_sub_u32 s42, s42, 1
    ds_read_b128 a[68:71], v61 offset:24576
    v_add_f32 v70, v70, v77
    v_cvt_pk_bf16_f32 v81, v76, v77
    v_fma_f32 v75, v101, s24, -v68
    v_exp_f32 v74, v74
    v_mfma_f32_32x32x16_bf16 v[112:127], a[76:79], a[44:47], v[112:127]
    s_add_u32 s47, s47, s69
    buffer_load_dwordx4 v49, s[12:15], s43 offen offset:1024 lds
    v_add_f32 v70, v70, v74
    v_fma_f32 v76, v102, s24, -v68
    v_exp_f32 v75, v75
    v_mfma_f32_32x32x16_bf16 v[112:127], a[80:83], a[48:51], v[112:127]
    s_cmp_gt_i32 s46, 0
    ds_read_b128 a[72:75], v62 offset:24576
    v_add_f32 v70, v70, v75
    v_cvt_pk_bf16_f32 v82, v74, v75
    v_fma_f32 v77, v103, s24, -v68
    v_exp_f32 v76, v76
    v_mfma_f32_32x32x16_bf16 v[112:127], a[84:87], a[52:55], v[112:127]
    buffer_load_dwordx4 v50, s[12:15], s43 offen offset:2048 lds
    v_add_f32 v70, v70, v76
    v_fma_f32 v74, v104, s24, -v68
    v_exp_f32 v77, v77
    v_mfma_f32_32x32x16_bf16 v[112:127], a[88:91], a[56:59], v[112:127]
    s_cselect_b32 s49, s47, s26
    ds_read_b128 a[76:79], v63 offset:24576
    v_add_f32 v70, v70, v77
    v_cvt_pk_bf16_f32 v83, v76, v77
    v_fma_f32 v75, v105, s24, -v68
    v_exp_f32 v74, v74
    v_mfma_f32_32x32x16_bf16 v[112:127], a[92:95], a[60:63], v[112:127]
    buffer_load_dwordx4 v51, s[12:15], s43 offen offset:3072 lds
    v_add_f32 v70, v70, v74
    v_fma_f32 v76, v106, s24, -v68
    v_exp_f32 v75, v75
    v_mfma_f32_32x32x16_bf16 v[192:207], a[96:99], v[88:91], v[192:207]
    s_cselect_b32 m0, s48, s76
    ds_read_b128 a[80:83], v64 offset:24576
    v_add_f32 v70, v70, v75
    v_cvt_pk_bf16_f32 v84, v74, v75
    v_fma_f32 v77, v107, s24, -v68
    v_exp_f32 v76, v76
    v_mfma_f32_32x32x16_bf16 v[208:223], a[100:103], v[88:91], v[208:223]
    ds_read_b128 a[84:87], v65 offset:24576
    ds_read_b128 a[88:91], v66 offset:24576
    v_add_f32 v70, v70, v76
    v_fma_f32 v74, v108, s24, -v68
    v_exp_f32 v77, v77
    v_mfma_f32_32x32x16_bf16 v[224:239], a[104:107], v[88:91], v[224:239]
    ds_read_b128 a[92:95], v67 offset:24576
    v_add_f32 v70, v70, v77
    v_cvt_pk_bf16_f32 v85, v76, v77
    v_fma_f32 v75, v109, s24, -v68
    v_exp_f32 v74, v74
    v_mfma_f32_32x32x16_bf16 v[240:255], a[108:111], v[88:91], v[240:255]
    buffer_load_dwordx4 v9, s[8:11], s49 offen nt lds
    v_add_f32 v70, v70, v74
    v_fma_f32 v76, v110, s24, -v68
    v_exp_f32 v75, v75
    v_mfma_f32_32x32x16_bf16 v[192:207], a[112:115], v[92:95], v[192:207]
    s_add_u32 s47, s47, 0x4000
    ds_read_b64_tr_b16 a[96:97], v56 offset:49152
    v_add_f32 v70, v70, v75
    v_cvt_pk_bf16_f32 v86, v74, v75
    v_fma_f32 v77, v111, s24, -v68
    v_exp_f32 v76, v76
    v_mfma_f32_32x32x16_bf16 v[208:223], a[116:119], v[92:95], v[208:223]
    s_add_u32 s48, s48, 0x400
    ds_read_b64_tr_b16 a[98:99], v56 offset:51200
    ds_read_b64_tr_b16 a[100:101], v57 offset:49152
    v_add_f32 v70, v70, v76
    v_fma_f32 v74, v112, s24, -v69
    v_exp_f32 v77, v77
    v_mfma_f32_32x32x16_bf16 v[224:239], a[120:123], v[92:95], v[224:239]
    s_cmp_ge_i32 s42, -1
    ds_read_b64_tr_b16 a[102:103], v57 offset:51200
    v_add_f32 v70, v70, v77
    v_cvt_pk_bf16_f32 v87, v76, v77
    v_fma_f32 v75, v113, s24, -v69
    v_exp_f32 v74, v74
    v_mfma_f32_32x32x16_bf16 v[240:255], a[124:127], v[92:95], v[240:255]
    s_waitcnt lgkmcnt(4)
    v_cmp_nge_f32 vcc, s25, v70
    v_add_f32 v72, v73, v74
    v_fma_f32 v76, v114, s24, -v69
    v_exp_f32 v75, v75
    s_cbranch_vccnz L_stub55
L_ret55:
    s_cbranch_scc0 L_tail_B_2
L_loop_B_2:
    v_mfma_f32_32x32x16_bf16 v[96:111], a[64:67], a[0:3], 0
    s_cmp_gt_i32 s42, 0
    ds_read_b64_tr_b16 a[104:105], v58 offset:49152
    v_add_f32 v72, v72, v75
    v_cvt_pk_bf16_f32 v88, v74, v75
    v_fma_f32 v77, v115, s24, -v69
    v_exp_f32 v76, v76
    v_mfma_f32_32x32x16_bf16 v[96:111], a[68:71], a[4:7], v[96:111]
    s_cselect_b32 s44, s41, s26
    ds_read_b64_tr_b16 a[106:107], v58 offset:51200
    ds_read_b64_tr_b16 a[108:109], v59 offset:49152
    v_add_f32 v72, v72, v76
    v_fma_f32 v74, v116, s24, -v69
    v_exp_f32 v77, v77
    v_mfma_f32_32x32x16_bf16 v[96:111], a[72:75], a[8:11], v[96:111]
    s_cselect_b32 m0, s65, s76
    ds_read_b64_tr_b16 a[110:111], v59 offset:51200
    v_add_f32 v72, v72, v77
    v_cvt_pk_bf16_f32 v89, v76, v77
    v_fma_f32 v75, v117, s24, -v69
    v_exp_f32 v74, v74
    v_mfma_f32_32x32x16_bf16 v[96:111], a[76:79], a[12:15], v[96:111]
    s_sub_u32 s45, s41, 0x10000
    ds_read_b64_tr_b16 a[112:113], v56 offset:53248
    ds_read_b64_tr_b16 a[114:115], v56 offset:55296
    v_add_f32 v72, v72, v74
    v_fma_f32 v76, v118, s24, -v69
    v_exp_f32 v75, v75
    v_mfma_f32_32x32x16_bf16 v[96:111], a[80:83], a[16:19], v[96:111]
    s_sub_u32 s41, s41, 0x8000
    ds_read_b64_tr_b16 a[116:117], v57 offset:53248
    v_add_f32 v72, v72, v75
    v_cvt_pk_bf16_f32 v90, v74, v75
    v_fma_f32 v77, v119, s24, -v69
    v_exp_f32 v76, v76
    v_mfma_f32_32x32x16_bf16 v[96:111], a[84:87], a[20:23], v[96:111]
    s_sub_u32 s46, s46, 1
    ds_read_b64_tr_b16 a[118:119], v57 offset:55296
    ds_read_b64_tr_b16 a[120:121], v58 offset:53248
    v_add_f32 v72, v72, v76
    v_fma_f32 v74, v120, s24, -v69
    v_exp_f32 v77, v77
    v_mfma_f32_32x32x16_bf16 v[96:111], a[88:91], a[24:27], v[96:111]
    s_cmp_eq_u32 s46, 8
    ds_read_b64_tr_b16 a[122:123], v58 offset:55296
    v_add_f32 v72, v72, v77
    v_cvt_pk_bf16_f32 v91, v76, v77
    v_fma_f32 v75, v121, s24, -v69
    v_exp_f32 v74, v74
    v_mfma_f32_32x32x16_bf16 v[96:111], a[92:95], a[28:31], v[96:111]
    s_waitcnt lgkmcnt(6)
    buffer_load_dwordx4 v52, s[16:19], s44 offen offset:0 lds
    v_add_f32 v72, v72, v74
    v_fma_f32 v76, v122, s24, -v69
    v_exp_f32 v75, v75
    v_mfma_f32_32x32x16_bf16 v[128:143], a[96:99], v[80:83], v[128:143]
    s_cselect_b32 s69, s70, 0
    ds_read_b64_tr_b16 a[124:125], v59 offset:53248
    v_add_f32 v72, v72, v75
    v_cvt_pk_bf16_f32 v92, v74, v75
    v_fma_f32 v77, v123, s24, -v69
    v_exp_f32 v76, v76
    v_mfma_f32_32x32x16_bf16 v[144:159], a[100:103], v[80:83], v[144:159]
    s_cselect_b32 s48, s71, s48
    buffer_load_dwordx4 v53, s[16:19], s44 offen offset:1024 lds
    v_add_f32 v72, v72, v76
    v_fma_f32 v74, v124, s24, -v69
    v_exp_f32 v77, v77
    v_mfma_f32_32x32x16_bf16 v[160:175], a[104:107], v[80:83], v[160:175]
    s_cmp_gt_i32 s42, 2
    ds_read_b64_tr_b16 a[126:127], v59 offset:55296
    v_add_f32 v72, v72, v77
    v_cvt_pk_bf16_f32 v93, v76, v77
    v_fma_f32 v75, v125, s24, -v69
    v_exp_f32 v74, v74
    v_mfma_f32_32x32x16_bf16 v[176:191], a[108:111], v[80:83], v[176:191]
    s_waitcnt lgkmcnt(0)
    buffer_load_dwordx4 v54, s[16:19], s44 offen offset:2048 lds
    v_add_f32 v72, v72, v74
    v_fma_f32 v76, v126, s24, -v69
    v_exp_f32 v75, v75
    v_mfma_f32_32x32x16_bf16 v[128:143], a[112:115], v[84:87], v[128:143]
    s_cselect_b32 s43, s45, s26
    v_add_f32 v72, v72, v75
    v_cvt_pk_bf16_f32 v94, v74, v75
    v_fma_f32 v77, v127, s24, -v69
    v_exp_f32 v76, v76
    v_mfma_f32_32x32x16_bf16 v[144:159], a[116:119], v[84:87], v[144:159]
    buffer_load_dwordx4 v55, s[16:19], s44 offen offset:3072 lds
    v_add_f32 v72, v72, v76
    v_fma_f32 v74, v96, s24, -v68
    v_exp_f32 v77, v77
    v_mfma_f32_32x32x16_bf16 v[160:175], a[120:123], v[84:87], v[160:175]
    s_cselect_b32 m0, s63, s76
    v_add_f32 v72, v72, v77
    v_cvt_pk_bf16_f32 v95, v76, v77
    v_fma_f32 v75, v97, s24, -v68
    v_exp_f32 v74, v74
    v_mfma_f32_32x32x16_bf16 v[176:191], a[124:127], v[84:87], v[176:191]
    s_waitcnt vmcnt(18)
    v_cmp_nge_f32 vcc, s25, v72
    v_add_f32 v71, v70, v74
    v_fma_f32 v76, v98, s24, -v68
    v_exp_f32 v75, v75
    s_cbranch_vccnz L_stub56
L_ret56:
    v_mfma_f32_32x32x16_bf16 v[112:127], a[64:67], a[32:35], 0
    s_barrier
    ds_read_b128 a[64:67], v60 offset:0
    v_add_f32 v71, v71, v75
    v_cvt_pk_bf16_f32 v80, v74, v75
    v_fma_f32 v77, v99, s24, -v68
    v_exp_f32 v76, v76
    v_mfma_f32_32x32x16_bf16 v[112:127], a[68:71], a[36:39], v[112:127]
    buffer_load_dwordx4 v48, s[12:15], s43 offen offset:0 lds
    v_add_f32 v71, v71, v76
    v_fma_f32 v74, v100, s24, -v68
    v_exp_f32 v77, v77
    v_mfma_f32_32x32x16_bf16 v[112:127], a[72:75], a[40:43], v[112:127]
    s_sub_u32 s42, s42, 1
    ds_read_b128 a[68:71], v61 offset:0
    v_add_f32 v71, v71, v77
    v_cvt_pk_bf16_f32 v81, v76, v77
    v_fma_f32 v75, v101, s24, -v68
    v_exp_f32 v74, v74
    v_mfma_f32_32x32x16_bf16 v[112:127], a[76:79], a[44:47], v[112:127]
    s_add_u32 s47, s47, s69
    buffer_load_dwordx4 v49, s[12:15], s43 offen offset:1024 lds
    v_add_f32 v71, v71, v74
    v_fma_f32 v76, v102, s24, -v68
    v_exp_f32 v75, v75
    v_mfma_f32_32x32x16_bf16 v[112:127], a[80:83], a[48:51], v[112:127]
    s_cmp_gt_i32 s46, 0
    ds_read_b128 a[72:75], v62 offset:0
    v_add_f32 v71, v71, v75
    v_cvt_pk_bf16_f32 v82, v74, v75
    v_fma_f32 v77, v103, s24, -v68
    v_exp_f32 v76, v76
    v_mfma_f32_32x32x16_bf16 v[112:127], a[84:87], a[52:55], v[112:127]
    buffer_load_dwordx4 v50, s[12:15], s43 offen offset:2048 lds
    v_add_f32 v71, v71, v76
    v_fma_f32 v74, v104, s24, -v68
    v_exp_f32 v77, v77
    v_mfma_f32_32x32x16_bf16 v[112:127], a[88:91], a[56:59], v[112:127]
    s_cselect_b32 s49, s47, s26
    ds_read_b128 a[76:79], v63 offset:0
    v_add_f32 v71, v71, v77
    v_cvt_pk_bf16_f32 v83, v76, v77
    v_fma_f32 v75, v105, s24, -v68
    v_exp_f32 v74, v74
    v_mfma_f32_32x32x16_bf16 v[112:127], a[92:95], a[60:63], v[112:127]
    buffer_load_dwordx4 v51, s[12:15], s43 offen offset:3072 lds
    v_add_f32 v71, v71, v74
    v_fma_f32 v76, v106, s24, -v68
    v_exp_f32 v75, v75
    v_mfma_f32_32x32x16_bf16 v[192:207], a[96:99], v[88:91], v[192:207]
    s_cselect_b32 m0, s48, s76
    ds_read_b128 a[80:83], v64 offset:0
    v_add_f32 v71, v71, v75
    v_cvt_pk_bf16_f32 v84, v74, v75
    v_fma_f32 v77, v107, s24, -v68
    v_exp_f32 v76, v76
    v_mfma_f32_32x32x16_bf16 v[208:223], a[100:103], v[88:91], v[208:223]
    ds_read_b128 a[84:87], v65 offset:0
    ds_read_b128 a[88:91], v66 offset:0
    v_add_f32 v71, v71, v76
    v_fma_f32 v74, v108, s24, -v68
    v_exp_f32 v77, v77
    v_mfma_f32_32x32x16_bf16 v[224:239], a[104:107], v[88:91], v[224:239]
    ds_read_b128 a[92:95], v67 offset:0
    v_add_f32 v71, v71, v77
    v_cvt_pk_bf16_f32 v85, v76, v77
    v_fma_f32 v75, v109, s24, -v68
    v_exp_f32 v74, v74
    v_mfma_f32_32x32x16_bf16 v[240:255], a[108:111], v[88:91], v[240:255]
    buffer_load_dwordx4 v10, s[8:11], s49 offen nt lds
    v_add_f32 v71, v71, v74
    v_fma_f32 v76, v110, s24, -v68
    v_exp_f32 v75, v75
    v_mfma_f32_32x32x16_bf16 v[192:207], a[112:115], v[92:95], v[192:207]
    s_add_u32 s47, s47, 0x4000
    ds_read_b64_tr_b16 a[96:97], v56 offset:57344
    v_add_f32 v71, v71, v75
    v_cvt_pk_bf16_f32 v86, v74, v75
    v_fma_f32 v77, v111, s24, -v68
    v_exp_f32 v76, v76
    v_mfma_f32_32x32x16_bf16 v[208:223], a[116:119], v[92:95], v[208:223]
    s_add_u32 s48, s48, 0x400
    ds_read_b64_tr_b16 a[98:99], v56 offset:59392
    ds_read_b64_tr_b16 a[100:101], v57 offset:57344
    v_add_f32 v71, v71, v76
    v_fma_f32 v74, v112, s24, -v69
    v_exp_f32 v77, v77
    v_mfma_f32_32x32x16_bf16 v[224:239], a[120:123], v[92:95], v[224:239]
    s_cmp_ge_i32 s42, -1
    ds_read_b64_tr_b16 a[102:103], v57 offset:59392
    v_add_f32 v71, v71, v77
    v_cvt_pk_bf16_f32 v87, v76, v77
    v_fma_f32 v75, v113, s24, -v69
    v_exp_f32 v74, v74
    v_mfma_f32_32x32x16_bf16 v[240:255], a[124:127], v[92:95], v[240:255]
    s_waitcnt lgkmcnt(4)
    v_cmp_nge_f32 vcc, s25, v71
    v_add_f32 v73, v72, v74
    v_fma_f32 v76, v114, s24, -v69
    v_exp_f32 v75, v75
    s_cbranch_vccnz L_stub57
L_ret57:
    s_cbranch_scc0 L_tail_B_3
L_loop_B_3:
    v_mfma_f32_32x32x16_bf16 v[96:111], a[64:67], a[0:3], 0
    s_cmp_gt_i32 s42, 0
    ds_read_b64_tr_b16 a[104:105], v58 offset:57344
    v_add_f32 v73, v73, v75
    v_cvt_pk_bf16_f32 v88, v74, v75
    v_fma_f32 v77, v115, s24, -v69
    v_exp_f32 v76, v76
    v_mfma_f32_32x32x16_bf16 v[96:111], a[68:71], a[4:7], v[96:111]
    s_cselect_b32 s44, s41, s26
    ds_read_b64_tr_b16 a[106:107], v58 offset:59392
    ds_read_b64_tr_b16 a[108:109], v59 offset:57344
    v_add_f32 v73, v73, v76
    v_fma_f32 v74, v116, s24, -v69
    v_exp_f32 v77, v77
    v_mfma_f32_32x32x16_bf16 v[96:111], a[72:75], a[8:11], v[96:111]
    s_cselect_b32 m0, s66, s76
    ds_read_b64_tr_b16 a[110:111], v59 offset:59392
    v_add_f32 v73, v73, v77
    v_cvt_pk_bf16_f32 v89, v76, v77
    v_fma_f32 v75, v117, s24, -v69
    v_exp_f32 v74, v74
    v_mfma_f32_32x32x16_bf16 v[96:111], a[76:79], a[12:15], v[96:111]
    s_sub_u32 s45, s41, 0x10000
    ds_read_b64_tr_b16 a[112:113], v56 offset:61440
    ds_read_b64_tr_b16 a[114:115], v56 offset:63488
    v_add_f32 v73, v73, v74
    v_fma_f32 v76, v118, s24, -v69
    v_exp_f32 v75, v75
    v_mfma_f32_32x32x16_bf16 v[96:111], a[80:83], a[16:19], v[96:111]
    s_sub_u32 s41, s41, 0x8000
    ds_read_b64_tr_b16 a[116:117], v57 offset:61440
    v_add_f32 v73, v73, v75
    v_cvt_pk_bf16_f32 v90, v74, v75
    v_fma_f32 v77, v119, s24, -v69
    v_exp_f32 v76, v76
    v_mfma_f32_32x32x16_bf16 v[96:111], a[84:87], a[20:23], v[96:111]
    s_sub_u32 s46, s46, 1
    ds_read_b64_tr_b16 a[118:119], v57 offset:63488
    ds_read_b64_tr_b16 a[120:121], v58 offset:61440
    v_add_f32 v73, v73, v76
    v_fma_f32 v74, v120, s24, -v69
    v_exp_f32 v77, v77
    v_mfma_f32_32x32x16_bf16 v[96:111], a[88:91], a[24:27], v[96:111]
    s_cmp_eq_u32 s46, 8
    ds_read_b64_tr_b16 a[122:123], v58 offset:63488
    v_add_f32 v73, v73, v77
    v_cvt_pk_bf16_f32 v91, v76, v77
    v_fma_f32 v75, v121, s24, -v69
    v_exp_f32 v74, v74
    v_mfma_f32_32x32x16_bf16 v[96:111], a[92:95], a[28:31], v[96:111]
    s_waitcnt lgkmcnt(6)
    buffer_load_dwordx4 v52, s[16:19], s44 offen offset:0 lds
    v_add_f32 v73, v73, v74
    v_fma_f32 v76, v122, s24, -v69
    v_exp_f32 v75, v75
    v_mfma_f32_32x32x16_bf16 v[128:143], a[96:99], v[80:83], v[128:143]
    s_cselect_b32 s69, s70, 0
    ds_read_b64_tr_b16 a[124:125], v59 offset:61440
    v_add_f32 v73, v73, v75
    v_cvt_pk_bf16_f32 v92, v74, v75
    v_fma_f32 v77, v123, s24, -v69
    v_exp_f32 v76, v76
    v_mfma_f32_32x32x16_bf16 v[144:159], a[100:103], v[80:83], v[144:159]
    s_cselect_b32 s48, s71, s48
    buffer_load_dwordx4 v53, s[16:19], s44 offen offset:1024 lds
    v_add_f32 v73, v73, v76
    v_fma_f32 v74, v124, s24, -v69
    v_exp_f32 v77, v77
    v_mfma_f32_32x32x16_bf16 v[160:175], a[104:107], v[80:83], v[160:175]
    s_cmp_gt_i32 s42, 2
    ds_read_b64_tr_b16 a[126:127], v59 offset:63488
    v_add_f32 v73, v73, v77
    v_cvt_pk_bf16_f32 v93, v76, v77
    v_fma_f32 v75, v125, s24, -v69
    v_exp_f32 v74, v74
    v_mfma_f32_32x32x16_bf16 v[176:191], a[108:111], v[80:83], v[176:191]
    s_waitcnt lgkmcnt(0)
    buffer_load_dwordx4 v54, s[16:19], s44 offen offset:2048 lds
    v_add_f32 v73, v73, v74
    v_fma_f32 v76, v126, s24, -v69
    v_exp_f32 v75, v75
    v_mfma_f32_32x32x16_bf16 v[128:143], a[112:115], v[84:87], v[128:143]
    s_cselect_b32 s43, s45, s26
    v_add_f32 v73, v73, v75
    v_cvt_pk_bf16_f32 v94, v74, v75
    v_fma_f32 v77, v127, s24, -v69
    v_exp_f32 v76, v76
    v_mfma_f32_32x32x16_bf16 v[144:159], a[116:119], v[84:87], v[144:159]
    buffer_load_dwordx4 v55, s[16:19], s44 offen offset:3072 lds
    v_add_f32 v73, v73, v76
    v_fma_f32 v74, v96, s24, -v68
    v_exp_f32 v77, v77
    v_mfma_f32_32x32x16_bf16 v[160:175], a[120:123], v[84:87], v[160:175]
    s_cselect_b32 m0, s60, s76
    v_add_f32 v73, v73, v77
    v_cvt_pk_bf16_f32 v95, v76, v77
    v_fma_f32 v75, v97, s24, -v68
    v_exp_f32 v74, v74
    v_mfma_f32_32x32x16_bf16 v[176:191], a[124:127], v[84:87], v[176:191]
    s_waitcnt vmcnt(18)
    v_cmp_nge_f32 vcc, s25, v73
    v_add_f32 v70, v71, v74
    v_fma_f32 v76, v98, s24, -v68
    v_exp_f32 v75, v75
    s_cbranch_vccnz L_stub58
L_ret58:
    v_mfma_f32_32x32x16_bf16 v[112:127], a[64:67], a[32:35], 0
    s_barrier
    ds_read_b128 a[64:67], v60 offset:8192
    v_add_f32 v70, v70, v75
    v_cvt_pk_bf16_f32 v80, v74, v75
    v_fma_f32 v77, v99, s24, -v68
    v_exp_f32 v76, v76
    v_mfma_f32_32x32x16_bf16 v[112:127], a[68:71], a[36:39], v[112:127]
    buffer_load_dwordx4 v48, s[12:15], s43 offen offset:0 lds
    v_add_f32 v70, v70, v76
    v_fma_f32 v74, v100, s24, -v68
    v_exp_f32 v77, v77
    v_mfma_f32_32x32x16_bf16 v[112:127], a[72:75], a[40:43], v[112:127]
    s_sub_u32 s42, s42, 1
    ds_read_b128 a[68:71], v61 offset:8192
    v_add_f32 v70, v70, v77
    v_cvt_pk_bf16_f32 v81, v76, v77
    v_fma_f32 v75, v101, s24, -v68
    v_exp_f32 v74, v74
    v_mfma_f32_32x32x16_bf16 v[112:127], a[76:79], a[44:47], v[112:127]
    s_add_u32 s47, s47, s69
    buffer_load_dwordx4 v49, s[12:15], s43 offen offset:1024 lds
    v_add_f32 v70, v70, v74
    v_fma_f32 v76, v102, s24, -v68
    v_exp_f32 v75, v75
    v_mfma_f32_32x32x16_bf16 v[112:127], a[80:83], a[48:51], v[112:127]
    s_cmp_gt_i32 s46, 0
    ds_read_b128 a[72:75], v62 offset:8192
    v_add_f32 v70, v70, v75
    v_cvt_pk_bf16_f32 v82, v74, v75
    v_fma_f32 v77, v103, s24, -v68
    v_exp_f32 v76, v76
    v_mfma_f32_32x32x16_bf16 v[112:127], a[84:87], a[52:55], v[112:127]
    buffer_load_dwordx4 v50, s[12:15], s43 offen offset:2048 lds
    v_add_f32 v70, v70, v76
    v_fma_f32 v74, v104, s24, -v68
    v_exp_f32 v77, v77
    v_mfma_f32_32x32x16_bf16 v[112:127], a[88:91], a[56:59], v[112:127]
    s_cselect_b32 s49, s47, s26
    ds_read_b128 a[76:79], v63 offset:8192
    v_add_f32 v70, v70, v77
    v_cvt_pk_bf16_f32 v83, v76, v77
    v_fma_f32 v75, v105, s24, -v68
    v_exp_f32 v74, v74
    v_mfma_f32_32x32x16_bf16 v[112:127], a[92:95], a[60:63], v[112:127]
    buffer_load_dwordx4 v51, s[12:15], s43 offen offset:3072 lds
    v_add_f32 v70, v70, v74
    v_fma_f32 v76, v106, s24, -v68
    v_exp_f32 v75, v75
    v_mfma_f32_32x32x16_bf16 v[192:207], a[96:99], v[88:91], v[192:207]
    s_cselect_b32 m0, s48, s76
    ds_read_b128 a[80:83], v64 offset:8192
    v_add_f32 v70, v70, v75
    v_cvt_pk_bf16_f32 v84, v74, v75
    v_fma_f32 v77, v107, s24, -v68
    v_exp_f32 v76, v76
    v_mfma_f32_32x32x16_bf16 v[208:223], a[100:103], v[88:91], v[208:223]
    ds_read_b128 a[84:87], v65 offset:8192
    ds_read_b128 a[88:91], v66 offset:8192
    v_add_f32 v70, v70, v76
    v_fma_f32 v74, v108, s24, -v68
    v_exp_f32 v77, v77
    v_mfma_f32_32x32x16_bf16 v[224:239], a[104:107], v[88:91], v[224:239]
    ds_read_b128 a[92:95], v67 offset:8192
    v_add_f32 v70, v70, v77
    v_cvt_pk_bf16_f32 v85, v76, v77
    v_fma_f32 v75, v109, s24, -v68
    v_exp_f32 v74, v74
    v_mfma_f32_32x32x16_bf16 v[240:255], a[108:111], v[88:91], v[240:255]
    buffer_load_dwordx4 v11, s[8:11], s49 offen nt lds
    v_add_f32 v70, v70, v74
    v_fma_f32 v76, v110, s24, -v68
    v_exp_f32 v75, v75
    v_mfma_f32_32x32x16_bf16 v[192:207], a[112:115], v[92:95], v[192:207]
    s_add_u32 s47, s47, 0x4000
    ds_read_b64_tr_b16 a[96:97], v56 offset:32768
    v_add_f32 v70, v70, v75
    v_cvt_pk_bf16_f32 v86, v74, v75
    v_fma_f32 v77, v111, s24, -v68
    v_exp_f32 v76, v76
    v_mfma_f32_32x32x16_bf16 v[208:223], a[116:119], v[92:95], v[208:223]
    s_add_u32 s48, s48, 0x400
    ds_read_b64_tr_b16 a[98:99], v56 offset:34816
    ds_read_b64_tr_b16 a[100:101], v57 offset:32768
    v_add_f32 v70, v70, v76
    v_fma_f32 v74, v112, s24, -v69
    v_exp_f32 v77, v77
    v_mfma_f32_32x32x16_bf16 v[224:239], a[120:123], v[92:95], v[224:239]
    s_cmp_ge_i32 s42, -1
    ds_read_b64_tr_b16 a[102:103], v57 offset:34816
    v_add_f32 v70, v70, v77
    v_cvt_pk_bf16_f32 v87, v76, v77
    v_fma_f32 v75, v113, s24, -v69
    v_exp_f32 v74, v74
    v_mfma_f32_32x32x16_bf16 v[240:255], a[124:127], v[92:95], v[240:255]
    s_waitcnt lgkmcnt(4)
    v_cmp_nge_f32 vcc, s25, v70
    v_add_f32 v72, v73, v74
    v_fma_f32 v76, v114, s24, -v69
    v_exp_f32 v75, v75
    s_cbranch_vccnz L_stub59
L_ret59:
    s_cbranch_scc0 L_tail_B_0
    s_branch L_loop_B_0
L_tail_B_0:
    ds_read_b64_tr_b16 a[104:105], v58 offset:32768
    ds_read_b64_tr_b16 a[106:107], v58 offset:34816
    ds_read_b64_tr_b16 a[108:109], v59 offset:32768
    ds_read_b64_tr_b16 a[110:111], v59 offset:34816
    ds_read_b64_tr_b16 a[112:113], v56 offset:36864
    ds_read_b64_tr_b16 a[114:115], v56 offset:38912
    ds_read_b64_tr_b16 a[116:117], v57 offset:36864
    ds_read_b64_tr_b16 a[118:119], v57 offset:38912
    ds_read_b64_tr_b16 a[120:121], v58 offset:36864
    ds_read_b64_tr_b16 a[122:123], v58 offset:38912
    ds_read_b64_tr_b16 a[124:125], v59 offset:36864
    ds_read_b64_tr_b16 a[126:127], v59 offset:38912
    s_lshl_b32 s50, s5, 4
    s_max_i32 s50, s50, s46
    s_cmp_gt_i32 s50, 1
    s_cbranch_scc1 L_cold61
L_back61:
    v_exp_f32 v76, v76
    v_add_f32 v72, v72, v75
    v_cvt_pk_bf16_f32 v88, v74, v75
    v_fma_f32 v77, v115, s24, -v69
    v_exp_f32 v77, v77
    v_add_f32 v72, v72, v76
    v_fma_f32 v74, v116, s24, -v69
    v_exp_f32 v74, v74
    v_add_f32 v72, v72, v77
    v_cvt_pk_bf16_f32 v89, v76, v77
    s_waitcnt lgkmcnt(0)
    v_mfma_f32_32x32x16_bf16 v[128:143], a[96:99], v[80:83], v[128:143]
    s_barrier
    s_lshl_b32 s50, s28, 16
    s_bitcmp1_b32 s75, 10
    s_cselect_b32 s68, s50, 0
    s_cselect_b32 s50, s97, s96
    v_fma_f32 v75, v117, s24, -v69
    v_exp_f32 v75, v75
    v_mfma_f32_32x32x16_bf16 v[144:159], a[100:103], v[80:83], v[144:159]
    s_add_u32 s60, s50, 0
    s_add_u32 s64, s50, 32768
    s_add_u32 s61, s50, 8192
    s_add_u32 s65, s50, 40960
    v_add_f32 v72, v72, v74
    v_fma_f32 v76, v118, s24, -v69
    v_exp_f32 v76, v76
    v_mfma_f32_32x32x16_bf16 v[160:175], a[104:107], v[80:83], v[160:175]
    s_add_u32 s62, s50, 16384
    s_add_u32 s66, s50, 49152
    s_add_u32 s63, s50, 24576
    s_add_u32 s67, s50, 57344
    v_add_f32 v72, v72, v75
    v_cvt_pk_bf16_f32 v90, v74, v75
    v_fma_f32 v77, v119, s24, -v69
    v_mfma_f32_32x32x16_bf16 v[176:191], a[108:111], v[80:83], v[176:191]
    s_sub_u32 s54, s73, 0
    s_cmp_gt_i32 s74, 0
    s_cselect_b32 s54, s54, s26
    s_cselect_b32 m0, s60, s76
    s_bitcmp1_b32 s75, 10
    s_cbranch_scc1 L_pfb62
    buffer_load_dwordx4 v0, s[12:15], s54 offen offset:0 nt lds
    buffer_load_dwordx4 v1, s[12:15], s54 offen offset:1024 nt lds
L_pfe62:
    v_mfma_f32_32x32x16_bf16 v[128:143], a[112:115], v[84:87], v[128:143]
    v_exp_f32 v77, v77
    v_add_f32 v72, v72, v76
    v_fma_f32 v74, v120, s24, -v69
    v_exp_f32 v74, v74
    v_add_f32 v72, v72, v77
    v_cvt_pk_bf16_f32 v91, v76, v77
    v_mfma_f32_32x32x16_bf16 v[144:159], a[116:119], v[84:87], v[144:159]
    v_fma_f32 v75, v121, s24, -v69
    v_exp_f32 v75, v75
    v_add_f32 v72, v72, v74
    v_fma_f32 v76, v122, s24, -v69
    v_exp_f32 v76, v76
    v_add_f32 v72, v72, v75
    v_mfma_f32_32x32x16_bf16 v[160:175], a[120:123], v[84:87], v[160:175]
    s_sub_u32 s54, s73, 32768
    s_cmp_gt_i32 s74, 1
    s_cselect_b32 s54, s54, s26
    s_cselect_b32 m0, s61, s76
    s_bitcmp1_b32 s75, 10
    s_cbranch_scc1 L_pfb63
    buffer_load_dwordx4 v0, s[12:15], s54 offen offset:0 nt lds
    buffer_load_dwordx4 v1, s[12:15], s54 offen offset:1024 nt lds
L_pfe63:
    v_mfma_f32_32x32x16_bf16 v[176:191], a[124:127], v[84:87], v[176:191]
    v_cvt_pk_bf16_f32 v92, v74, v75
    v_fma_f32 v77, v123, s24, -v69
    v_exp_f32 v77, v77
    v_add_f32 v72, v72, v76
    v_fma_f32 v74, v124, s24, -v69
    v_exp_f32 v74, v74
    v_add_f32 v72, v72, v77
    v_cvt_pk_bf16_f32 v93, v76, v77
    v_fma_f32 v75, v125, s24, -v69
    v_exp_f32 v75, v75
    v_add_f32 v72, v72, v74
    v_fma_f32 v76, v126, s24, -v69
    v_exp_f32 v76, v76
    v_add_f32 v72, v72, v75
    v_cvt_pk_bf16_f32 v94, v74, v75
    v_fma_f32 v77, v127, s24, -v69
    v_exp_f32 v77, v77
    v_add_f32 v72, v72, v76
    s_nop 0
    v_add_f32 v72, v72, v77
    v_cvt_pk_bf16_f32 v95, v76, v77
    v_cmp_nge_f32 vcc, s25, v72
    s_nop 1
    s_cbranch_vccnz L_stub64
L_ret64:
    v_mfma_f32_32x32x16_bf16 v[192:207], a[96:99], v[88:91], v[192:207]
    v_mov_b32 v2, v70
    v_mov_b32 v3, v70
    v_mov_b32 v4, v72
    v_mov_b32 v5, v72
    s_and_b32 s50, s39, 63
    v_and_b32 v6, 31, v15
    v_mfma_f32_32x32x16_bf16 v[208:223], a[100:103], v[88:91], v[208:223]
    v_lshrrev_b32 v7, 5, v15
    v_lshlrev_b32 v36, 7, v6
    v_bfe_u32 v42, v15, 3, 1
    v_xor_b32 v7, v7, v42
    v_lshl_add_u32 v36, v7, 3, v36
    v_and_b32 v6, 7, v15
    v_mfma_f32_32x32x16_bf16 v[224:239], a[104:107], v[88:91], v[224:239]
    v_lshl_add_u32 v36, v6, 4, v36
    v_add_u32 v36, s78, v36
    v_permlane32_swap_b32 v2, v3
    v_permlane32_swap_b32 v4, v5
    v_lshrrev_b32 v6, 3, v15
    v_and_b32 v7, 7, v15
    v_mfma_f32_32x32x16_bf16 v[240:255], a[108:111], v[88:91], v[240:255]
    v_add_f32 v2, v2, v3
    v_add_f32 v4, v4, v5
    v_xor_b32 v37, v6, v7
    v_lshlrev_b32 v37, 4, v37
    v_lshl_add_u32 v37, v6, 7, v37
    v_add_u32 v37, s78, v37
    v_mfma_f32_32x32x16_bf16 v[192:207], a[112:115], v[92:95], v[192:207]
    v_lshlrev_b32 v7, 4, v7
    v_lshl_add_u32 v7, v6, 12, v7
    v_mov_b32 v43, s26
    v_add_u32 v42, 0, v6
    v_cmp_gt_u32 vcc, s50, v42
    v_add_u32 v42, 0, v7
    v_mfma_f32_32x32x16_bf16 v[208:223], a[116:119], v[92:95], v[208:223]
    s_nop 0
    v_cndmask_b32 v32, v43, v42, vcc
    v_add_u32 v42, 8, v6
    v_cmp_gt_u32 vcc, s50, v42
    v_add_u32 v42, 32768, v7
    s_nop 0
    v_mfma_f32_32x32x16_bf16 v[224:239], a[120:123], v[92:95], v[224:239]
    v_cndmask_b32 v33, v43, v42, vcc
    v_add_u32 v42, 16, v6
    v_cmp_gt_u32 vcc, s50, v42
    v_add_u32 v42, 65536, v7
    s_nop 0
    v_cndmask_b32 v34, v43, v42, vcc
    v_mfma_f32_32x32x16_bf16 v[240:255], a[124:127], v[92:95], v[240:255]
    v_add_u32 v42, 24, v6
    v_cmp_gt_u32 vcc, s50, v42
    v_add_u32 v42, 98304, v7
    s_nop 0
    v_cndmask_b32 v35, v43, v42, vcc
    s_lshl_b32 s50, s28, 16
    s_lshl_b32 s51, s29, 14
    s_add_u32 s50, s50, s51
    s_add_u32 s50, s50, 0x8000
    s_xor_b32 s51, s50, 0x10000
    v_lshlrev_b32 v6, 4, v15
    v_add_u32 v38, s50, v6
    v_add_u32 v39, s51, v6
    s_lshl_b32 s50, s27, 9
    s_add_u32 s50, s50, 0x6000
    s_xor_b32 s51, s50, 0x400
    v_lshlrev_b32 v6, 3, v15
    v_add_u32 v40, s50, v6
    v_add_u32 v41, s51, v6
    s_branch L_epi_B
L_cold61:
    s_call_b64 s[30:31], L_qrem_0
    s_branch L_back61
L_pfb62:
    buffer_load_dwordx4 v48, s[12:15], s54 offen offset:0 nt lds
    buffer_load_dwordx4 v49, s[12:15], s54 offen offset:1024 nt lds
    buffer_load_dwordx4 v50, s[12:15], s54 offen offset:2048 nt lds
    buffer_load_dwordx4 v51, s[12:15], s54 offen offset:3072 nt lds
    s_branch L_pfe62
L_pfb63:
    buffer_load_dwordx4 v48, s[12:15], s54 offen offset:0 nt lds
    buffer_load_dwordx4 v49, s[12:15], s54 offen offset:1024 nt lds
    buffer_load_dwordx4 v50, s[12:15], s54 offen offset:2048 nt lds
    buffer_load_dwordx4 v51, s[12:15], s54 offen offset:3072 nt lds
    s_branch L_pfe63
L_tail_B_1:
    ds_read_b64_tr_b16 a[104:105], v58 offset:40960
    ds_read_b64_tr_b16 a[106:107], v58 offset:43008
    ds_read_b64_tr_b16 a[108:109], v59 offset:40960
    ds_read_b64_tr_b16 a[110:111], v59 offset:43008
    ds_read_b64_tr_b16 a[112:113], v56 offset:45056
    ds_read_b64_tr_b16 a[114:115], v56 offset:47104
    ds_read_b64_tr_b16 a[116:117], v57 offset:45056
    ds_read_b64_tr_b16 a[118:119], v57 offset:47104
    ds_read_b64_tr_b16 a[120:121], v58 offset:45056
    ds_read_b64_tr_b16 a[122:123], v58 offset:47104
    ds_read_b64_tr_b16 a[124:125], v59 offset:45056
    ds_read_b64_tr_b16 a[126:127], v59 offset:47104
    s_lshl_b32 s50, s5, 4
    s_max_i32 s50, s50, s46
    s_cmp_gt_i32 s50, 1
    s_cbranch_scc1 L_cold66
L_back66:
    v_exp_f32 v76, v76
    v_add_f32 v73, v73, v75
    v_cvt_pk_bf16_f32 v88, v74, v75
    v_fma_f32 v77, v115, s24, -v69
    v_exp_f32 v77, v77
    v_add_f32 v73, v73, v76
    v_fma_f32 v74, v116, s24, -v69
    v_exp_f32 v74, v74
    v_add_f32 v73, v73, v77
    v_cvt_pk_bf16_f32 v89, v76, v77
    s_waitcnt lgkmcnt(0)
    v_mfma_f32_32x32x16_bf16 v[128:143], a[96:99], v[80:83], v[128:143]
    s_barrier
    s_lshl_b32 s50, s28, 16
    s_bitcmp1_b32 s75, 10
    s_cselect_b32 s68, s50, 0
    s_cselect_b32 s50, s97, s96
    v_fma_f32 v75, v117, s24, -v69
    v_exp_f32 v75, v75
    v_mfma_f32_32x32x16_bf16 v[144:159], a[100:103], v[80:83], v[144:159]
    s_add_u32 s60, s50, 0
    s_add_u32 s64, s50, 32768
    s_add_u32 s61, s50, 8192
    s_add_u32 s65, s50, 40960
    v_add_f32 v73, v73, v74
    v_fma_f32 v76, v118, s24, -v69
    v_exp_f32 v76, v76
    v_mfma_f32_32x32x16_bf16 v[160:175], a[104:107], v[80:83], v[160:175]
    s_add_u32 s62, s50, 16384
    s_add_u32 s66, s50, 49152
    s_add_u32 s63, s50, 24576
    s_add_u32 s67, s50, 57344
    v_add_f32 v73, v73, v75
    v_cvt_pk_bf16_f32 v90, v74, v75
    v_fma_f32 v77, v119, s24, -v69
    v_mfma_f32_32x32x16_bf16 v[176:191], a[108:111], v[80:83], v[176:191]
    s_sub_u32 s54, s73, 0
    s_cmp_gt_i32 s74, 0
    s_cselect_b32 s54, s54, s26
    s_cselect_b32 m0, s60, s76
    s_bitcmp1_b32 s75, 10
    s_cbranch_scc1 L_pfb67
    buffer_load_dwordx4 v0, s[12:15], s54 offen offset:0 nt lds
    buffer_load_dwordx4 v1, s[12:15], s54 offen offset:1024 nt lds
L_pfe67:
    v_mfma_f32_32x32x16_bf16 v[128:143], a[112:115], v[84:87], v[128:143]
    v_exp_f32 v77, v77
    v_add_f32 v73, v73, v76
    v_fma_f32 v74, v120, s24, -v69
    v_exp_f32 v74, v74
    v_add_f32 v73, v73, v77
    v_cvt_pk_bf16_f32 v91, v76, v77
    v_mfma_f32_32x32x16_bf16 v[144:159], a[116:119], v[84:87], v[144:159]
    v_fma_f32 v75, v121, s24, -v69
    v_exp_f32 v75, v75
    v_add_f32 v73, v73, v74
    v_fma_f32 v76, v122, s24, -v69
    v_exp_f32 v76, v76
    v_add_f32 v73, v73, v75
    v_mfma_f32_32x32x16_bf16 v[160:175], a[120:123], v[84:87], v[160:175]
    s_sub_u32 s54, s73, 32768
    s_cmp_gt_i32 s74, 1
    s_cselect_b32 s54, s54, s26
    s_cselect_b32 m0, s61, s76
    s_bitcmp1_b32 s75, 10
    s_cbranch_scc1 L_pfb68
    buffer_load_dwordx4 v0, s[12:15], s54 offen offset:0 nt lds
    buffer_load_dwordx4 v1, s[12:15], s54 offen offset:1024 nt lds
L_pfe68:
    v_mfma_f32_32x32x16_bf16 v[176:191], a[124:127], v[84:87], v[176:191]
    v_cvt_pk_bf16_f32 v92, v74, v75
    v_fma_f32 v77, v123, s24, -v69
    v_exp_f32 v77, v77
    v_add_f32 v73, v73, v76
    v_fma_f32 v74, v124, s24, -v69
    v_exp_f32 v74, v74
    v_add_f32 v73, v73, v77
    v_cvt_pk_bf16_f32 v93, v76, v77
    v_fma_f32 v75, v125, s24, -v69
    v_exp_f32 v75, v75
    v_add_f32 v73, v73, v74
    v_fma_f32 v76, v126, s24, -v69
    v_exp_f32 v76, v76
    v_add_f32 v73, v73, v75
    v_cvt_pk_bf16_f32 v94, v74, v75
    v_fma_f32 v77, v127, s24, -v69
    v_exp_f32 v77, v77
    v_add_f32 v73, v73, v76
    s_nop 0
    v_add_f32 v73, v73, v77
    v_cvt_pk_bf16_f32 v95, v76, v77
    v_cmp_nge_f32 vcc, s25, v73
    s_nop 1
    s_cbranch_vccnz L_stub69
L_ret69:
    v_mfma_f32_32x32x16_bf16 v[192:207], a[96:99], v[88:91], v[192:207]
    v_mov_b32 v2, v71
    v_mov_b32 v3, v71
    v_mov_b32 v4, v73
    v_mov_b32 v5, v73
    s_and_b32 s50, s39, 63
    v_and_b32 v6, 31, v15
    v_mfma_f32_32x32x16_bf16 v[208:223], a[100:103], v[88:91], v[208:223]
    v_lshrrev_b32 v7, 5, v15
    v_lshlrev_b32 v36, 7, v6
    v_bfe_u32 v42, v15, 3, 1
    v_xor_b32 v7, v7, v42
    v_lshl_add_u32 v36, v7, 3, v36
    v_and_b32 v6, 7, v15
    v_mfma_f32_32x32x16_bf16 v[224:239], a[104:107], v[88:91], v[224:239]
    v_lshl_add_u32 v36, v6, 4, v36
    v_add_u32 v36, s78, v36
    v_permlane32_swap_b32 v2, v3
    v_permlane32_swap_b32 v4, v5
    v_lshrrev_b32 v6, 3, v15
    v_and_b32 v7, 7, v15
    v_mfma_f32_32x32x16_bf16 v[240:255], a[108:111], v[88:91], v[240:255]
    v_add_f32 v2, v2, v3
    v_add_f32 v4, v4, v5
    v_xor_b32 v37, v6, v7
    v_lshlrev_b32 v37, 4, v37
    v_lshl_add_u32 v37, v6, 7, v37
    v_add_u32 v37, s78, v37
    v_mfma_f32_32x32x16_bf16 v[192:207], a[112:115], v[92:95], v[192:207]
    v_lshlrev_b32 v7, 4, v7
    v_lshl_add_u32 v7, v6, 12, v7
    v_mov_b32 v43, s26
    v_add_u32 v42, 0, v6
    v_cmp_gt_u32 vcc, s50, v42
    v_add_u32 v42, 0, v7
    v_mfma_f32_32x32x16_bf16 v[208:223], a[116:119], v[92:95], v[208:223]
    s_nop 0
    v_cndmask_b32 v32, v43, v42, vcc
    v_add_u32 v42, 8, v6
    v_cmp_gt_u32 vcc, s50, v42
    v_add_u32 v42, 32768, v7
    s_nop 0
    v_mfma_f32_32x32x16_bf16 v[224:239], a[120:123], v[92:95], v[224:239]
    v_cndmask_b32 v33, v43, v42, vcc
    v_add_u32 v42, 16, v6
    v_cmp_gt_u32 vcc, s50, v42
    v_add_u32 v42, 65536, v7
    s_nop 0
    v_cndmask_b32 v34, v43, v42, vcc
    v_mfma_f32_32x32x16_bf16 v[240:255], a[124:127], v[92:95], v[240:255]
    v_add_u32 v42, 24, v6
    v_cmp_gt_u32 vcc, s50, v42
    v_add_u32 v42, 98304, v7
    s_nop 0
    v_cndmask_b32 v35, v43, v42, vcc
    s_lshl_b32 s50, s28, 16
    s_lshl_b32 s51, s29, 14
    s_add_u32 s50, s50, s51
    s_add_u32 s50, s50, 0x8000
    s_xor_b32 s51, s50, 0x10000
    v_lshlrev_b32 v6, 4, v15
    v_add_u32 v38, s50, v6
    v_add_u32 v39, s51, v6
    s_lshl_b32 s50, s27, 9
    s_add_u32 s50, s50, 0x6000
    s_xor_b32 s51, s50, 0x400
    v_lshlrev_b32 v6, 3, v15
    v_add_u32 v40, s50, v6
    v_add_u32 v41, s51, v6
    s_branch L_epi_B
L_cold66:
    s_call_b64 s[30:31], L_qrem_1
    s_branch L_back66
L_pfb67:
    buffer_load_dwordx4 v48, s[12:15], s54 offen offset:0 nt lds
    buffer_load_dwordx4 v49, s[12:15], s54 offen offset:1024 nt lds
    buffer_load_dwordx4 v50, s[12:15], s54 offen offset:2048 nt lds
    buffer_load_dwordx4 v51, s[12:15], s54 offen offset:3072 nt lds
    s_branch L_pfe67
L_pfb68:
    buffer_load_dwordx4 v48, s[12:15], s54 offen offset:0 nt lds
    buffer_load_dwordx4 v49, s[12:15], s54 offen offset:1024 nt lds
    buffer_load_dwordx4 v50, s[12:15], s54 offen offset:2048 nt lds
    buffer_load_dwordx4 v51, s[12:15], s54 offen offset:3072 nt lds
    s_branch L_pfe68
L_tail_B_2:
    ds_read_b64_tr_b16 a[104:105], v58 offset:49152
    ds_read_b64_tr_b16 a[106:107], v58 offset:51200
    ds_read_b64_tr_b16 a[108:109], v59 offset:49152
    ds_read_b64_tr_b16 a[110:111], v59 offset:51200
    ds_read_b64_tr_b16 a[112:113], v56 offset:53248
    ds_read_b64_tr_b16 a[114:115], v56 offset:55296
    ds_read_b64_tr_b16 a[116:117], v57 offset:53248
    ds_read_b64_tr_b16 a[118:119], v57 offset:55296
    ds_read_b64_tr_b16 a[120:121], v58 offset:53248
    ds_read_b64_tr_b16 a[122:123], v58 offset:55296
    ds_read_b64_tr_b16 a[124:125], v59 offset:53248
    ds_read_b64_tr_b16 a[126:127], v59 offset:55296
    s_lshl_b32 s50, s5, 4
    s_max_i32 s50, s50, s46
    s_cmp_gt_i32 s50, 1
    s_cbranch_scc1 L_cold71
L_back71:
    v_exp_f32 v76, v76
    v_add_f32 v72, v72, v75
    v_cvt_pk_bf16_f32 v88, v74, v75
    v_fma_f32 v77, v115, s24, -v69
    v_exp_f32 v77, v77
    v_add_f32 v72, v72, v76
    v_fma_f32 v74, v116, s24, -v69
    v_exp_f32 v74, v74
    v_add_f32 v72, v72, v77
    v_cvt_pk_bf16_f32 v89, v76, v77
    s_waitcnt lgkmcnt(0)
    v_mfma_f32_32x32x16_bf16 v[128:143], a[96:99], v[80:83], v[128:143]
    s_barrier
    s_lshl_b32 s50, s28, 16
    s_bitcmp1_b32 s75, 10
    s_cselect_b32 s68, s50, 0
    s_cselect_b32 s50, s97, s96
    v_fma_f32 v75, v117, s24, -v69
    v_exp_f32 v75, v75
    v_mfma_f32_32x32x16_bf16 v[144:159], a[100:103], v[80:83], v[144:159]
    s_add_u32 s60, s50, 0
    s_add_u32 s64, s50, 32768
    s_add_u32 s61, s50, 8192
    s_add_u32 s65, s50, 40960
    v_add_f32 v72, v72, v74
    v_fma_f32 v76, v118, s24, -v69
    v_exp_f32 v76, v76
    v_mfma_f32_32x32x16_bf16 v[160:175], a[104:107], v[80:83], v[160:175]
    s_add_u32 s62, s50, 16384
    s_add_u32 s66, s50, 49152
    s_add_u32 s63, s50, 24576
    s_add_u32 s67, s50, 57344
    v_add_f32 v72, v72, v75
    v_cvt_pk_bf16_f32 v90, v74, v75
    v_fma_f32 v77, v119, s24, -v69
    v_mfma_f32_32x32x16_bf16 v[176:191], a[108:111], v[80:83], v[176:191]
    s_sub_u32 s54, s73, 0
    s_cmp_gt_i32 s74, 0
    s_cselect_b32 s54, s54, s26
    s_cselect_b32 m0, s60, s76
    s_bitcmp1_b32 s75, 10
    s_cbranch_scc1 L_pfb72
    buffer_load_dwordx4 v0, s[12:15], s54 offen offset:0 nt lds
    buffer_load_dwordx4 v1, s[12:15], s54 offen offset:1024 nt lds
L_pfe72:
    v_mfma_f32_32x32x16_bf16 v[128:143], a[112:115], v[84:87], v[128:143]
    v_exp_f32 v77, v77
    v_add_f32 v72, v72, v76
    v_fma_f32 v74, v120, s24, -v69
    v_exp_f32 v74, v74
    v_add_f32 v72, v72, v77
    v_cvt_pk_bf16_f32 v91, v76, v77
    v_mfma_f32_32x32x16_bf16 v[144:159], a[116:119], v[84:87], v[144:159]
    v_fma_f32 v75, v121, s24, -v69
    v_exp_f32 v75, v75
    v_add_f32 v72, v72, v74
    v_fma_f32 v76, v122, s24, -v69
    v_exp_f32 v76, v76
    v_add_f32 v72, v72, v75
    v_mfma_f32_32x32x16_bf16 v[160:175], a[120:123], v[84:87], v[160:175]
    s_sub_u32 s54, s73, 32768
    s_cmp_gt_i32 s74, 1
    s_cselect_b32 s54, s54, s26
    s_cselect_b32 m0, s61, s76
    s_bitcmp1_b32 s75, 10
    s_cbranch_scc1 L_pfb73
    buffer_load_dwordx4 v0, s[12:15], s54 offen offset:0 nt lds
    buffer_load_dwordx4 v1, s[12:15], s54 offen offset:1024 nt lds
L_pfe73:
    v_mfma_f32_32x32x16_bf16 v[176:191], a[124:127], v[84:87], v[176:191]
    v_cvt_pk_bf16_f32 v92, v74, v75
    v_fma_f32 v77, v123, s24, -v69
    v_exp_f32 v77, v77
    v_add_f32 v72, v72, v76
    v_fma_f32 v74, v124, s24, -v69
    v_exp_f32 v74, v74
    v_add_f32 v72, v72, v77
    v_cvt_pk_bf16_f32 v93, v76, v77
    v_fma_f32 v75, v125, s24, -v69
    v_exp_f32 v75, v75
    v_add_f32 v72, v72, v74
    v_fma_f32 v76, v126, s24, -v69
    v_exp_f32 v76, v76
    v_add_f32 v72, v72, v75
    v_cvt_pk_bf16_f32 v94, v74, v75
    v_fma_f32 v77, v127, s24, -v69
    v_exp_f32 v77, v77
    v_add_f32 v72, v72, v76
    s_nop 0
    v_add_f32 v72, v72, v77
    v_cvt_pk_bf16_f32 v95, v76, v77
    v_cmp_nge_f32 vcc, s25, v72
    s_nop 1
    s_cbranch_vccnz L_stub74
L_ret74:
    v_mfma_f32_32x32x16_bf16 v[192:207], a[96:99], v[88:91], v[192:207]
    v_mov_b32 v2, v70
    v_mov_b32 v3, v70
    v_mov_b32 v4, v72
    v_mov_b32 v5, v72
    s_and_b32 s50, s39, 63
    v_and_b32 v6, 31, v15
    v_mfma_f32_32x32x16_bf16 v[208:223], a[100:103], v[88:91], v[208:223]
    v_lshrrev_b32 v7, 5, v15
    v_lshlrev_b32 v36, 7, v6
    v_bfe_u32 v42, v15, 3, 1
    v_xor_b32 v7, v7, v42
    v_lshl_add_u32 v36, v7, 3, v36
    v_and_b32 v6, 7, v15
    v_mfma_f32_32x32x16_bf16 v[224:239], a[104:107], v[88:91], v[224:239]
    v_lshl_add_u32 v36, v6, 4, v36
    v_add_u32 v36, s78, v36
    v_permlane32_swap_b32 v2, v3
    v_permlane32_swap_b32 v4, v5
    v_lshrrev_b32 v6, 3, v15
    v_and_b32 v7, 7, v15
    v_mfma_f32_32x32x16_bf16 v[240:255], a[108:111], v[88:91], v[240:255]
    v_add_f32 v2, v2, v3
    v_add_f32 v4, v4, v5
    v_xor_b32 v37, v6, v7
    v_lshlrev_b32 v37, 4, v37
    v_lshl_add_u32 v37, v6, 7, v37
    v_add_u32 v37, s78, v37
    v_mfma_f32_32x32x16_bf16 v[192:207], a[112:115], v[92:95], v[192:207]
    v_lshlrev_b32 v7, 4, v7
    v_lshl_add_u32 v7, v6, 12, v7
    v_mov_b32 v43, s26
    v_add_u32 v42, 0, v6
    v_cmp_gt_u32 vcc, s50, v42
    v_add_u32 v42, 0, v7
    v_mfma_f32_32x32x16_bf16 v[208:223], a[116:119], v[92:95], v[208:223]
    s_nop 0
    v_cndmask_b32 v32, v43, v42, vcc
    v_add_u32 v42, 8, v6
    v_cmp_gt_u32 vcc, s50, v42
    v_add_u32 v42, 32768, v7
    s_nop 0
    v_mfma_f32_32x32x16_bf16 v[224:239], a[120:123], v[92:95], v[224:239]
    v_cndmask_b32 v33, v43, v42, vcc
    v_add_u32 v42, 16, v6
    v_cmp_gt_u32 vcc, s50, v42
    v_add_u32 v42, 65536, v7
    s_nop 0
    v_cndmask_b32 v34, v43, v42, vcc
    v_mfma_f32_32x32x16_bf16 v[240:255], a[124:127], v[92:95], v[240:255]
    v_add_u32 v42, 24, v6
    v_cmp_gt_u32 vcc, s50, v42
    v_add_u32 v42, 98304, v7
    s_nop 0
    v_cndmask_b32 v35, v43, v42, vcc
    s_lshl_b32 s50, s28, 16
    s_lshl_b32 s51, s29, 14
    s_add_u32 s50, s50, s51
    s_add_u32 s50, s50, 0x8000
    s_xor_b32 s51, s50, 0x10000
    v_lshlrev_b32 v6, 4, v15
    v_add_u32 v38, s50, v6
    v_add_u32 v39, s51, v6
    s_lshl_b32 s50, s27, 9
    s_add_u32 s50, s50, 0x6000
    s_xor_b32 s51, s50, 0x400
    v_lshlrev_b32 v6, 3, v15
    v_add_u32 v40, s50, v6
    v_add_u32 v41, s51, v6
    s_branch L_epi_B
L_cold71:
    s_call_b64 s[30:31], L_qrem_2
    s_branch L_back71
L_pfb72:
    buffer_load_dwordx4 v48, s[12:15], s54 offen offset:0 nt lds
    buffer_load_dwordx4 v49, s[12:15], s54 offen offset:1024 nt lds
    buffer_load_dwordx4 v50, s[12:15], s54 offen offset:2048 nt lds
    buffer_load_dwordx4 v51, s[12:15], s54 offen offset:3072 nt lds
    s_branch L_pfe72
L_pfb73:
    buffer_load_dwordx4 v48, s[12:15], s54 offen offset:0 nt lds
    buffer_load_dwordx4 v49, s[12:15], s54 offen offset:1024 nt lds
    buffer_load_dwordx4 v50, s[12:15], s54 offen offset:2048 nt lds
    buffer_load_dwordx4 v51, s[12:15], s54 offen offset:3072 nt lds
    s_branch L_pfe73
L_tail_B_3:
    ds_read_b64_tr_b16 a[104:105], v58 offset:57344
    ds_read_b64_tr_b16 a[106:107], v58 offset:59392
    ds_read_b64_tr_b16 a[108:109], v59 offset:57344
    ds_read_b64_tr_b16 a[110:111], v59 offset:59392
    ds_read_b64_tr_b16 a[112:113], v56 offset:61440
    ds_read_b64_tr_b16 a[114:115], v56 offset:63488
    ds_read_b64_tr_b16 a[116:117], v57 offset:61440
    ds_read_b64_tr_b16 a[118:119], v57 offset:63488
    ds_read_b64_tr_b16 a[120:121], v58 offset:61440
    ds_read_b64_tr_b16 a[122:123], v58 offset:63488
    ds_read_b64_tr_b16 a[124:125], v59 offset:61440
    ds_read_b64_tr_b16 a[126:127], v59 offset:63488
    s_lshl_b32 s50, s5, 4
    s_max_i32 s50, s50, s46
    s_cmp_gt_i32 s50, 1
    s_cbranch_scc1 L_cold76
L_back76:
    v_exp_f32 v76, v76
    v_add_f32 v73, v73, v75
    v_cvt_pk_bf16_f32 v88, v74, v75
    v_fma_f32 v77, v115, s24, -v69
    v_exp_f32 v77, v77
    v_add_f32 v73, v73, v76
    v_fma_f32 v74, v116, s24, -v69
    v_exp_f32 v74, v74
    v_add_f32 v73, v73, v77
    v_cvt_pk_bf16_f32 v89, v76, v77
    s_waitcnt lgkmcnt(0)
    v_mfma_f32_32x32x16_bf16 v[128:143], a[96:99], v[80:83], v[128:143]
    s_barrier
    s_lshl_b32 s50, s28, 16
    s_bitcmp1_b32 s75, 10
    s_cselect_b32 s68, s50, 0
    s_cselect_b32 s50, s97, s96
    v_fma_f32 v75, v117, s24, -v69
    v_exp_f32 v75, v75
    v_mfma_f32_32x32x16_bf16 v[144:159], a[100:103], v[80:83], v[144:159]
    s_add_u32 s60, s50, 0
    s_add_u32 s64, s50, 32768
    s_add_u32 s61, s50, 8192
    s_add_u32 s65, s50, 40960
    v_add_f32 v73, v73, v74
    v_fma_f32 v76, v118, s24, -v69
    v_exp_f32 v76, v76
    v_mfma_f32_32x32x16_bf16 v[160:175], a[104:107], v[80:83], v[160:175]
    s_add_u32 s62, s50, 16384
    s_add_u32 s66, s50, 49152
    s_add_u32 s63, s50, 24576
    s_add_u32 s67, s50, 57344
    v_add_f32 v73, v73, v75
    v_cvt_pk_bf16_f32 v90, v74, v75
    v_fma_f32 v77, v119, s24, -v69
    v_mfma_f32_32x32x16_bf16 v[176:191], a[108:111], v[80:83], v[176:191]
    s_sub_u32 s54, s73, 0
    s_cmp_gt_i32 s74, 0
    s_cselect_b32 s54, s54, s26
    s_cselect_b32 m0, s60, s76
    s_bitcmp1_b32 s75, 10
    s_cbranch_scc1 L_pfb77
    buffer_load_dwordx4 v0, s[12:15], s54 offen offset:0 nt lds
    buffer_load_dwordx4 v1, s[12:15], s54 offen offset:1024 nt lds
L_pfe77:
    v_mfma_f32_32x32x16_bf16 v[128:143], a[112:115], v[84:87], v[128:143]
    v_exp_f32 v77, v77
    v_add_f32 v73, v73, v76
    v_fma_f32 v74, v120, s24, -v69
    v_exp_f32 v74, v74
    v_add_f32 v73, v73, v77
    v_cvt_pk_bf16_f32 v91, v76, v77
    v_mfma_f32_32x32x16_bf16 v[144:159], a[116:119], v[84:87], v[144:159]
    v_fma_f32 v75, v121, s24, -v69
    v_exp_f32 v75, v75
    v_add_f32 v73, v73, v74
    v_fma_f32 v76, v122, s24, -v69
    v_exp_f32 v76, v76
    v_add_f32 v73, v73, v75
    v_mfma_f32_32x32x16_bf16 v[160:175], a[120:123], v[84:87], v[160:175]
    s_sub_u32 s54, s73, 32768
    s_cmp_gt_i32 s74, 1
    s_cselect_b32 s54, s54, s26
    s_cselect_b32 m0, s61, s76
    s_bitcmp1_b32 s75, 10
    s_cbranch_scc1 L_pfb78
    buffer_load_dwordx4 v0, s[12:15], s54 offen offset:0 nt lds
    buffer_load_dwordx4 v1, s[12:15], s54 offen offset:1024 nt lds
L_pfe78:
    v_mfma_f32_32x32x16_bf16 v[176:191], a[124:127], v[84:87], v[176:191]
    v_cvt_pk_bf16_f32 v92, v74, v75
    v_fma_f32 v77, v123, s24, -v69
    v_exp_f32 v77, v77
    v_add_f32 v73, v73, v76
    v_fma_f32 v74, v124, s24, -v69
    v_exp_f32 v74, v74
    v_add_f32 v73, v73, v77
    v_cvt_pk_bf16_f32 v93, v76, v77
    v_fma_f32 v75, v125, s24, -v69
    v_exp_f32 v75, v75
    v_add_f32 v73, v73, v74
    v_fma_f32 v76, v126, s24, -v69
    v_exp_f32 v76, v76
    v_add_f32 v73, v73, v75
    v_cvt_pk_bf16_f32 v94, v74, v75
    v_fma_f32 v77, v127, s24, -v69
    v_exp_f32 v77, v77
    v_add_f32 v73, v73, v76
    s_nop 0
    v_add_f32 v73, v73, v77
    v_cvt_pk_bf16_f32 v95, v76, v77
    v_cmp_nge_f32 vcc, s25, v73
    s_nop 1
    s_cbranch_vccnz L_stub79
L_ret79:
    v_mfma_f32_32x32x16_bf16 v[192:207], a[96:99], v[88:91], v[192:207]
    v_mov_b32 v2, v71
    v_mov_b32 v3, v71
    v_mov_b32 v4, v73
    v_mov_b32 v5, v73
    s_and_b32 s50, s39, 63
    v_and_b32 v6, 31, v15
    v_mfma_f32_32x32x16_bf16 v[208:223], a[100:103], v[88:91], v[208:223]
    v_lshrrev_b32 v7, 5, v15
    v_lshlrev_b32 v36, 7, v6
    v_bfe_u32 v42, v15, 3, 1
    v_xor_b32 v7, v7, v42
    v_lshl_add_u32 v36, v7, 3, v36
    v_and_b32 v6, 7, v15
    v_mfma_f32_32x32x16_bf16 v[224:239], a[104:107], v[88:91], v[224:239]
    v_lshl_add_u32 v36, v6, 4, v36
    v_add_u32 v36, s78, v36
    v_permlane32_swap_b32 v2, v3
    v_permlane32_swap_b32 v4, v5
    v_lshrrev_b32 v6, 3, v15
    v_and_b32 v7, 7, v15
    v_mfma_f32_32x32x16_bf16 v[240:255], a[108:111], v[88:91], v[240:255]
    v_add_f32 v2, v2, v3
    v_add_f32 v4, v4, v5
    v_xor_b32 v37, v6, v7
    v_lshlrev_b32 v37, 4, v37
    v_lshl_add_u32 v37, v6, 7, v37
    v_add_u32 v37, s78, v37
    v_mfma_f32_32x32x16_bf16 v[192:207], a[112:115], v[92:95], v[192:207]
    v_lshlrev_b32 v7, 4, v7
    v_lshl_add_u32 v7, v6, 12, v7
    v_mov_b32 v43, s26
    v_add_u32 v42, 0, v6
    v_cmp_gt_u32 vcc, s50, v42
    v_add_u32 v42, 0, v7
    v_mfma_f32_32x32x16_bf16 v[208:223], a[116:119], v[92:95], v[208:223]
    s_nop 0
    v_cndmask_b32 v32, v43, v42, vcc
    v_add_u32 v42, 8, v6
    v_cmp_gt_u32 vcc, s50, v42
    v_add_u32 v42, 32768, v7
    s_nop 0
    v_mfma_f32_32x32x16_bf16 v[224:239], a[120:123], v[92:95], v[224:239]
    v_cndmask_b32 v33, v43, v42, vcc
    v_add_u32 v42, 16, v6
    v_cmp_gt_u32 vcc, s50, v42
    v_add_u32 v42, 65536, v7
    s_nop 0
    v_cndmask_b32 v34, v43, v42, vcc
    v_mfma_f32_32x32x16_bf16 v[240:255], a[124:127], v[92:95], v[240:255]
    v_add_u32 v42, 24, v6
    v_cmp_gt_u32 vcc, s50, v42
    v_add_u32 v42, 98304, v7
    s_nop 0
    v_cndmask_b32 v35, v43, v42, vcc
    s_lshl_b32 s50, s28, 16
    s_lshl_b32 s51, s29, 14
    s_add_u32 s50, s50, s51
    s_add_u32 s50, s50, 0x8000
    s_xor_b32 s51, s50, 0x10000
    v_lshlrev_b32 v6, 4, v15
    v_add_u32 v38, s50, v6
    v_add_u32 v39, s51, v6
    s_lshl_b32 s50, s27, 9
    s_add_u32 s50, s50, 0x6000
    s_xor_b32 s51, s50, 0x400
    v_lshlrev_b32 v6, 3, v15
    v_add_u32 v40, s50, v6
    v_add_u32 v41, s51, v6
    s_branch L_epi_B
L_cold76:
    s_call_b64 s[30:31], L_qrem_3
    s_branch L_back76
L_pfb77:
    buffer_load_dwordx4 v48, s[12:15], s54 offen offset:0 nt lds
    buffer_load_dwordx4 v49, s[12:15], s54 offen offset:1024 nt lds
    buffer_load_dwordx4 v50, s[12:15], s54 offen offset:2048 nt lds
    buffer_load_dwordx4 v51, s[12:15], s54 offen offset:3072 nt lds
    s_branch L_pfe77
L_pfb78:
    buffer_load_dwordx4 v48, s[12:15], s54 offen offset:0 nt lds
    buffer_load_dwordx4 v49, s[12:15], s54 offen offset:1024 nt lds
    buffer_load_dwordx4 v50, s[12:15], s54 offen offset:2048 nt lds
    buffer_load_dwordx4 v51, s[12:15], s54 offen offset:3072 nt lds
    s_branch L_pfe78
L_epi_B:
    v_xor_b32 v88, 0, v36
    v_xor_b32 v89, 16, v36
    v_xor_b32 v90, 32, v36
    v_xor_b32 v91, 48, v36
    v_xor_b32 v92, 64, v36
    v_xor_b32 v93, 80, v36
    v_xor_b32 v94, 96, v36
    v_xor_b32 v95, 112, v36
    s_cmp_eq_u32 s28, 0
    s_cbranch_scc0 L_epiB_1
    v_mov_b32 v6, v69
    v_mov_b32 v7, v4
    s_nop 7
    ds_write_b64 v40, v[6:7]
    ds_write_b128 v38, v[192:195] offset:0
    ds_write_b128 v38, v[196:199] offset:1024
    ds_write_b128 v38, v[200:203] offset:2048
    ds_write_b128 v38, v[204:207] offset:3072
    ds_write_b128 v38, v[208:211] offset:4096
    ds_write_b128 v38, v[212:215] offset:5120
    ds_write_b128 v38, v[216:219] offset:6144
    ds_write_b128 v38, v[220:223] offset:7168
    ds_write_b128 v38, v[224:227] offset:8192
    ds_write_b128 v38, v[228:231] offset:9216
    ds_write_b128 v38, v[232:235] offset:10240
    ds_write_b128 v38, v[236:239] offset:11264
    ds_write_b128 v38, v[240:243] offset:12288
    ds_write_b128 v38, v[244:247] offset:13312
    ds_write_b128 v38, v[248:251] offset:14336
    ds_write_b128 v38, v[252:255] offset:15360
    s_waitcnt lgkmcnt(0)
    s_barrier
    ds_read_b64 v[6:7], v41
    ds_read_b128 v[192:195], v39 offset:0
    ds_read_b128 v[196:199], v39 offset:1024
    ds_read_b128 v[200:203], v39 offset:2048
    ds_read_b128 v[204:207], v39 offset:3072
    ds_read_b128 v[208:211], v39 offset:4096
    ds_read_b128 v[212:215], v39 offset:5120
    ds_read_b128 v[216:219], v39 offset:6144
    ds_read_b128 v[220:223], v39 offset:7168
    ds_read_b128 v[224:227], v39 offset:8192
    ds_read_b128 v[228:231], v39 offset:9216
    ds_read_b128 v[232:235], v39 offset:10240
    ds_read_b128 v[236:239], v39 offset:11264
    ds_read_b128 v[240:243], v39 offset:12288
    ds_read_b128 v[244:247], v39 offset:13312
    ds_read_b128 v[248:251], v39 offset:14336
    ds_read_b128 v[252:255], v39 offset:15360
    s_waitcnt lgkmcnt(15)
    s_nop 0
    s_waitcnt lgkmcnt(15)
    v_max_f32 v44, v68, v6
    v_sub_f32 v46, v6, v44
    v_sub_f32 v44, v68, v44
    v_exp_f32 v46, v46
    v_exp_f32 v44, v44
    s_nop 0
    v_mul_f32 v7, v7, v46
    v_fma_f32 v7, v2, v44, v7
    v_rcp_f32 v7, v7
    s_nop 0
    v_mul_f32 v44, v44, v7
    v_mul_f32 v46, v46, v7
    s_waitcnt lgkmcnt(0)
    s_barrier
    v_pk_mul_f32 v[80:81], v[128:129], v[44:45] op_sel_hi:[1,0]
    v_pk_fma_f32 v[80:81], v[192:193], v[46:47], v[80:81] op_sel_hi:[1,0,1]
    v_pk_mul_f32 v[82:83], v[130:131], v[44:45] op_sel_hi:[1,0]
    v_pk_fma_f32 v[82:83], v[194:195], v[46:47], v[82:83] op_sel_hi:[1,0,1]
    v_cvt_pk_bf16_f32 v96, v80, v81
    v_cvt_pk_bf16_f32 v97, v82, v83
    v_pk_mul_f32 v[84:85], v[132:133], v[44:45] op_sel_hi:[1,0]
    v_pk_fma_f32 v[84:85], v[196:197], v[46:47], v[84:85] op_sel_hi:[1,0,1]
    v_pk_mul_f32 v[86:87], v[134:135], v[44:45] op_sel_hi:[1,0]
    v_pk_fma_f32 v[86:87], v[198:199], v[46:47], v[86:87] op_sel_hi:[1,0,1]
    v_cvt_pk_bf16_f32 v98, v84, v85
    v_cvt_pk_bf16_f32 v99, v86, v87
    s_sub_u32 s54, s73, 0
    s_cmp_gt_i32 s74, 0
    s_cselect_b32 s54, s54, s26
    s_cselect_b32 m0, s64, s76
    s_bitcmp1_b32 s75, 10
    s_cbranch_scc1 L_pfb80
    buffer_load_dwordx4 v78, s[16:19], s54 offen offset:0 nt lds
    buffer_load_dwordx4 v79, s[16:19], s54 offen offset:1024 nt lds
L_pfe80:
    v_pk_mul_f32 v[80:81], v[136:137], v[44:45] op_sel_hi:[1,0]
    v_pk_fma_f32 v[80:81], v[200:201], v[46:47], v[80:81] op_sel_hi:[1,0,1]
    v_pk_mul_f32 v[82:83], v[138:139], v[44:45] op_sel_hi:[1,0]
    v_pk_fma_f32 v[82:83], v[202:203], v[46:47], v[82:83] op_sel_hi:[1,0,1]
    v_cvt_pk_bf16_f32 v100, v80, v81
    v_cvt_pk_bf16_f32 v101, v82, v83
    v_pk_mul_f32 v[84:85], v[140:141], v[44:45] op_sel_hi:[1,0]
    v_pk_fma_f32 v[84:85], v[204:205], v[46:47], v[84:85] op_sel_hi:[1,0,1]
    v_pk_mul_f32 v[86:87], v[142:143], v[44:45] op_sel_hi:[1,0]
    v_pk_fma_f32 v[86:87], v[206:207], v[46:47], v[86:87] op_sel_hi:[1,0,1]
    v_cvt_pk_bf16_f32 v102, v84, v85
    v_cvt_pk_bf16_f32 v103, v86, v87
    v_pk_mul_f32 v[80:81], v[144:145], v[44:45] op_sel_hi:[1,0]
    v_pk_fma_f32 v[80:81], v[208:209], v[46:47], v[80:81] op_sel_hi:[1,0,1]
    v_pk_mul_f32 v[82:83], v[146:147], v[44:45] op_sel_hi:[1,0]
    v_pk_fma_f32 v[82:83], v[210:211], v[46:47], v[82:83] op_sel_hi:[1,0,1]
    v_cvt_pk_bf16_f32 v104, v80, v81
    v_cvt_pk_bf16_f32 v105, v82, v83
    v_pk_mul_f32 v[84:85], v[148:149], v[44:45] op_sel_hi:[1,0]
    v_pk_fma_f32 v[84:85], v[212:213], v[46:47], v[84:85] op_sel_hi:[1,0,1]
    v_pk_mul_f32 v[86:87], v[150:151], v[44:45] op_sel_hi:[1,0]
    v_pk_fma_f32 v[86:87], v[214:215], v[46:47], v[86:87] op_sel_hi:[1,0,1]
    v_cvt_pk_bf16_f32 v106, v84, v85
    v_cvt_pk_bf16_f32 v107, v86, v87
    s_sub_u32 s54, s73, 65536
    s_cmp_gt_i32 s74, 2
    s_cselect_b32 s54, s54, s26
    s_cselect_b32 m0, s62, s76
    s_bitcmp1_b32 s75, 10
    s_cbranch_scc1 L_pfb81
    buffer_load_dwordx4 v0, s[12:15], s54 offen offset:0 nt lds
    buffer_load_dwordx4 v1, s[12:15], s54 offen offset:1024 nt lds
L_pfe81:
    v_pk_mul_f32 v[80:81], v[152:153], v[44:45] op_sel_hi:[1,0]
    v_pk_fma_f32 v[80:81], v[216:217], v[46:47], v[80:81] op_sel_hi:[1,0,1]
    v_pk_mul_f32 v[82:83], v[154:155], v[44:45] op_sel_hi:[1,0]
    v_pk_fma_f32 v[82:83], v[218:219], v[46:47], v[82:83] op_sel_hi:[1,0,1]
    v_cvt_pk_bf16_f32 v108, v80, v81
    v_cvt_pk_bf16_f32 v109, v82, v83
    v_pk_mul_f32 v[84:85], v[156:157], v[44:45] op_sel_hi:[1,0]
    v_pk_fma_f32 v[84:85], v[220:221], v[46:47], v[84:85] op_sel_hi:[1,0,1]
    v_pk_mul_f32 v[86:87], v[158:159], v[44:45] op_sel_hi:[1,0]
    v_pk_fma_f32 v[86:87], v[222:223], v[46:47], v[86:87] op_sel_hi:[1,0,1]
    v_cvt_pk_bf16_f32 v110, v84, v85
    v_cvt_pk_bf16_f32 v111, v86, v87
    ds_write_b64 v88, v[96:97] offset:0
    ds_write_b64 v89, v[98:99] offset:0
    ds_write_b64 v90, v[100:101] offset:0
    ds_write_b64 v91, v[102:103] offset:0
    ds_write_b64 v92, v[104:105] offset:0
    ds_write_b64 v93, v[106:107] offset:0
    ds_write_b64 v94, v[108:109] offset:0
    ds_write_b64 v95, v[110:111] offset:0
    v_pk_mul_f32 v[80:81], v[160:161], v[44:45] op_sel_hi:[1,0]
    v_pk_fma_f32 v[80:81], v[224:225], v[46:47], v[80:81] op_sel_hi:[1,0,1]
    v_pk_mul_f32 v[82:83], v[162:163], v[44:45] op_sel_hi:[1,0]
    v_pk_fma_f32 v[82:83], v[226:227], v[46:47], v[82:83] op_sel_hi:[1,0,1]
    v_cvt_pk_bf16_f32 v96, v80, v81
    v_cvt_pk_bf16_f32 v97, v82, v83
    v_pk_mul_f32 v[84:85], v[164:165], v[44:45] op_sel_hi:[1,0]
    v_pk_fma_f32 v[84:85], v[228:229], v[46:47], v[84:85] op_sel_hi:[1,0,1]
    v_pk_mul_f32 v[86:87], v[166:167], v[44:45] op_sel_hi:[1,0]
    v_pk_fma_f32 v[86:87], v[230:231], v[46:47], v[86:87] op_sel_hi:[1,0,1]
    v_cvt_pk_bf16_f32 v98, v84, v85
    v_cvt_pk_bf16_f32 v99, v86, v87
    s_sub_u32 s54, s73, 32768
    s_cmp_gt_i32 s74, 1
    s_cselect_b32 s54, s54, s26
    s_cselect_b32 m0, s65, s76
    s_bitcmp1_b32 s75, 10
    s_cbranch_scc1 L_pfb82
    buffer_load_dwordx4 v78, s[16:19], s54 offen offset:0 nt lds
    buffer_load_dwordx4 v79, s[16:19], s54 offen offset:1024 nt lds
L_pfe82:
    v_pk_mul_f32 v[80:81], v[168:169], v[44:45] op_sel_hi:[1,0]
    v_pk_fma_f32 v[80:81], v[232:233], v[46:47], v[80:81] op_sel_hi:[1,0,1]
    v_pk_mul_f32 v[82:83], v[170:171], v[44:45] op_sel_hi:[1,0]
    v_pk_fma_f32 v[82:83], v[234:235], v[46:47], v[82:83] op_sel_hi:[1,0,1]
    v_cvt_pk_bf16_f32 v100, v80, v81
    v_cvt_pk_bf16_f32 v101, v82, v83
    v_pk_mul_f32 v[84:85], v[172:173], v[44:45] op_sel_hi:[1,0]
    v_pk_fma_f32 v[84:85], v[236:237], v[46:47], v[84:85] op_sel_hi:[1,0,1]
    v_pk_mul_f32 v[86:87], v[174:175], v[44:45] op_sel_hi:[1,0]
    v_pk_fma_f32 v[86:87], v[238:239], v[46:47], v[86:87] op_sel_hi:[1,0,1]
    v_cvt_pk_bf16_f32 v102, v84, v85
    v_cvt_pk_bf16_f32 v103, v86, v87
    v_pk_mul_f32 v[80:81], v[176:177], v[44:45] op_sel_hi:[1,0]
    v_pk_fma_f32 v[80:81], v[240:241], v[46:47], v[80:81] op_sel_hi:[1,0,1]
    v_pk_mul_f32 v[82:83], v[178:179], v[44:45] op_sel_hi:[1,0]
    v_pk_fma_f32 v[82:83], v[242:243], v[46:47], v[82:83] op_sel_hi:[1,0,1]
    v_cvt_pk_bf16_f32 v104, v80, v81
    v_cvt_pk_bf16_f32 v105, v82, v83
    v_pk_mul_f32 v[84:85], v[180:181], v[44:45] op_sel_hi:[1,0]
    v_pk_fma_f32 v[84:85], v[244:245], v[46:47], v[84:85] op_sel_hi:[1,0,1]
    v_pk_mul_f32 v[86:87], v[182:183], v[44:45] op_sel_hi:[1,0]
    v_pk_fma_f32 v[86:87], v[246:247], v[46:47], v[86:87] op_sel_hi:[1,0,1]
    v_cvt_pk_bf16_f32 v106, v84, v85
    v_cvt_pk_bf16_f32 v107, v86, v87
    s_sub_u32 s54, s73, 98304
    s_cmp_gt_i32 s74, 3
    s_cselect_b32 s54, s54, s26
    s_cselect_b32 m0, s63, s76
    s_bitcmp1_b32 s75, 10
    s_cbranch_scc1 L_pfb83
    buffer_load_dwordx4 v0, s[12:15], s54 offen offset:0 nt lds
    buffer_load_dwordx4 v1, s[12:15], s54 offen offset:1024 nt lds
L_pfe83:
    v_pk_mul_f32 v[80:81], v[184:185], v[44:45] op_sel_hi:[1,0]
    v_pk_fma_f32 v[80:81], v[248:249], v[46:47], v[80:81] op_sel_hi:[1,0,1]
    v_pk_mul_f32 v[82:83], v[186:187], v[44:45] op_sel_hi:[1,0]
    v_pk_fma_f32 v[82:83], v[250:251], v[46:47], v[82:83] op_sel_hi:[1,0,1]
    v_cvt_pk_bf16_f32 v108, v80, v81
    v_cvt_pk_bf16_f32 v109, v82, v83
    v_pk_mul_f32 v[84:85], v[188:189], v[44:45] op_sel_hi:[1,0]
    v_pk_fma_f32 v[84:85], v[252:253], v[46:47], v[84:85] op_sel_hi:[1,0,1]
    v_pk_mul_f32 v[86:87], v[190:191], v[44:45] op_sel_hi:[1,0]
    v_pk_fma_f32 v[86:87], v[254:255], v[46:47], v[86:87] op_sel_hi:[1,0,1]
    v_cvt_pk_bf16_f32 v110, v84, v85
    v_cvt_pk_bf16_f32 v111, v86, v87
    ds_read_b128 v[112:115], v37 offset:0
    ds_read_b64 v[116:117], v37 offset:1032
    ds_read_b64 v[118:119], v37 offset:1024
    ds_read_b128 v[120:123], v37 offset:2048
    ds_read_b64 v[124:125], v37 offset:3080
    ds_read_b64 v[126:127], v37 offset:3072
    ds_write_b64 v88, v[96:97] offset:4096
    ds_write_b64 v89, v[98:99] offset:4096
    ds_write_b64 v90, v[100:101] offset:4096
    ds_write_b64 v91, v[102:103] offset:4096
    ds_write_b64 v92, v[104:105] offset:4096
    ds_write_b64 v93, v[106:107] offset:4096
    ds_write_b64 v94, v[108:109] offset:4096
    ds_write_b64 v95, v[110:111] offset:4096
    s_waitcnt lgkmcnt(8)
    buffer_store_dwordx4 v[112:115], v32, s[20:23], s40 offen offset:0 sc0 sc1
    buffer_store_dwordx4 v[116:119], v33, s[20:23], s40 offen offset:0 sc0 sc1
    buffer_store_dwordx4 v[120:123], v34, s[20:23], s40 offen offset:0 sc0 sc1
    buffer_store_dwordx4 v[124:127], v35, s[20:23], s40 offen offset:0 sc0 sc1
    ds_read_b128 v[112:115], v37 offset:4096
    ds_read_b64 v[116:117], v37 offset:5128
    ds_read_b64 v[118:119], v37 offset:5120
    ds_read_b128 v[120:123], v37 offset:6144
    ds_read_b64 v[124:125], v37 offset:7176
    ds_read_b64 v[126:127], v37 offset:7168
    s_waitcnt lgkmcnt(0)
    buffer_store_dwordx4 v[112:115], v32, s[20:23], s40 offen offset:128 sc0 sc1
    buffer_store_dwordx4 v[116:119], v33, s[20:23], s40 offen offset:128 sc0 sc1
    buffer_store_dwordx4 v[120:123], v34, s[20:23], s40 offen offset:128 sc0 sc1
    buffer_store_dwordx4 v[124:127], v35, s[20:23], s40 offen offset:128 sc0 sc1
    s_mov_b32 s4, 1
    s_branch L_job
L_epiB_1:
    v_mov_b32 v6, v68
    v_mov_b32 v7, v2
    s_nop 7
    ds_write_b64 v40, v[6:7]
    ds_write_b128 v38, v[128:131] offset:0
    ds_write_b128 v38, v[132:135] offset:1024
    ds_write_b128 v38, v[136:139] offset:2048
    ds_write_b128 v38, v[140:143] offset:3072
    ds_write_b128 v38, v[144:147] offset:4096
    ds_write_b128 v38, v[148:151] offset:5120
    ds_write_b128 v38, v[152:155] offset:6144
    ds_write_b128 v38, v[156:159] offset:7168
    ds_write_b128 v38, v[160:163] offset:8192
    ds_write_b128 v38, v[164:167] offset:9216
    ds_write_b128 v38, v[168:171] offset:10240
    ds_write_b128 v38, v[172:175] offset:11264
    ds_write_b128 v38, v[176:179] offset:12288
    ds_write_b128 v38, v[180:183] offset:13312
    ds_write_b128 v38, v[184:187] offset:14336
    ds_write_b128 v38, v[188:191] offset:15360
    s_waitcnt lgkmcnt(0)
    s_barrier
    ds_read_b64 v[6:7], v41
    ds_read_b128 v[128:131], v39 offset:0
    ds_read_b128 v[132:135], v39 offset:1024
    ds_read_b128 v[136:139], v39 offset:2048
    ds_read_b128 v[140:143], v39 offset:3072
    ds_read_b128 v[144:147], v39 offset:4096
    ds_read_b128 v[148:151], v39 offset:5120
    ds_read_b128 v[152:155], v39 offset:6144
    ds_read_b128 v[156:159], v39 offset:7168
    ds_read_b128 v[160:163], v39 offset:8192
    ds_read_b128 v[164:167], v39 offset:9216
    ds_read_b128 v[168:171], v39 offset:10240
    ds_read_b128 v[172:175], v39 offset:11264
    ds_read_b128 v[176:179], v39 offset:12288
    ds_read_b128 v[180:183], v39 offset:13312
    ds_read_b128 v[184:187], v39 offset:14336
    ds_read_b128 v[188:191], v39 offset:15360
    s_waitcnt lgkmcnt(15)
    s_nop 0
    s_waitcnt lgkmcnt(15)
    v_max_f32 v44, v69, v6
    v_sub_f32 v46, v6, v44
    v_sub_f32 v44, v69, v44
    v_exp_f32 v46, v46
    v_exp_f32 v44, v44
    s_nop 0
    v_mul_f32 v7, v7, v46
    v_fma_f32 v7, v4, v44, v7
    v_rcp_f32 v7, v7
    s_nop 0
    v_mul_f32 v44, v44, v7
    v_mul_f32 v46, v46, v7
    s_waitcnt lgkmcnt(0)
    s_barrier
    v_pk_mul_f32 v[80:81], v[192:193], v[44:45] op_sel_hi:[1,0]
    v_pk_fma_f32 v[80:81], v[128:129], v[46:47], v[80:81] op_sel_hi:[1,0,1]
    v_pk_mul_f32 v[82:83], v[194:195], v[44:45] op_sel_hi:[1,0]
    v_pk_fma_f32 v[82:83], v[130:131], v[46:47], v[82:83] op_sel_hi:[1,0,1]
    v_cvt_pk_bf16_f32 v96, v80, v81
    v_cvt_pk_bf16_f32 v97, v82, v83
    v_pk_mul_f32 v[84:85], v[196:197], v[44:45] op_sel_hi:[1,0]
    v_pk_fma_f32 v[84:85], v[132:133], v[46:47], v[84:85] op_sel_hi:[1,0,1]
    v_pk_mul_f32 v[86:87], v[198:199], v[44:45] op_sel_hi:[1,0]
    v_pk_fma_f32 v[86:87], v[134:135], v[46:47], v[86:87] op_sel_hi:[1,0,1]
    v_cvt_pk_bf16_f32 v98, v84, v85
    v_cvt_pk_bf16_f32 v99, v86, v87
    s_sub_u32 s54, s73, 0
    s_cmp_gt_i32 s74, 0
    s_cselect_b32 s54, s54, s26
    s_cselect_b32 m0, s64, s76
    s_bitcmp1_b32 s75, 10
    s_cbranch_scc1 L_pfb84
    buffer_load_dwordx4 v78, s[16:19], s54 offen offset:0 nt lds
    buffer_load_dwordx4 v79, s[16:19], s54 offen offset:1024 nt lds
L_pfe84:
    v_pk_mul_f32 v[80:81], v[200:201], v[44:45] op_sel_hi:[1,0]
    v_pk_fma_f32 v[80:81], v[136:137], v[46:47], v[80:81] op_sel_hi:[1,0,1]
    v_pk_mul_f32 v[82:83], v[202:203], v[44:45] op_sel_hi:[1,0]
    v_pk_fma_f32 v[82:83], v[138:139], v[46:47], v[82:83] op_sel_hi:[1,0,1]
    v_cvt_pk_bf16_f32 v100, v80, v81
    v_cvt_pk_bf16_f32 v101, v82, v83
    v_pk_mul_f32 v[84:85], v[204:205], v[44:45] op_sel_hi:[1,0]
    v_pk_fma_f32 v[84:85], v[140:141], v[46:47], v[84:85] op_sel_hi:[1,0,1]
    v_pk_mul_f32 v[86:87], v[206:207], v[44:45] op_sel_hi:[1,0]
    v_pk_fma_f32 v[86:87], v[142:143], v[46:47], v[86:87] op_sel_hi:[1,0,1]
    v_cvt_pk_bf16_f32 v102, v84, v85
    v_cvt_pk_bf16_f32 v103, v86, v87
    v_pk_mul_f32 v[80:81], v[208:209], v[44:45] op_sel_hi:[1,0]
    v_pk_fma_f32 v[80:81], v[144:145], v[46:47], v[80:81] op_sel_hi:[1,0,1]
    v_pk_mul_f32 v[82:83], v[210:211], v[44:45] op_sel_hi:[1,0]
    v_pk_fma_f32 v[82:83], v[146:147], v[46:47], v[82:83] op_sel_hi:[1,0,1]
    v_cvt_pk_bf16_f32 v104, v80, v81
    v_cvt_pk_bf16_f32 v105, v82, v83
    v_pk_mul_f32 v[84:85], v[212:213], v[44:45] op_sel_hi:[1,0]
    v_pk_fma_f32 v[84:85], v[148:149], v[46:47], v[84:85] op_sel_hi:[1,0,1]
    v_pk_mul_f32 v[86:87], v[214:215], v[44:45] op_sel_hi:[1,0]
    v_pk_fma_f32 v[86:87], v[150:151], v[46:47], v[86:87] op_sel_hi:[1,0,1]
    v_cvt_pk_bf16_f32 v106, v84, v85
    v_cvt_pk_bf16_f32 v107, v86, v87
    s_sub_u32 s54, s73, 65536
    s_cmp_gt_i32 s74, 2
    s_cselect_b32 s54, s54, s26
    s_cselect_b32 m0, s62, s76
    s_bitcmp1_b32 s75, 10
    s_cbranch_scc1 L_pfb85
    buffer_load_dwordx4 v0, s[12:15], s54 offen offset:0 nt lds
    buffer_load_dwordx4 v1, s[12:15], s54 offen offset:1024 nt lds
L_pfe85:
    v_pk_mul_f32 v[80:81], v[216:217], v[44:45] op_sel_hi:[1,0]
    v_pk_fma_f32 v[80:81], v[152:153], v[46:47], v[80:81] op_sel_hi:[1,0,1]
    v_pk_mul_f32 v[82:83], v[218:219], v[44:45] op_sel_hi:[1,0]
    v_pk_fma_f32 v[82:83], v[154:155], v[46:47], v[82:83] op_sel_hi:[1,0,1]
    v_cvt_pk_bf16_f32 v108, v80, v81
    v_cvt_pk_bf16_f32 v109, v82, v83
    v_pk_mul_f32 v[84:85], v[220:221], v[44:45] op_sel_hi:[1,0]
    v_pk_fma_f32 v[84:85], v[156:157], v[46:47], v[84:85] op_sel_hi:[1,0,1]
    v_pk_mul_f32 v[86:87], v[222:223], v[44:45] op_sel_hi:[1,0]
    v_pk_fma_f32 v[86:87], v[158:159], v[46:47], v[86:87] op_sel_hi:[1,0,1]
    v_cvt_pk_bf16_f32 v110, v84, v85
    v_cvt_pk_bf16_f32 v111, v86, v87
    ds_write_b64 v88, v[96:97] offset:0
    ds_write_b64 v89, v[98:99] offset:0
    ds_write_b64 v90, v[100:101] offset:0
    ds_write_b64 v91, v[102:103] offset:0
    ds_write_b64 v92, v[104:105] offset:0
    ds_write_b64 v93, v[106:107] offset:0
    ds_write_b64 v94, v[108:109] offset:0
    ds_write_b64 v95, v[110:111] offset:0
    v_pk_mul_f32 v[80:81], v[224:225], v[44:45] op_sel_hi:[1,0]
    v_pk_fma_f32 v[80:81], v[160:161], v[46:47], v[80:81] op_sel_hi:[1,0,1]
    v_pk_mul_f32 v[82:83], v[226:227], v[44:45] op_sel_hi:[1,0]
    v_pk_fma_f32 v[82:83], v[162:163], v[46:47], v[82:83] op_sel_hi:[1,0,1]
    v_cvt_pk_bf16_f32 v96, v80, v81
    v_cvt_pk_bf16_f32 v97, v82, v83
    v_pk_mul_f32 v[84:85], v[228:229], v[44:45] op_sel_hi:[1,0]
    v_pk_fma_f32 v[84:85], v[164:165], v[46:47], v[84:85] op_sel_hi:[1,0,1]
    v_pk_mul_f32 v[86:87], v[230:231], v[44:45] op_sel_hi:[1,0]
    v_pk_fma_f32 v[86:87], v[166:167], v[46:47], v[86:87] op_sel_hi:[1,0,1]
    v_cvt_pk_bf16_f32 v98, v84, v85
    v_cvt_pk_bf16_f32 v99, v86, v87
    s_sub_u32 s54, s73, 32768
    s_cmp_gt_i32 s74, 1
    s_cselect_b32 s54, s54, s26
    s_cselect_b32 m0, s65, s76
    s_bitcmp1_b32 s75, 10
    s_cbranch_scc1 L_pfb86
    buffer_load_dwordx4 v78, s[16:19], s54 offen offset:0 nt lds
    buffer_load_dwordx4 v79, s[16:19], s54 offen offset:1024 nt lds
L_pfe86:
    v_pk_mul_f32 v[80:81], v[232:233], v[44:45] op_sel_hi:[1,0]
    v_pk_fma_f32 v[80:81], v[168:169], v[46:47], v[80:81] op_sel_hi:[1,0,1]
    v_pk_mul_f32 v[82:83], v[234:235], v[44:45] op_sel_hi:[1,0]
    v_pk_fma_f32 v[82:83], v[170:171], v[46:47], v[82:83] op_sel_hi:[1,0,1]
    v_cvt_pk_bf16_f32 v100, v80, v81
    v_cvt_pk_bf16_f32 v101, v82, v83
    v_pk_mul_f32 v[84:85], v[236:237], v[44:45] op_sel_hi:[1,0]
    v_pk_fma_f32 v[84:85], v[172:173], v[46:47], v[84:85] op_sel_hi:[1,0,1]
    v_pk_mul_f32 v[86:87], v[238:239], v[44:45] op_sel_hi:[1,0]
    v_pk_fma_f32 v[86:87], v[174:175], v[46:47], v[86:87] op_sel_hi:[1,0,1]
    v_cvt_pk_bf16_f32 v102, v84, v85
    v_cvt_pk_bf16_f32 v103, v86, v87
    v_pk_mul_f32 v[80:81], v[240:241], v[44:45] op_sel_hi:[1,0]
    v_pk_fma_f32 v[80:81], v[176:177], v[46:47], v[80:81] op_sel_hi:[1,0,1]
    v_pk_mul_f32 v[82:83], v[242:243], v[44:45] op_sel_hi:[1,0]
    v_pk_fma_f32 v[82:83], v[178:179], v[46:47], v[82:83] op_sel_hi:[1,0,1]
    v_cvt_pk_bf16_f32 v104, v80, v81
    v_cvt_pk_bf16_f32 v105, v82, v83
    v_pk_mul_f32 v[84:85], v[244:245], v[44:45] op_sel_hi:[1,0]
    v_pk_fma_f32 v[84:85], v[180:181], v[46:47], v[84:85] op_sel_hi:[1,0,1]
    v_pk_mul_f32 v[86:87], v[246:247], v[44:45] op_sel_hi:[1,0]
    v_pk_fma_f32 v[86:87], v[182:183], v[46:47], v[86:87] op_sel_hi:[1,0,1]
    v_cvt_pk_bf16_f32 v106, v84, v85
    v_cvt_pk_bf16_f32 v107, v86, v87
    s_sub_u32 s54, s73, 98304
    s_cmp_gt_i32 s74, 3
    s_cselect_b32 s54, s54, s26
    s_cselect_b32 m0, s63, s76
    s_bitcmp1_b32 s75, 10
    s_cbranch_scc1 L_pfb87
    buffer_load_dwordx4 v0, s[12:15], s54 offen offset:0 nt lds
    buffer_load_dwordx4 v1, s[12:15], s54 offen offset:1024 nt lds
L_pfe87:
    v_pk_mul_f32 v[80:81], v[248:249], v[44:45] op_sel_hi:[1,0]
    v_pk_fma_f32 v[80:81], v[184:185], v[46:47], v[80:81] op_sel_hi:[1,0,1]
    v_pk_mul_f32 v[82:83], v[250:251], v[44:45] op_sel_hi:[1,0]
    v_pk_fma_f32 v[82:83], v[186:187], v[46:47], v[82:83] op_sel_hi:[1,0,1]
    v_cvt_pk_bf16_f32 v108, v80, v81
    v_cvt_pk_bf16_f32 v109, v82, v83
    v_pk_mul_f32 v[84:85], v[252:253], v[44:45] op_sel_hi:[1,0]
    v_pk_fma_f32 v[84:85], v[188:189], v[46:47], v[84:85] op_sel_hi:[1,0,1]
    v_pk_mul_f32 v[86:87], v[254:255], v[44:45] op_sel_hi:[1,0]
    v_pk_fma_f32 v[86:87], v[190:191], v[46:47], v[86:87] op_sel_hi:[1,0,1]
    v_cvt_pk_bf16_f32 v110, v84, v85
    v_cvt_pk_bf16_f32 v111, v86, v87
    ds_read_b128 v[112:115], v37 offset:0
    ds_read_b64 v[116:117], v37 offset:1032
    ds_read_b64 v[118:119], v37 offset:1024
    ds_read_b128 v[120:123], v37 offset:2048
    ds_read_b64 v[124:125], v37 offset:3080
    ds_read_b64 v[126:127], v37 offset:3072
    ds_write_b64 v88, v[96:97] offset:4096
    ds_write_b64 v89, v[98:99] offset:4096
    ds_write_b64 v90, v[100:101] offset:4096
    ds_write_b64 v91, v[102:103] offset:4096
    ds_write_b64 v92, v[104:105] offset:4096
    ds_write_b64 v93, v[106:107] offset:4096
    ds_write_b64 v94, v[108:109] offset:4096
    ds_write_b64 v95, v[110:111] offset:4096
    s_waitcnt lgkmcnt(8)
    buffer_store_dwordx4 v[112:115], v32, s[20:23], s40 offen offset:256 sc0 sc1
    buffer_store_dwordx4 v[116:119], v33, s[20:23], s40 offen offset:256 sc0 sc1
    buffer_store_dwordx4 v[120:123], v34, s[20:23], s40 offen offset:256 sc0 sc1
    buffer_store_dwordx4 v[124:127], v35, s[20:23], s40 offen offset:256 sc0 sc1
    ds_read_b128 v[112:115], v37 offset:4096
    ds_read_b64 v[116:117], v37 offset:5128
    ds_read_b64 v[118:119], v37 offset:5120
    ds_read_b128 v[120:123], v37 offset:6144
    ds_read_b64 v[124:125], v37 offset:7176
    ds_read_b64 v[126:127], v37 offset:7168
    s_waitcnt lgkmcnt(0)
    buffer_store_dwordx4 v[112:115], v32, s[20:23], s40 offen offset:384 sc0 sc1
    buffer_store_dwordx4 v[116:119], v33, s[20:23], s40 offen offset:384 sc0 sc1
    buffer_store_dwordx4 v[120:123], v34, s[20:23], s40 offen offset:384 sc0 sc1
    buffer_store_dwordx4 v[124:127], v35, s[20:23], s40 offen offset:384 sc0 sc1
    s_mov_b32 s4, 1
    s_branch L_job
L_pfb80:
    buffer_load_dwordx4 v52, s[16:19], s54 offen offset:0 nt lds
    buffer_load_dwordx4 v53, s[16:19], s54 offen offset:1024 nt lds
    buffer_load_dwordx4 v54, s[16:19], s54 offen offset:2048 nt lds
    buffer_load_dwordx4 v55, s[16:19], s54 offen offset:3072 nt lds
    s_branch L_pfe80
L_pfb81:
    buffer_load_dwordx4 v48, s[12:15], s54 offen offset:0 nt lds
    buffer_load_dwordx4 v49, s[12:15], s54 offen offset:1024 nt lds
    buffer_load_dwordx4 v50, s[12:15], s54 offen offset:2048 nt lds
    buffer_load_dwordx4 v51, s[12:15], s54 offen offset:3072 nt lds
    s_branch L_pfe81
L_pfb82:
    buffer_load_dwordx4 v52, s[16:19], s54 offen offset:0 nt lds
    buffer_load_dwordx4 v53, s[16:19], s54 offen offset:1024 nt lds
    buffer_load_dwordx4 v54, s[16:19], s54 offen offset:2048 nt lds
    buffer_load_dwordx4 v55, s[16:19], s54 offen offset:3072 nt lds
    s_branch L_pfe82
L_pfb83:
    buffer_load_dwordx4 v48, s[12:15], s54 offen offset:0 nt lds
    buffer_load_dwordx4 v49, s[12:15], s54 offen offset:1024 nt lds
    buffer_load_dwordx4 v50, s[12:15], s54 offen offset:2048 nt lds
    buffer_load_dwordx4 v51, s[12:15], s54 offen offset:3072 nt lds
    s_branch L_pfe83
L_pfb84:
    buffer_load_dwordx4 v52, s[16:19], s54 offen offset:0 nt lds
    buffer_load_dwordx4 v53, s[16:19], s54 offen offset:1024 nt lds
    buffer_load_dwordx4 v54, s[16:19], s54 offen offset:2048 nt lds
    buffer_load_dwordx4 v55, s[16:19], s54 offen offset:3072 nt lds
    s_branch L_pfe84
L_pfb85:
    buffer_load_dwordx4 v48, s[12:15], s54 offen offset:0 nt lds
    buffer_load_dwordx4 v49, s[12:15], s54 offen offset:1024 nt lds
    buffer_load_dwordx4 v50, s[12:15], s54 offen offset:2048 nt lds
    buffer_load_dwordx4 v51, s[12:15], s54 offen offset:3072 nt lds
    s_branch L_pfe85
L_pfb86:
    buffer_load_dwordx4 v52, s[16:19], s54 offen offset:0 nt lds
    buffer_load_dwordx4 v53, s[16:19], s54 offen offset:1024 nt lds
    buffer_load_dwordx4 v54, s[16:19], s54 offen offset:2048 nt lds
    buffer_load_dwordx4 v55, s[16:19], s54 offen offset:3072 nt lds
    s_branch L_pfe86
L_pfb87:
    buffer_load_dwordx4 v48, s[12:15], s54 offen offset:0 nt lds
    buffer_load_dwordx4 v49, s[12:15], s54 offen offset:1024 nt lds
    buffer_load_dwordx4 v50, s[12:15], s54 offen offset:2048 nt lds
    buffer_load_dwordx4 v51, s[12:15], s54 offen offset:3072 nt lds
    s_branch L_pfe87
L_rare_0_0:
    s_nop 15
    v_max3_f32 v2, v96, v97, v98
    v_max3_f32 v2, v2, v99, v100
    v_max3_f32 v2, v2, v101, v102
    v_max3_f32 v2, v2, v103, v104
    v_max3_f32 v2, v2, v105, v106
    v_max3_f32 v2, v2, v107, v108
    v_max3_f32 v2, v2, v109, v110
    v_max_f32 v2, v2, v111
    v_mov_b32 v3, v2
    s_nop 1
    v_permlane32_swap_b32 v2, v3
    v_max_f32 v2, v2, v3
    v_mul_f32 v2, s24, v2
    v_max_f32 v2, v2, v68
    v_sub_f32 v3, v68, v2
    v_exp_f32 v3, v3
    v_mov_b32 v68, v2
    v_mul_f32 v70, v3, v71
    v_mul_f32 v128, v3, v128
    v_mul_f32 v129, v3, v129
    v_mul_f32 v130, v3, v130
    v_mul_f32 v131, v3, v131
    v_mul_f32 v132, v3, v132
    v_mul_f32 v133, v3, v133
    v_mul_f32 v134, v3, v134
    v_mul_f32 v135, v3, v135
    v_mul_f32 v136, v3, v136
    v_mul_f32 v137, v3, v137
    v_mul_f32 v138, v3, v138
    v_mul_f32 v139, v3, v139
    v_mul_f32 v140, v3, v140
    v_mul_f32 v141, v3, v141
    v_mul_f32 v142, v3, v142
    v_mul_f32 v143, v3, v143
    v_mul_f32 v144, v3, v144
    v_mul_f32 v145, v3, v145
    v_mul_f32 v146, v3, v146
    v_mul_f32 v147, v3, v147
    v_mul_f32 v148, v3, v148
    v_mul_f32 v149, v3, v149
    v_mul_f32 v150, v3, v150
    v_mul_f32 v151, v3, v151
    v_mul_f32 v152, v3, v152
    v_mul_f32 v153, v3, v153
    v_mul_f32 v154, v3, v154
    v_mul_f32 v155, v3, v155
    v_mul_f32 v156, v3, v156
    v_mul_f32 v157, v3, v157
    v_mul_f32 v158, v3, v158
    v_mul_f32 v159, v3, v159
    v_mul_f32 v160, v3, v160
    v_mul_f32 v161, v3, v161
    v_mul_f32 v162, v3, v162
    v_mul_f32 v163, v3, v163
    v_mul_f32 v164, v3, v164
    v_mul_f32 v165, v3, v165
    v_mul_f32 v166, v3, v166
    v_mul_f32 v167, v3, v167
    v_mul_f32 v168, v3, v168
    v_mul_f32 v169, v3, v169
    v_mul_f32 v170, v3, v170
    v_mul_f32 v171, v3, v171
    v_mul_f32 v172, v3, v172
    v_mul_f32 v173, v3, v173
    v_mul_f32 v174, v3, v174
    v_mul_f32 v175, v3, v175
    v_mul_f32 v176, v3, v176
    v_mul_f32 v177, v3, v177
    v_mul_f32 v178, v3, v178
    v_mul_f32 v179, v3, v179
    v_mul_f32 v180, v3, v180
    v_mul_f32 v181, v3, v181
    v_mul_f32 v182, v3, v182
    v_mul_f32 v183, v3, v183
    v_mul_f32 v184, v3, v184
    v_mul_f32 v185, v3, v185
    v_mul_f32 v186, v3, v186
    v_mul_f32 v187, v3, v187
    v_mul_f32 v188, v3, v188
    v_mul_f32 v189, v3, v189
    v_mul_f32 v190, v3, v190
    v_mul_f32 v191, v3, v191
    v_fma_f32 v4, v96, s24, -v68
    v_fma_f32 v5, v97, s24, -v68
    v_exp_f32 v4, v4
    v_exp_f32 v5, v5
    s_nop 0
    v_add_f32 v70, v70, v4
    v_add_f32 v70, v70, v5
    v_cvt_pk_bf16_f32 v80, v4, v5
    v_fma_f32 v4, v98, s24, -v68
    v_fma_f32 v5, v99, s24, -v68
    v_exp_f32 v4, v4
    v_exp_f32 v5, v5
    s_nop 0
    v_add_f32 v70, v70, v4
    v_add_f32 v70, v70, v5
    v_cvt_pk_bf16_f32 v81, v4, v5
    v_fma_f32 v4, v100, s24, -v68
    v_fma_f32 v5, v101, s24, -v68
    v_exp_f32 v4, v4
    v_exp_f32 v5, v5
    s_nop 0
    v_add_f32 v70, v70, v4
    v_add_f32 v70, v70, v5
    v_cvt_pk_bf16_f32 v82, v4, v5
    v_fma_f32 v4, v102, s24, -v68
    v_fma_f32 v5, v103, s24, -v68
    v_exp_f32 v4, v4
    v_exp_f32 v5, v5
    s_nop 0
    v_add_f32 v70, v70, v4
    v_add_f32 v70, v70, v5
    v_cvt_pk_bf16_f32 v83, v4, v5
    v_fma_f32 v4, v104, s24, -v68
    v_fma_f32 v5, v105, s24, -v68
    v_exp_f32 v4, v4
    v_exp_f32 v5, v5
    s_nop 0
    v_add_f32 v70, v70, v4
    v_add_f32 v70, v70, v5
    v_cvt_pk_bf16_f32 v84, v4, v5
    v_fma_f32 v4, v106, s24, -v68
    v_fma_f32 v5, v107, s24, -v68
    v_exp_f32 v4, v4
    v_exp_f32 v5, v5
    s_nop 0
    v_add_f32 v70, v70, v4
    v_add_f32 v70, v70, v5
    v_cvt_pk_bf16_f32 v85, v4, v5
    v_fma_f32 v4, v108, s24, -v68
    v_fma_f32 v5, v109, s24, -v68
    v_exp_f32 v4, v4
    v_exp_f32 v5, v5
    s_nop 0
    v_add_f32 v70, v70, v4
    v_add_f32 v70, v70, v5
    v_cvt_pk_bf16_f32 v86, v4, v5
    v_fma_f32 v4, v110, s24, -v68
    v_fma_f32 v5, v111, s24, -v68
    v_exp_f32 v4, v4
    v_exp_f32 v5, v5
    s_nop 0
    v_add_f32 v70, v70, v4
    v_add_f32 v70, v70, v5
    v_cvt_pk_bf16_f32 v87, v4, v5
    s_nop 1
    s_setpc_b64 s[30:31]
L_rare_0_1:
    s_nop 15
    v_max3_f32 v2, v96, v97, v98
    v_max3_f32 v2, v2, v99, v100
    v_max3_f32 v2, v2, v101, v102
    v_max3_f32 v2, v2, v103, v104
    v_max3_f32 v2, v2, v105, v106
    v_max3_f32 v2, v2, v107, v108
    v_max3_f32 v2, v2, v109, v110
    v_max_f32 v2, v2, v111
    v_mov_b32 v3, v2
    s_nop 1
    v_permlane32_swap_b32 v2, v3
    v_max_f32 v2, v2, v3
    v_mul_f32 v2, s24, v2
    v_max_f32 v2, v2, v68
    v_sub_f32 v3, v68, v2
    v_exp_f32 v3, v3
    v_mov_b32 v68, v2
    v_mul_f32 v71, v3, v70
    v_mul_f32 v128, v3, v128
    v_mul_f32 v129, v3, v129
    v_mul_f32 v130, v3, v130
    v_mul_f32 v131, v3, v131
    v_mul_f32 v132, v3, v132
    v_mul_f32 v133, v3, v133
    v_mul_f32 v134, v3, v134
    v_mul_f32 v135, v3, v135
    v_mul_f32 v136, v3, v136
    v_mul_f32 v137, v3, v137
    v_mul_f32 v138, v3, v138
    v_mul_f32 v139, v3, v139
    v_mul_f32 v140, v3, v140
    v_mul_f32 v141, v3, v141
    v_mul_f32 v142, v3, v142
    v_mul_f32 v143, v3, v143
    v_mul_f32 v144, v3, v144
    v_mul_f32 v145, v3, v145
    v_mul_f32 v146, v3, v146
    v_mul_f32 v147, v3, v147
    v_mul_f32 v148, v3, v148
    v_mul_f32 v149, v3, v149
    v_mul_f32 v150, v3, v150
    v_mul_f32 v151, v3, v151
    v_mul_f32 v152, v3, v152
    v_mul_f32 v153, v3, v153
    v_mul_f32 v154, v3, v154
    v_mul_f32 v155, v3, v155
    v_mul_f32 v156, v3, v156
    v_mul_f32 v157, v3, v157
    v_mul_f32 v158, v3, v158
    v_mul_f32 v159, v3, v159
    v_mul_f32 v160, v3, v160
    v_mul_f32 v161, v3, v161
    v_mul_f32 v162, v3, v162
    v_mul_f32 v163, v3, v163
    v_mul_f32 v164, v3, v164
    v_mul_f32 v165, v3, v165
    v_mul_f32 v166, v3, v166
    v_mul_f32 v167, v3, v167
    v_mul_f32 v168, v3, v168
    v_mul_f32 v169, v3, v169
    v_mul_f32 v170, v3, v170
    v_mul_f32 v171, v3, v171
    v_mul_f32 v172, v3, v172
    v_mul_f32 v173, v3, v173
    v_mul_f32 v174, v3, v174
    v_mul_f32 v175, v3, v175
    v_mul_f32 v176, v3, v176
    v_mul_f32 v177, v3, v177
    v_mul_f32 v178, v3, v178
    v_mul_f32 v179, v3, v179
    v_mul_f32 v180, v3, v180
    v_mul_f32 v181, v3, v181
    v_mul_f32 v182, v3, v182
    v_mul_f32 v183, v3, v183
    v_mul_f32 v184, v3, v184
    v_mul_f32 v185, v3, v185
    v_mul_f32 v186, v3, v186
    v_mul_f32 v187, v3, v187
    v_mul_f32 v188, v3, v188
    v_mul_f32 v189, v3, v189
    v_mul_f32 v190, v3, v190
    v_mul_f32 v191, v3, v191
    v_fma_f32 v4, v96, s24, -v68
    v_fma_f32 v5, v97, s24, -v68
    v_exp_f32 v4, v4
    v_exp_f32 v5, v5
    s_nop 0
    v_add_f32 v71, v71, v4
    v_add_f32 v71, v71, v5
    v_cvt_pk_bf16_f32 v80, v4, v5
    v_fma_f32 v4, v98, s24, -v68
    v_fma_f32 v5, v99, s24, -v68
    v_exp_f32 v4, v4
    v_exp_f32 v5, v5
    s_nop 0
    v_add_f32 v71, v71, v4
    v_add_f32 v71, v71, v5
    v_cvt_pk_bf16_f32 v81, v4, v5
    v_fma_f32 v4, v100, s24, -v68
    v_fma_f32 v5, v101, s24, -v68
    v_exp_f32 v4, v4
    v_exp_f32 v5, v5
    s_nop 0
    v_add_f32 v71, v71, v4
    v_add_f32 v71, v71, v5
    v_cvt_pk_bf16_f32 v82, v4, v5
    v_fma_f32 v4, v102, s24, -v68
    v_fma_f32 v5, v103, s24, -v68
    v_exp_f32 v4, v4
    v_exp_f32 v5, v5
    s_nop 0
    v_add_f32 v71, v71, v4
    v_add_f32 v71, v71, v5
    v_cvt_pk_bf16_f32 v83, v4, v5
    v_fma_f32 v4, v104, s24, -v68
    v_fma_f32 v5, v105, s24, -v68
    v_exp_f32 v4, v4
    v_exp_f32 v5, v5
    s_nop 0
    v_add_f32 v71, v71, v4
    v_add_f32 v71, v71, v5
    v_cvt_pk_bf16_f32 v84, v4, v5
    v_fma_f32 v4, v106, s24, -v68
    v_fma_f32 v5, v107, s24, -v68
    v_exp_f32 v4, v4
    v_exp_f32 v5, v5
    s_nop 0
    v_add_f32 v71, v71, v4
    v_add_f32 v71, v71, v5
    v_cvt_pk_bf16_f32 v85, v4, v5
    v_fma_f32 v4, v108, s24, -v68
    v_fma_f32 v5, v109, s24, -v68
    v_exp_f32 v4, v4
    v_exp_f32 v5, v5
    s_nop 0
    v_add_f32 v71, v71, v4
    v_add_f32 v71, v71, v5
    v_cvt_pk_bf16_f32 v86, v4, v5
    v_fma_f32 v4, v110, s24, -v68
    v_fma_f32 v5, v111, s24, -v68
    v_exp_f32 v4, v4
    v_exp_f32 v5, v5
    s_nop 0
    v_add_f32 v71, v71, v4
    v_add_f32 v71, v71, v5
    v_cvt_pk_bf16_f32 v87, v4, v5
    s_nop 1
    s_setpc_b64 s[30:31]
L_rare_1_0:
    s_nop 15
    v_max3_f32 v2, v112, v113, v114
    v_max3_f32 v2, v2, v115, v116
    v_max3_f32 v2, v2, v117, v118
    v_max3_f32 v2, v2, v119, v120
    v_max3_f32 v2, v2, v121, v122
    v_max3_f32 v2, v2, v123, v124
    v_max3_f32 v2, v2, v125, v126
    v_max_f32 v2, v2, v127
    v_mov_b32 v3, v2
    s_nop 1
    v_permlane32_swap_b32 v2, v3
    v_max_f32 v2, v2, v3
    v_mul_f32 v2, s24, v2
    v_max_f32 v2, v2, v69
    v_sub_f32 v3, v69, v2
    v_exp_f32 v3, v3
    v_mov_b32 v69, v2
    v_mul_f32 v72, v3, v73
    v_mul_f32 v192, v3, v192
    v_mul_f32 v193, v3, v193
    v_mul_f32 v194, v3, v194
    v_mul_f32 v195, v3, v195
    v_mul_f32 v196, v3, v196
    v_mul_f32 v197, v3, v197
    v_mul_f32 v198, v3, v198
    v_mul_f32 v199, v3, v199
    v_mul_f32 v200, v3, v200
    v_mul_f32 v201, v3, v201
    v_mul_f32 v202, v3, v202
    v_mul_f32 v203, v3, v203
    v_mul_f32 v204, v3, v204
    v_mul_f32 v205, v3, v205
    v_mul_f32 v206, v3, v206
    v_mul_f32 v207, v3, v207
    v_mul_f32 v208, v3, v208
    v_mul_f32 v209, v3, v209
    v_mul_f32 v210, v3, v210
    v_mul_f32 v211, v3, v211
    v_mul_f32 v212, v3, v212
    v_mul_f32 v213, v3, v213
    v_mul_f32 v214, v3, v214
    v_mul_f32 v215, v3, v215
    v_mul_f32 v216, v3, v216
    v_mul_f32 v217, v3, v217
    v_mul_f32 v218, v3, v218
    v_mul_f32 v219, v3, v219
    v_mul_f32 v220, v3, v220
    v_mul_f32 v221, v3, v221
    v_mul_f32 v222, v3, v222
    v_mul_f32 v223, v3, v223
    v_mul_f32 v224, v3, v224
    v_mul_f32 v225, v3, v225
    v_mul_f32 v226, v3, v226
    v_mul_f32 v227, v3, v227
    v_mul_f32 v228, v3, v228
    v_mul_f32 v229, v3, v229
    v_mul_f32 v230, v3, v230
    v_mul_f32 v231, v3, v231
    v_mul_f32 v232, v3, v232
    v_mul_f32 v233, v3, v233
    v_mul_f32 v234, v3, v234
    v_mul_f32 v235, v3, v235
    v_mul_f32 v236, v3, v236
    v_mul_f32 v237, v3, v237
    v_mul_f32 v238, v3, v238
    v_mul_f32 v239, v3, v239
    v_mul_f32 v240, v3, v240
    v_mul_f32 v241, v3, v241
    v_mul_f32 v242, v3, v242
    v_mul_f32 v243, v3, v243
    v_mul_f32 v244, v3, v244
    v_mul_f32 v245, v3, v245
    v_mul_f32 v246, v3, v246
    v_mul_f32 v247, v3, v247
    v_mul_f32 v248, v3, v248
    v_mul_f32 v249, v3, v249
    v_mul_f32 v250, v3, v250
    v_mul_f32 v251, v3, v251
    v_mul_f32 v252, v3, v252
    v_mul_f32 v253, v3, v253
    v_mul_f32 v254, v3, v254
    v_mul_f32 v255, v3, v255
    v_fma_f32 v4, v112, s24, -v69
    v_fma_f32 v5, v113, s24, -v69
    v_exp_f32 v4, v4
    v_exp_f32 v5, v5
    s_nop 0
    v_add_f32 v72, v72, v4
    v_add_f32 v72, v72, v5
    v_cvt_pk_bf16_f32 v88, v4, v5
    v_fma_f32 v4, v114, s24, -v69
    v_fma_f32 v5, v115, s24, -v69
    v_exp_f32 v4, v4
    v_exp_f32 v5, v5
    s_nop 0
    v_add_f32 v72, v72, v4
    v_add_f32 v72, v72, v5
    v_cvt_pk_bf16_f32 v89, v4, v5
    v_fma_f32 v4, v116, s24, -v69
    v_fma_f32 v5, v117, s24, -v69
    v_exp_f32 v4, v4
    v_exp_f32 v5, v5
    s_nop 0
    v_add_f32 v72, v72, v4
    v_add_f32 v72, v72, v5
    v_cvt_pk_bf16_f32 v90, v4, v5
    v_fma_f32 v4, v118, s24, -v69
    v_fma_f32 v5, v119, s24, -v69
    v_exp_f32 v4, v4
    v_exp_f32 v5, v5
    s_nop 0
    v_add_f32 v72, v72, v4
    v_add_f32 v72, v72, v5
    v_cvt_pk_bf16_f32 v91, v4, v5
    v_fma_f32 v4, v120, s24, -v69
    v_fma_f32 v5, v121, s24, -v69
    v_exp_f32 v4, v4
    v_exp_f32 v5, v5
    s_nop 0
    v_add_f32 v72, v72, v4
    v_add_f32 v72, v72, v5
    v_cvt_pk_bf16_f32 v92, v4, v5
    v_fma_f32 v4, v122, s24, -v69
    v_fma_f32 v5, v123, s24, -v69
    v_exp_f32 v4, v4
    v_exp_f32 v5, v5
    s_nop 0
    v_add_f32 v72, v72, v4
    v_add_f32 v72, v72, v5
    v_cvt_pk_bf16_f32 v93, v4, v5
    v_fma_f32 v4, v124, s24, -v69
    v_fma_f32 v5, v125, s24, -v69
    v_exp_f32 v4, v4
    v_exp_f32 v5, v5
    s_nop 0
    v_add_f32 v72, v72, v4
    v_add_f32 v72, v72, v5
    v_cvt_pk_bf16_f32 v94, v4, v5
    v_fma_f32 v4, v126, s24, -v69
    v_fma_f32 v5, v127, s24, -v69
    v_exp_f32 v4, v4
    v_exp_f32 v5, v5
    s_nop 0
    v_add_f32 v72, v72, v4
    v_add_f32 v72, v72, v5
    v_cvt_pk_bf16_f32 v95, v4, v5
    s_nop 1
    s_setpc_b64 s[30:31]
L_rare_1_1:
    s_nop 15
    v_max3_f32 v2, v112, v113, v114
    v_max3_f32 v2, v2, v115, v116
    v_max3_f32 v2, v2, v117, v118
    v_max3_f32 v2, v2, v119, v120
    v_max3_f32 v2, v2, v121, v122
    v_max3_f32 v2, v2, v123, v124
    v_max3_f32 v2, v2, v125, v126
    v_max_f32 v2, v2, v127
    v_mov_b32 v3, v2
    s_nop 1
    v_permlane32_swap_b32 v2, v3
    v_max_f32 v2, v2, v3
    v_mul_f32 v2, s24, v2
    v_max_f32 v2, v2, v69
    v_sub_f32 v3, v69, v2
    v_exp_f32 v3, v3
    v_mov_b32 v69, v2
    v_mul_f32 v73, v3, v72
    v_mul_f32 v192, v3, v192
    v_mul_f32 v193, v3, v193
    v_mul_f32 v194, v3, v194
    v_mul_f32 v195, v3, v195
    v_mul_f32 v196, v3, v196
    v_mul_f32 v197, v3, v197
    v_mul_f32 v198, v3, v198
    v_mul_f32 v199, v3, v199
    v_mul_f32 v200, v3, v200
    v_mul_f32 v201, v3, v201
    v_mul_f32 v202, v3, v202
    v_mul_f32 v203, v3, v203
    v_mul_f32 v204, v3, v204
    v_mul_f32 v205, v3, v205
    v_mul_f32 v206, v3, v206
    v_mul_f32 v207, v3, v207
    v_mul_f32 v208, v3, v208
    v_mul_f32 v209, v3, v209
    v_mul_f32 v210, v3, v210
    v_mul_f32 v211, v3, v211
    v_mul_f32 v212, v3, v212
    v_mul_f32 v213, v3, v213
    v_mul_f32 v214, v3, v214
    v_mul_f32 v215, v3, v215
    v_mul_f32 v216, v3, v216
    v_mul_f32 v217, v3, v217
    v_mul_f32 v218, v3, v218
    v_mul_f32 v219, v3, v219
    v_mul_f32 v220, v3, v220
    v_mul_f32 v221, v3, v221
    v_mul_f32 v222, v3, v222
    v_mul_f32 v223, v3, v223
    v_mul_f32 v224, v3, v224
    v_mul_f32 v225, v3, v225
    v_mul_f32 v226, v3, v226
    v_mul_f32 v227, v3, v227
    v_mul_f32 v228, v3, v228
    v_mul_f32 v229, v3, v229
    v_mul_f32 v230, v3, v230
    v_mul_f32 v231, v3, v231
    v_mul_f32 v232, v3, v232
    v_mul_f32 v233, v3, v233
    v_mul_f32 v234, v3, v234
    v_mul_f32 v235, v3, v235
    v_mul_f32 v236, v3, v236
    v_mul_f32 v237, v3, v237
    v_mul_f32 v238, v3, v238
    v_mul_f32 v239, v3, v239
    v_mul_f32 v240, v3, v240
    v_mul_f32 v241, v3, v241
    v_mul_f32 v242, v3, v242
    v_mul_f32 v243, v3, v243
    v_mul_f32 v244, v3, v244
    v_mul_f32 v245, v3, v245
    v_mul_f32 v246, v3, v246
    v_mul_f32 v247, v3, v247
    v_mul_f32 v248, v3, v248
    v_mul_f32 v249, v3, v249
    v_mul_f32 v250, v3, v250
    v_mul_f32 v251, v3, v251
    v_mul_f32 v252, v3, v252
    v_mul_f32 v253, v3, v253
    v_mul_f32 v254, v3, v254
    v_mul_f32 v255, v3, v255
    v_fma_f32 v4, v112, s24, -v69
    v_fma_f32 v5, v113, s24, -v69
    v_exp_f32 v4, v4
    v_exp_f32 v5, v5
    s_nop 0
    v_add_f32 v73, v73, v4
    v_add_f32 v73, v73, v5
    v_cvt_pk_bf16_f32 v88, v4, v5
    v_fma_f32 v4, v114, s24, -v69
    v_fma_f32 v5, v115, s24, -v69
    v_exp_f32 v4, v4
    v_exp_f32 v5, v5
    s_nop 0
    v_add_f32 v73, v73, v4
    v_add_f32 v73, v73, v5
    v_cvt_pk_bf16_f32 v89, v4, v5
    v_fma_f32 v4, v116, s24, -v69
    v_fma_f32 v5, v117, s24, -v69
    v_exp_f32 v4, v4
    v_exp_f32 v5, v5
    s_nop 0
    v_add_f32 v73, v73, v4
    v_add_f32 v73, v73, v5
    v_cvt_pk_bf16_f32 v90, v4, v5
    v_fma_f32 v4, v118, s24, -v69
    v_fma_f32 v5, v119, s24, -v69
    v_exp_f32 v4, v4
    v_exp_f32 v5, v5
    s_nop 0
    v_add_f32 v73, v73, v4
    v_add_f32 v73, v73, v5
    v_cvt_pk_bf16_f32 v91, v4, v5
    v_fma_f32 v4, v120, s24, -v69
    v_fma_f32 v5, v121, s24, -v69
    v_exp_f32 v4, v4
    v_exp_f32 v5, v5
    s_nop 0
    v_add_f32 v73, v73, v4
    v_add_f32 v73, v73, v5
    v_cvt_pk_bf16_f32 v92, v4, v5
    v_fma_f32 v4, v122, s24, -v69
    v_fma_f32 v5, v123, s24, -v69
    v_exp_f32 v4, v4
    v_exp_f32 v5, v5
    s_nop 0
    v_add_f32 v73, v73, v4
    v_add_f32 v73, v73, v5
    v_cvt_pk_bf16_f32 v93, v4, v5
    v_fma_f32 v4, v124, s24, -v69
    v_fma_f32 v5, v125, s24, -v69
    v_exp_f32 v4, v4
    v_exp_f32 v5, v5
    s_nop 0
    v_add_f32 v73, v73, v4
    v_add_f32 v73, v73, v5
    v_cvt_pk_bf16_f32 v94, v4, v5
    v_fma_f32 v4, v126, s24, -v69
    v_fma_f32 v5, v127, s24, -v69
    v_exp_f32 v4, v4
    v_exp_f32 v5, v5
    s_nop 0
    v_add_f32 v73, v73, v4
    v_add_f32 v73, v73, v5
    v_cvt_pk_bf16_f32 v95, v4, v5
    s_nop 1
    s_setpc_b64 s[30:31]
L_stub12:
    s_call_b64 s[30:31], L_rare_1_0
    s_branch L_ret12
L_stub13:
    s_call_b64 s[30:31], L_rare_0_1
    s_branch L_ret13
L_stub14:
    s_call_b64 s[30:31], L_rare_1_1
    s_branch L_ret14
L_stub15:
    s_call_b64 s[30:31], L_rare_0_0
    s_branch L_ret15
L_stub16:
    s_call_b64 s[30:31], L_rare_1_0
    s_branch L_ret16
L_stub17:
    s_call_b64 s[30:31], L_rare_0_1
    s_branch L_ret17
L_stub18:
    s_call_b64 s[30:31], L_rare_1_1
    s_branch L_ret18
L_stub19:
    s_call_b64 s[30:31], L_rare_0_0
    s_branch L_ret19
L_stub24:
    s_call_b64 s[30:31], L_rare_1_0
    s_branch L_ret24
L_stub29:
    s_call_b64 s[30:31], L_rare_1_1
    s_branch L_ret29
L_stub34:
    s_call_b64 s[30:31], L_rare_1_0
    s_branch L_ret34
L_stub39:
    s_call_b64 s[30:31], L_rare_1_1
    s_branch L_ret39
L_stub52:
    s_call_b64 s[30:31], L_rare_1_0
    s_branch L_ret52
L_stub53:
    s_call_b64 s[30:31], L_rare_0_1
    s_branch L_ret53
L_stub54:
    s_call_b64 s[30:31], L_rare_1_1
    s_branch L_ret54
L_stub55:
    s_call_b64 s[30:31], L_rare_0_0
    s_branch L_ret55
L_stub56:
    s_call_b64 s[30:31], L_rare_1_0
    s_branch L_ret56
L_stub57:
    s_call_b64 s[30:31], L_rare_0_1
    s_branch L_ret57
L_stub58:
    s_call_b64 s[30:31], L_rare_1_1
    s_branch L_ret58
L_stub59:
    s_call_b64 s[30:31], L_rare_0_0
    s_branch L_ret59
L_stub64:
    s_call_b64 s[30:31], L_rare_1_0
    s_branch L_ret64
L_stub69:
    s_call_b64 s[30:31], L_rare_1_1
    s_branch L_ret69
L_stub74:
    s_call_b64 s[30:31], L_rare_1_0
    s_branch L_ret74
L_stub79:
    s_call_b64 s[30:31], L_rare_1_1
    s_branch L_ret79
L_end:
    s_endpgm
.p2align 6
.type jobtab,@object
jobtab:
.long 0x19a7000, 0x671c00, 0x28, 0xb20, 0x0, 0x0, 0x0, 0x0
.long 0x0, 0x0, 0x0, 0x0, 0x0, 0x0, 0x0, 0x0
.long 0x19c7000, 0x671c00, 0x28, 0x920, 0x0, 0x0, 0x0, 0x0
.long 0x0, 0x0, 0x0, 0x0, 0x0, 0x0, 0x0, 0x0
.long 0x987000, 0x269c00, 0x26, 0xb20, 0x14e7000, 0x541c00, 0x2, 0xb20
.long 0x0, 0x0, 0x0, 0x0, 0x0, 0x0, 0x0, 0x0
.long 0x9a7000, 0x269c00, 0x26, 0x920, 0x1507000, 0x541c00, 0x2, 0x920
.long 0x0, 0x0, 0x0, 0x0, 0x0, 0x0, 0x0, 0x0
.long 0x19a7400, 0x671d00, 0x28, 0xb20, 0x0, 0x0, 0x0, 0x0
.long 0x0, 0x0, 0x0, 0x0, 0x0, 0x0, 0x0, 0x0
.long 0x19c7400, 0x671d00, 0x28, 0x920, 0x0, 0x0, 0x0, 0x0
.long 0x0, 0x0, 0x0, 0x0, 0x0, 0x0, 0x0, 0x0
.long 0x987400, 0x269d00, 0x26, 0xb20, 0x14e7400, 0x541d00, 0x2, 0xb20
.long 0x0, 0x0, 0x0, 0x0, 0x0, 0x0, 0x0, 0x0
.long 0x9a7400, 0x269d00, 0x26, 0x920, 0x1507400, 0x541d00, 0x2, 0x920
.long 0x0, 0x0, 0x0, 0x0, 0x0, 0x0, 0x0, 0x0
.long 0x19a7800, 0x671e00, 0x28, 0xb20, 0x0, 0x0, 0x0, 0x0
.long 0x0, 0x0, 0x0, 0x0, 0x0, 0x0, 0x0, 0x0
.long 0x19c7800, 0x671e00, 0x28, 0x920, 0x0, 0x0, 0x0, 0x0
.long 0x0, 0x0, 0x0, 0x0, 0x0, 0x0, 0x0, 0x0
.long 0x987800, 0x269e00, 0x26, 0xb20, 0x14e7800, 0x541e00, 0x2, 0xb20
.long 0x0, 0x0, 0x0, 0x0, 0x0, 0x0, 0x0, 0x0
.long 0x9a7800, 0x269e00, 0x26, 0x920, 0x1507800, 0x541e00, 0x2, 0x920
.long 0x0, 0x0, 0x0, 0x0, 0x0, 0x0, 0x0, 0x0
.long 0x19a7c00, 0x671f00, 0x28, 0xb20, 0x0, 0x0, 0x0, 0x0
.long 0x0, 0x0, 0x0, 0x0, 0x0, 0x0, 0x0, 0x0
.long 0x19c7c00, 0x671f00, 0x28, 0x920, 0x0, 0x0, 0x0, 0x0
.long 0x0, 0x0, 0x0, 0x0, 0x0, 0x0, 0x0, 0x0
.long 0x987c00, 0x269f00, 0x26, 0xb20, 0x14e7c00, 0x541f00, 0x2, 0xb20
.long 0x0, 0x0, 0x0, 0x0, 0x0, 0x0, 0x0, 0x0
.long 0x9a7c00, 0x269f00, 0x26, 0x920, 0x1507c00, 0x541f00, 0x2, 0x920
.long 0x0, 0x0, 0x0, 0x0, 0x0, 0x0, 0x0, 0x0
.long 0x1927000, 0x651c00, 0x24, 0xb20, 0x12c1000, 0x4b8400, 0x4, 0xb20
.long 0x0, 0x0, 0x0, 0x0, 0x0, 0x0, 0x0, 0x0
.long 0x1947000, 0x651c00, 0x24, 0x920, 0x12e1000, 0x4b8400, 0x4, 0x920
.long 0x0, 0x0, 0x0, 0x0, 0x0, 0x0, 0x0, 0x0
.long 0x8c7000, 0x239c00, 0x20, 0xb20, 0x403000, 0x108c00, 0x6, 0xb20
.long 0x0, 0x0, 0x0, 0x0, 0x0, 0x0, 0x0, 0x0
.long 0x8e7000, 0x239c00, 0x20, 0x920, 0x423000, 0x108c00, 0x6, 0x920
.long 0x0, 0x0, 0x0, 0x0, 0x0, 0x0, 0x0, 0x0
.long 0x1927400, 0x651d00, 0x24, 0xb20, 0x12c1400, 0x4b8500, 0x4, 0xb20
.long 0x0, 0x0, 0x0, 0x0, 0x0, 0x0, 0x0, 0x0
.long 0x1947400, 0x651d00, 0x24, 0x920, 0x12e1400, 0x4b8500, 0x4, 0x920
.long 0x0, 0x0, 0x0, 0x0, 0x0, 0x0, 0x0, 0x0
.long 0x8c7400, 0x239d00, 0x20, 0xb20, 0x403400, 0x108d00, 0x6, 0xb20
.long 0x0, 0x0, 0x0, 0x0, 0x0, 0x0, 0x0, 0x0
.long 0x8e7400, 0x239d00, 0x20, 0x920, 0x423400, 0x108d00, 0x6, 0x920
.long 0x0, 0x0, 0x0, 0x0, 0x0, 0x0, 0x0, 0x0
.long 0x1927800, 0x651e00, 0x24, 0xb20, 0x12c1800, 0x4b8600, 0x4, 0xb20
.long 0x0, 0x0, 0x0, 0x0, 0x0, 0x0, 0x0, 0x0
.long 0x1947800, 0x651e00, 0x24, 0x920, 0x12e1800, 0x4b8600, 0x4, 0x920
.long 0x0, 0x0, 0x0, 0x0, 0x0, 0x0, 0x0, 0x0
.long 0x8c7800, 0x239e00, 0x20, 0xb20, 0x403800, 0x108e00, 0x6, 0xb20
.long 0x0, 0x0, 0x0, 0x0, 0x0, 0x0, 0x0, 0x0
.long 0x8e7800, 0x239e00, 0x20, 0x920, 0x423800, 0x108e00, 0x6, 0x920
.long 0x0, 0x0, 0x0, 0x0, 0x0, 0x0, 0x0, 0x0
.long 0x1927c00, 0x651f00, 0x24, 0xb20, 0x12c1c00, 0x4b8700, 0x4, 0xb20
.long 0x0, 0x0, 0x0, 0x0, 0x0, 0x0, 0x0, 0x0
.long 0x1947c00, 0x651f00, 0x24, 0x920, 0x12e1c00, 0x4b8700, 0x4, 0x920
.long 0x0, 0x0, 0x0, 0x0, 0x0, 0x0, 0x0, 0x0
.long 0x8c7c00, 0x239f00, 0x20, 0xb20, 0x403c00, 0x108f00, 0x6, 0xb20
.long 0x0, 0x0, 0x0, 0x0, 0x0, 0x0, 0x0, 0x0
.long 0x8e7c00, 0x239f00, 0x20, 0x920, 0x423c00, 0x108f00, 0x6, 0x920
.long 0x0, 0x0, 0x0, 0x0, 0x0, 0x0, 0x0, 0x0
.long 0x19e7000, 0x681c00, 0x2a, 0xb20, 0x0, 0x0, 0x0, 0x0
.long 0x0, 0x0, 0x0, 0x0, 0x0, 0x0, 0x0, 0x0
.long 0x1a07000, 0x681c00, 0x2a, 0x920, 0x0, 0x0, 0x0, 0x0
.long 0x0, 0x0, 0x0, 0x0, 0x0, 0x0, 0x0, 0x0
.long 0x9c7000, 0x279c00, 0x28, 0xb20, 0x0, 0x0, 0x0, 0x0
.long 0x0, 0x0, 0x0, 0x0, 0x0, 0x0, 0x0, 0x0
.long 0x9e7000, 0x279c00, 0x28, 0x920, 0x0, 0x0, 0x0, 0x0
.long 0x0, 0x0, 0x0, 0x0, 0x0, 0x0, 0x0, 0x0
.long 0x19e7400, 0x681d00, 0x2a, 0xb20, 0x0, 0x0, 0x0, 0x0
.long 0x0, 0x0, 0x0, 0x0, 0x0, 0x0, 0x0, 0x0
.long 0x1a07400, 0x681d00, 0x2a, 0x920, 0x0, 0x0, 0x0, 0x0
.long 0x0, 0x0, 0x0, 0x0, 0x0, 0x0, 0x0, 0x0
.long 0x9c7400, 0x279d00, 0x28, 0xb20, 0x0, 0x0, 0x0, 0x0
.long 0x0, 0x0, 0x0, 0x0, 0x0, 0x0, 0x0, 0x0
.long 0x9e7400, 0x279d00, 0x28, 0x920, 0x0, 0x0, 0x0, 0x0
.long 0x0, 0x0, 0x0, 0x0, 0x0, 0x0, 0x0, 0x0
.long 0x19e7800, 0x681e00, 0x2a, 0xb20, 0x0, 0x0, 0x0, 0x0
.long 0x0, 0x0, 0x0, 0x0, 0x0, 0x0, 0x0, 0x0
.long 0x1a07800, 0x681e00, 0x2a, 0x920, 0x0, 0x0, 0x0, 0x0
.long 0x0, 0x0, 0x0, 0x0, 0x0, 0x0, 0x0, 0x0
.long 0x9c7800, 0x279e00, 0x28, 0xb20, 0x0, 0x0, 0x0, 0x0
.long 0x0, 0x0, 0x0, 0x0, 0x0, 0x0, 0x0, 0x0
.long 0x9e7800, 0x279e00, 0x28, 0x920, 0x0, 0x0, 0x0, 0x0
.long 0x0, 0x0, 0x0, 0x0, 0x0, 0x0, 0x0, 0x0
.long 0x19e7c00, 0x681f00, 0x2a, 0xb20, 0x0, 0x0, 0x0, 0x0
.long 0x0, 0x0, 0x0, 0x0, 0x0, 0x0, 0x0, 0x0
.long 0x1a07c00, 0x681f00, 0x2a, 0x920, 0x0, 0x0, 0x0, 0x0
.long 0x0, 0x0, 0x0, 0x0, 0x0, 0x0, 0x0, 0x0
.long 0x9c7c00, 0x279f00, 0x28, 0xb20, 0x0, 0x0, 0x0, 0x0
.long 0x0, 0x0, 0x0, 0x0, 0x0, 0x0, 0x0, 0x0
.long 0x9e7c00, 0x279f00, 0x28, 0x920, 0x0, 0x0, 0x0, 0x0
.long 0x0, 0x0, 0x0, 0x0, 0x0, 0x0, 0x0, 0x0
.long 0x1a87000, 0x6a1c00, 0x17, 0xd20, 0xf75000, 0x3dd400, 0xa, 0xd05
.long 0x0, 0x0, 0x0, 0x0, 0x0, 0x0, 0x0, 0x0
.long 0x1a87000, 0x5e9c00, 0x17, 0xc20, 0xf75000, 0x395400, 0xa, 0xe05
.long 0x0, 0x0, 0x0, 0x0, 0x0, 0x0, 0x0, 0x0
.long 0x807000, 0x209c00, 0x1a, 0xb20, 0xdb5000, 0x375400, 0x6, 0xb20
.long 0xd35000, 0x355400, 0x2, 0xb20, 0x0, 0x0, 0x0, 0x0
.long 0x827000, 0x209c00, 0x1a, 0x920, 0xdd5000, 0x375400, 0x6, 0x920
.long 0xd55000, 0x355400, 0x2, 0x920, 0x0, 0x0, 0x0, 0x0
.long 0x1a87400, 0x6a1d00, 0x17, 0xd20, 0xf75400, 0x3dd500, 0xa, 0xd05
.long 0x0, 0x0, 0x0, 0x0, 0x0, 0x0, 0x0, 0x0
.long 0x1a87400, 0x5e9d00, 0x17, 0xc20, 0xf75400, 0x395500, 0xa, 0xe05
.long 0x0, 0x0, 0x0, 0x0, 0x0, 0x0, 0x0, 0x0
.long 0x807400, 0x209d00, 0x1a, 0xb20, 0xdb5400, 0x375500, 0x6, 0xb20
.long 0xd35400, 0x355500, 0x2, 0xb20, 0x0, 0x0, 0x0, 0x0
.long 0x827400, 0x209d00, 0x1a, 0x920, 0xdd5400, 0x375500, 0x6, 0x920
.long 0xd55400, 0x355500, 0x2, 0x920, 0x0, 0x0, 0x0, 0x0
.long 0x1a87800, 0x6a1e00, 0x17, 0xd20, 0xf75800, 0x3dd600, 0xa, 0xd05
.long 0x0, 0x0, 0x0, 0x0, 0x0, 0x0, 0x0, 0x0
.long 0x1a87800, 0x5e9e00, 0x17, 0xc20, 0xf75800, 0x395600, 0xa, 0xe05
.long 0x0, 0x0, 0x0, 0x0, 0x0, 0x0, 0x0, 0x0
.long 0x807800, 0x209e00, 0x1a, 0xb20, 0xdb5800, 0x375600, 0x6, 0xb20
.long 0xd35800, 0x355600, 0x2, 0xb20, 0x0, 0x0, 0x0, 0x0
.long 0x827800, 0x209e00, 0x1a, 0x920, 0xdd5800, 0x375600, 0x6, 0x920
.long 0xd55800, 0x355600, 0x2, 0x920, 0x0, 0x0, 0x0, 0x0
.long 0x1a87c00, 0x6a1f00, 0x17, 0xd20, 0xf75c00, 0x3dd700, 0xa, 0xd05
.long 0x0, 0x0, 0x0, 0x0, 0x0, 0x0, 0x0, 0x0
.long 0x1a87c00, 0x5e9f00, 0x17, 0xc20, 0xf75c00, 0x395700, 0xa, 0xe05
.long 0x0, 0x0, 0x0, 0x0, 0x0, 0x0, 0x0, 0x0
.long 0x807c00, 0x209f00, 0x1a, 0xb20, 0xdb5c00, 0x375700, 0x6, 0xb20
.long 0xd35c00, 0x355700, 0x2, 0xb20, 0x0, 0x0, 0x0, 0x0
.long 0x827c00, 0x209f00, 0x1a, 0x920, 0xdd5c00, 0x375700, 0x6, 0x920
.long 0xd55c00, 0x355700, 0x2, 0x920, 0x0, 0x0, 0x0, 0x0
.long 0x1be7000, 0x6f9c00, 0x1d, 0xd20, 0xdf5000, 0x385400, 0x8, 0xb20
.long 0x0, 0x0, 0x0, 0x0, 0x0, 0x0, 0x0, 0x0
.long 0x1be7000, 0x619c00, 0x1d, 0xe20, 0xe15000, 0x385400, 0x8, 0x920
.long 0x0, 0x0, 0x0, 0x0, 0x0, 0x0, 0x0, 0x0
.long 0x847000, 0x219c00, 0x1c, 0xb20, 0x3c3000, 0xf8c00, 0x4, 0xb20
.long 0x507000, 0x149c00, 0x2, 0xb20, 0x0, 0x0, 0x0, 0x0
.long 0x867000, 0x219c00, 0x1c, 0x920, 0x3e3000, 0xf8c00, 0x4, 0x920
.long 0x527000, 0x149c00, 0x2, 0x920, 0x0, 0x0, 0x0, 0x0
.long 0x1be7400, 0x6f9d00, 0x1d, 0xd20, 0xdf5400, 0x385500, 0x8, 0xb20
.long 0x0, 0x0, 0x0, 0x0, 0x0, 0x0, 0x0, 0x0
.long 0x1be7400, 0x619d00, 0x1d, 0xe20, 0xe15400, 0x385500, 0x8, 0x920
.long 0x0, 0x0, 0x0, 0x0, 0x0, 0x0, 0x0, 0x0
.long 0x847400, 0x219d00, 0x1c, 0xb20, 0x3c3400, 0xf8d00, 0x4, 0xb20
.long 0x507400, 0x149d00, 0x2, 0xb20, 0x0, 0x0, 0x0, 0x0
.long 0x867400, 0x219d00, 0x1c, 0x920, 0x3e3400, 0xf8d00, 0x4, 0x920
.long 0x527400, 0x149d00, 0x2, 0x920, 0x0, 0x0, 0x0, 0x0
.long 0x1be7800, 0x6f9e00, 0x1d, 0xd20, 0xdf5800, 0x385600, 0x8, 0xb20
.long 0x0, 0x0, 0x0, 0x0, 0x0, 0x0, 0x0, 0x0
.long 0x1be7800, 0x619e00, 0x1d, 0xe20, 0xe15800, 0x385600, 0x8, 0x920
.long 0x0, 0x0, 0x0, 0x0, 0x0, 0x0, 0x0, 0x0
.long 0x847800, 0x219e00, 0x1c, 0xb20, 0x3c3800, 0xf8e00, 0x4, 0xb20
.long 0x507800, 0x149e00, 0x2, 0xb20, 0x0, 0x0, 0x0, 0x0
.long 0x867800, 0x219e00, 0x1c, 0x920, 0x3e3800, 0xf8e00, 0x4, 0x920
.long 0x527800, 0x149e00, 0x2, 0x920, 0x0, 0x0, 0x0, 0x0
.long 0x1be7c00, 0x6f9f00, 0x1d, 0xd20, 0xdf5c00, 0x385700, 0x8, 0xb20
.long 0x0, 0x0, 0x0, 0x0, 0x0, 0x0, 0x0, 0x0
.long 0x1be7c00, 0x619f00, 0x1d, 0xe20, 0xe15c00, 0x385700, 0x8, 0x920
.long 0x0, 0x0, 0x0, 0x0, 0x0, 0x0, 0x0, 0x0
.long 0x847c00, 0x219f00, 0x1c, 0xb20, 0x3c3c00, 0xf8f00, 0x4, 0xb20
.long 0x507c00, 0x149f00, 0x2, 0xb20, 0x0, 0x0, 0x0, 0x0
.long 0x867c00, 0x219f00, 0x1c, 0x920, 0x3e3c00, 0xf8f00, 0x4, 0x920
.long 0x527c00, 0x149f00, 0x2, 0x920, 0x0, 0x0, 0x0, 0x0
.long 0x1a67000, 0x699c00, 0x17, 0xd20, 0x40000, 0x18000, 0x4, 0xb20
.long 0xd75000, 0x365400, 0x4, 0xb20, 0x0, 0x0, 0x0, 0x0
.long 0x1a67000, 0x5e9c00, 0x17, 0xe20, 0x60000, 0x18000, 0x4, 0x920
.long 0xd95000, 0x365400, 0x4, 0x920, 0x0, 0x0, 0x0, 0x0
.long 0x1a47000, 0x691c00, 0x16, 0xd20, 0x1401000, 0x508400, 0xe, 0xb20
.long 0x0, 0x0, 0x0, 0x0, 0x0, 0x0, 0x0, 0x0
.long 0x1a47000, 0x5e1c00, 0x16, 0xc20, 0x1421000, 0x508400, 0xe, 0x920
.long 0x0, 0x0, 0x0, 0x0, 0x0, 0x0, 0x0, 0x0
.long 0x1a67400, 0x699d00, 0x17, 0xd20, 0x40400, 0x18100, 0x4, 0xb20
.long 0xd75400, 0x365500, 0x4, 0xb20, 0x0, 0x0, 0x0, 0x0
.long 0x1a67400, 0x5e9d00, 0x17, 0xe20, 0x60400, 0x18100, 0x4, 0x920
.long 0xd95400, 0x365500, 0x4, 0x920, 0x0, 0x0, 0x0, 0x0
.long 0x1a47400, 0x691d00, 0x16, 0xd20, 0x1401400, 0x508500, 0xe, 0xb20
.long 0x0, 0x0, 0x0, 0x0, 0x0, 0x0, 0x0, 0x0
.long 0x1a47400, 0x5e1d00, 0x16, 0xc20, 0x1421400, 0x508500, 0xe, 0x920
.long 0x0, 0x0, 0x0, 0x0, 0x0, 0x0, 0x0, 0x0
.long 0x1a67800, 0x699e00, 0x17, 0xd20, 0x40800, 0x18200, 0x4, 0xb20
.long 0xd75800, 0x365600, 0x4, 0xb20, 0x0, 0x0, 0x0, 0x0
.long 0x1a67800, 0x5e9e00, 0x17, 0xe20, 0x60800, 0x18200, 0x4, 0x920
.long 0xd95800, 0x365600, 0x4, 0x920, 0x0, 0x0, 0x0, 0x0
.long 0x1a47800, 0x691e00, 0x16, 0xd20, 0x1401800, 0x508600, 0xe, 0xb20
.long 0x0, 0x0, 0x0, 0x0, 0x0, 0x0, 0x0, 0x0
.long 0x1a47800, 0x5e1e00, 0x16, 0xc20, 0x1421800, 0x508600, 0xe, 0x920
.long 0x0, 0x0, 0x0, 0x0, 0x0, 0x0, 0x0, 0x0
.long 0x1a67c00, 0x699f00, 0x17, 0xd20, 0x40c00, 0x18300, 0x4, 0xb20
.long 0xd75c00, 0x365700, 0x4, 0xb20, 0x0, 0x0, 0x0, 0x0
.long 0x1a67c00, 0x5e9f00, 0x17, 0xe20, 0x60c00, 0x18300, 0x4, 0x920
.long 0xd95c00, 0x365700, 0x4, 0x920, 0x0, 0x0, 0x0, 0x0
.long 0x1a47c00, 0x691f00, 0x16, 0xd20, 0x1401c00, 0x508700, 0xe, 0xb20
.long 0x0, 0x0, 0x0, 0x0, 0x0, 0x0, 0x0, 0x0
.long 0x1a47c00, 0x5e1f00, 0x16, 0xc20, 0x1421c00, 0x508700, 0xe, 0x920
.long 0x0, 0x0, 0x0, 0x0, 0x0, 0x0, 0x0, 0x0
.long 0x1b87000, 0x6e1c00, 0x1b, 0xd20, 0x107a000, 0x426800, 0xa, 0xb20
.long 0x0, 0x0, 0x0, 0x0, 0x0, 0x0, 0x0, 0x0
.long 0x1b87000, 0x609c00, 0x1b, 0xc20, 0x109a000, 0x426800, 0xa, 0x920
.long 0x0, 0x0, 0x0, 0x0, 0x0, 0x0, 0x0, 0x0
.long 0xbc7000, 0x2f1c00, 0x1c, 0xd20, 0x103a000, 0x416800, 0x8, 0xb20
.long 0x0, 0x0, 0x0, 0x0, 0x0, 0x0, 0x0, 0x0
.long 0xbc7000, 0x219c00, 0x1c, 0xe20, 0x105a000, 0x416800, 0x8, 0x920
.long 0x0, 0x0, 0x0, 0x0, 0x0, 0x0, 0x0, 0x0
.long 0x1b87400, 0x6e1d00, 0x1b, 0xd20, 0x107a400, 0x426900, 0xa, 0xb20
.long 0x0, 0x0, 0x0, 0x0, 0x0, 0x0, 0x0, 0x0
.long 0x1b87400, 0x609d00, 0x1b, 0xc20, 0x109a400, 0x426900, 0xa, 0x920
.long 0x0, 0x0, 0x0, 0x0, 0x0, 0x0, 0x0, 0x0
.long 0xbc7400, 0x2f1d00, 0x1c, 0xd20, 0x103a400, 0x416900, 0x8, 0xb20
.long 0x0, 0x0, 0x0, 0x0, 0x0, 0x0, 0x0, 0x0
.long 0xbc7400, 0x219d00, 0x1c, 0xe20, 0x105a400, 0x416900, 0x8, 0x920
.long 0x0, 0x0, 0x0, 0x0, 0x0, 0x0, 0x0, 0x0
.long 0x1b87800, 0x6e1e00, 0x1b, 0xd20, 0x107a800, 0x426a00, 0xa, 0xb20
.long 0x0, 0x0, 0x0, 0x0, 0x0, 0x0, 0x0, 0x0
.long 0x1b87800, 0x609e00, 0x1b, 0xc20, 0x109a800, 0x426a00, 0xa, 0x920
.long 0x0, 0x0, 0x0, 0x0, 0x0, 0x0, 0x0, 0x0
.long 0xbc7800, 0x2f1e00, 0x1c, 0xd20, 0x103a800, 0x416a00, 0x8, 0xb20
.long 0x0, 0x0, 0x0, 0x0, 0x0, 0x0, 0x0, 0x0
.long 0xbc7800, 0x219e00, 0x1c, 0xe20, 0x105a800, 0x416a00, 0x8, 0x920
.long 0x0, 0x0, 0x0, 0x0, 0x0, 0x0, 0x0, 0x0
.long 0x1b87c00, 0x6e1f00, 0x1b, 0xd20, 0x107ac00, 0x426b00, 0xa, 0xb20
.long 0x0, 0x0, 0x0, 0x0, 0x0, 0x0, 0x0, 0x0
.long 0x1b87c00, 0x609f00, 0x1b, 0xc20, 0x109ac00, 0x426b00, 0xa, 0x920
.long 0x0, 0x0, 0x0, 0x0, 0x0, 0x0, 0x0, 0x0
.long 0xbc7c00, 0x2f1f00, 0x1c, 0xd20, 0x103ac00, 0x416b00, 0x8, 0xb20
.long 0x0, 0x0, 0x0, 0x0, 0x0, 0x0, 0x0, 0x0
.long 0xbc7c00, 0x219f00, 0x1c, 0xe20, 0x105ac00, 0x416b00, 0x8, 0x920
.long 0x0, 0x0, 0x0, 0x0, 0x0, 0x0, 0x0, 0x0
.long 0x1b47000, 0x6d1c00, 0x1a, 0xd20, 0x1381000, 0x4e8400, 0xa, 0xb20
.long 0x0, 0x0, 0x0, 0x0, 0x0, 0x0, 0x0, 0x0
.long 0x1b47000, 0x601c00, 0x1a, 0xc20, 0x13a1000, 0x4e8400, 0xa, 0x920
.long 0x0, 0x0, 0x0, 0x0, 0x0, 0x0, 0x0, 0x0
.long 0x300000, 0xc8000, 0x1a, 0xb20, 0xffa000, 0x406800, 0x6, 0xb20
.long 0x0, 0x8000, 0x2, 0xb20, 0x0, 0x0, 0x0, 0x0
.long 0x320000, 0xc8000, 0x1a, 0x920, 0x101a000, 0x406800, 0x6, 0x920
.long 0x20000, 0x8000, 0x2, 0x920, 0x0, 0x0, 0x0, 0x0
.long 0x1b47400, 0x6d1d00, 0x1a, 0xd20, 0x1381400, 0x4e8500, 0xa, 0xb20
.long 0x0, 0x0, 0x0, 0x0, 0x0, 0x0, 0x0, 0x0
.long 0x1b47400, 0x601d00, 0x1a, 0xc20, 0x13a1400, 0x4e8500, 0xa, 0x920
.long 0x0, 0x0, 0x0, 0x0, 0x0, 0x0, 0x0, 0x0
.long 0x300400, 0xc8100, 0x1a, 0xb20, 0xffa400, 0x406900, 0x6, 0xb20
.long 0x400, 0x8100, 0x2, 0xb20, 0x0, 0x0, 0x0, 0x0
.long 0x320400, 0xc8100, 0x1a, 0x920, 0x101a400, 0x406900, 0x6, 0x920
.long 0x20400, 0x8100, 0x2, 0x920, 0x0, 0x0, 0x0, 0x0
.long 0x1b47800, 0x6d1e00, 0x1a, 0xd20, 0x1381800, 0x4e8600, 0xa, 0xb20
.long 0x0, 0x0, 0x0, 0x0, 0x0, 0x0, 0x0, 0x0
.long 0x1b47800, 0x601e00, 0x1a, 0xc20, 0x13a1800, 0x4e8600, 0xa, 0x920
.long 0x0, 0x0, 0x0, 0x0, 0x0, 0x0, 0x0, 0x0
.long 0x300800, 0xc8200, 0x1a, 0xb20, 0xffa800, 0x406a00, 0x6, 0xb20
.long 0x800, 0x8200, 0x2, 0xb20, 0x0, 0x0, 0x0, 0x0
.long 0x320800, 0xc8200, 0x1a, 0x920, 0x101a800, 0x406a00, 0x6, 0x920
.long 0x20800, 0x8200, 0x2, 0x920, 0x0, 0x0, 0x0, 0x0
.long 0x1b47c00, 0x6d1f00, 0x1a, 0xd20, 0x1381c00, 0x4e8700, 0xa, 0xb20
.long 0x0, 0x0, 0x0, 0x0, 0x0, 0x0, 0x0, 0x0
.long 0x1b47c00, 0x601f00, 0x1a, 0xc20, 0x13a1c00, 0x4e8700, 0xa, 0x920
.long 0x0, 0x0, 0x0, 0x0, 0x0, 0x0, 0x0, 0x0
.long 0x300c00, 0xc8300, 0x1a, 0xb20, 0xffac00, 0x406b00, 0x6, 0xb20
.long 0xc00, 0x8300, 0x2, 0xb20, 0x0, 0x0, 0x0, 0x0
.long 0x320c00, 0xc8300, 0x1a, 0x920, 0x101ac00, 0x406b00, 0x6, 0x920
.long 0x20c00, 0x8300, 0x2, 0x920, 0x0, 0x0, 0x0, 0x0
.long 0x1967000, 0x661c00, 0x26, 0xb20, 0x1281000, 0x4a8400, 0x2, 0xb20
.long 0x0, 0x0, 0x0, 0x0, 0x0, 0x0, 0x0, 0x0
.long 0x1987000, 0x661c00, 0x26, 0x920, 0x12a1000, 0x4a8400, 0x2, 0x920
.long 0x0, 0x0, 0x0, 0x0, 0x0, 0x0, 0x0, 0x0
.long 0x887000, 0x229c00, 0x1e, 0xb20, 0x1341000, 0x4d8400, 0x8, 0xb20
.long 0x0, 0x0, 0x0, 0x0, 0x0, 0x0, 0x0, 0x0
.long 0x8a7000, 0x229c00, 0x1e, 0x920, 0x1361000, 0x4d8400, 0x8, 0x920
.long 0x0, 0x0, 0x0, 0x0, 0x0, 0x0, 0x0, 0x0
.long 0x1967400, 0x661d00, 0x26, 0xb20, 0x1281400, 0x4a8500, 0x2, 0xb20
.long 0x0, 0x0, 0x0, 0x0, 0x0, 0x0, 0x0, 0x0
.long 0x1987400, 0x661d00, 0x26, 0x920, 0x12a1400, 0x4a8500, 0x2, 0x920
.long 0x0, 0x0, 0x0, 0x0, 0x0, 0x0, 0x0, 0x0
.long 0x887400, 0x229d00, 0x1e, 0xb20, 0x1341400, 0x4d8500, 0x8, 0xb20
.long 0x0, 0x0, 0x0, 0x0, 0x0, 0x0, 0x0, 0x0
.long 0x8a7400, 0x229d00, 0x1e, 0x920, 0x1361400, 0x4d8500, 0x8, 0x920
.long 0x0, 0x0, 0x0, 0x0, 0x0, 0x0, 0x0, 0x0
.long 0x1967800, 0x661e00, 0x26, 0xb20, 0x1281800, 0x4a8600, 0x2, 0xb20
.long 0x0, 0x0, 0x0, 0x0, 0x0, 0x0, 0x0, 0x0
.long 0x1987800, 0x661e00, 0x26, 0x920, 0x12a1800, 0x4a8600, 0x2, 0x920
.long 0x0, 0x0, 0x0, 0x0, 0x0, 0x0, 0x0, 0x0
.long 0x887800, 0x229e00, 0x1e, 0xb20, 0x1341800, 0x4d8600, 0x8, 0xb20
.long 0x0, 0x0, 0x0, 0x0, 0x0, 0x0, 0x0, 0x0
.long 0x8a7800, 0x229e00, 0x1e, 0x920, 0x1361800, 0x4d8600, 0x8, 0x920
.long 0x0, 0x0, 0x0, 0x0, 0x0, 0x0, 0x0, 0x0
.long 0x1967c00, 0x661f00, 0x26, 0xb20, 0x1281c00, 0x4a8700, 0x2, 0xb20
.long 0x0, 0x0, 0x0, 0x0, 0x0, 0x0, 0x0, 0x0
.long 0x1987c00, 0x661f00, 0x26, 0x920, 0x12a1c00, 0x4a8700, 0x2, 0x920
.long 0x0, 0x0, 0x0, 0x0, 0x0, 0x0, 0x0, 0x0
.long 0x887c00, 0x229f00, 0x1e, 0xb20, 0x1341c00, 0x4d8700, 0x8, 0xb20
.long 0x0, 0x0, 0x0, 0x0, 0x0, 0x0, 0x0, 0x0
.long 0x8a7c00, 0x229f00, 0x1e, 0x920, 0x1361c00, 0x4d8700, 0x8, 0x920
.long 0x0, 0x0, 0x0, 0x0, 0x0, 0x0, 0x0, 0x0
.long 0x18e7000, 0x641c00, 0x22, 0xb20, 0xfba000, 0x3f6800, 0x4, 0xb20
.long 0x0, 0x0, 0x0, 0x0, 0x0, 0x0, 0x0, 0x0
.long 0x1907000, 0x641c00, 0x22, 0x920, 0xfda000, 0x3f6800, 0x4, 0x920
.long 0x0, 0x0, 0x0, 0x0, 0x0, 0x0, 0x0, 0x0
.long 0xa27000, 0x289c00, 0x15, 0xd20, 0x113a000, 0x456800, 0x10, 0xb20
.long 0x0, 0x0, 0x0, 0x0, 0x0, 0x0, 0x0, 0x0
.long 0xa27000, 0x1e1c00, 0x15, 0xc20, 0x115a000, 0x456800, 0x10, 0x920
.long 0x0, 0x0, 0x0, 0x0, 0x0, 0x0, 0x0, 0x0
.long 0x18e7400, 0x641d00, 0x22, 0xb20, 0xfba400, 0x3f6900, 0x4, 0xb20
.long 0x0, 0x0, 0x0, 0x0, 0x0, 0x0, 0x0, 0x0
.long 0x1907400, 0x641d00, 0x22, 0x920, 0xfda400, 0x3f6900, 0x4, 0x920
.long 0x0, 0x0, 0x0, 0x0, 0x0, 0x0, 0x0, 0x0
.long 0xa27400, 0x289d00, 0x15, 0xd20, 0x113a400, 0x456900, 0x10, 0xb20
.long 0x0, 0x0, 0x0, 0x0, 0x0, 0x0, 0x0, 0x0
.long 0xa27400, 0x1e1d00, 0x15, 0xc20, 0x115a400, 0x456900, 0x10, 0x920
.long 0x0, 0x0, 0x0, 0x0, 0x0, 0x0, 0x0, 0x0
.long 0x18e7800, 0x641e00, 0x22, 0xb20, 0xfba800, 0x3f6a00, 0x4, 0xb20
.long 0x0, 0x0, 0x0, 0x0, 0x0, 0x0, 0x0, 0x0
.long 0x1907800, 0x641e00, 0x22, 0x920, 0xfda800, 0x3f6a00, 0x4, 0x920
.long 0x0, 0x0, 0x0, 0x0, 0x0, 0x0, 0x0, 0x0
.long 0xa27800, 0x289e00, 0x15, 0xd20, 0x113a800, 0x456a00, 0x10, 0xb20
.long 0x0, 0x0, 0x0, 0x0, 0x0, 0x0, 0x0, 0x0
.long 0xa27800, 0x1e1e00, 0x15, 0xc20, 0x115a800, 0x456a00, 0x10, 0x920
.long 0x0, 0x0, 0x0, 0x0, 0x0, 0x0, 0x0, 0x0
.long 0x18e7c00, 0x641f00, 0x22, 0xb20, 0xfbac00, 0x3f6b00, 0x4, 0xb20
.long 0x0, 0x0, 0x0, 0x0, 0x0, 0x0, 0x0, 0x0
.long 0x1907c00, 0x641f00, 0x22, 0x920, 0xfdac00, 0x3f6b00, 0x4, 0x920
.long 0x0, 0x0, 0x0, 0x0, 0x0, 0x0, 0x0, 0x0
.long 0xa27c00, 0x289f00, 0x15, 0xd20, 0x113ac00, 0x456b00, 0x10, 0xb20
.long 0x0, 0x0, 0x0, 0x0, 0x0, 0x0, 0x0, 0x0
.long 0xa27c00, 0x1e1f00, 0x15, 0xc20, 0x115ac00, 0x456b00, 0x10, 0x920
.long 0x0, 0x0, 0x0, 0x0, 0x0, 0x0, 0x0, 0x0
.long 0x17e7000, 0x601c00, 0x1a, 0xb20, 0x587000, 0x169c00, 0x6, 0xb20
.long 0xbf7000, 0x305c00, 0x2, 0xb20, 0x0, 0x0, 0x0, 0x0
.long 0x1807000, 0x601c00, 0x1a, 0x920, 0x5a7000, 0x169c00, 0x6, 0x920
.long 0xc17000, 0x305c00, 0x2, 0x920, 0x0, 0x0, 0x0, 0x0
.long 0xb67000, 0x2d9c00, 0x1a, 0xd20, 0x15e7000, 0x581c00, 0xa, 0xb20
.long 0x0, 0x0, 0x0, 0x0, 0x0, 0x0, 0x0, 0x0
.long 0xb67000, 0x209c00, 0x1a, 0xc20, 0x1607000, 0x581c00, 0xa, 0x920
.long 0x0, 0x0, 0x0, 0x0, 0x0, 0x0, 0x0, 0x0
.long 0x17e7400, 0x601d00, 0x1a, 0xb20, 0x587400, 0x169d00, 0x6, 0xb20
.long 0xbf7400, 0x305d00, 0x2, 0xb20, 0x0, 0x0, 0x0, 0x0
.long 0x1807400, 0x601d00, 0x1a, 0x920, 0x5a7400, 0x169d00, 0x6, 0x920
.long 0xc17400, 0x305d00, 0x2, 0x920, 0x0, 0x0, 0x0, 0x0
.long 0xb67400, 0x2d9d00, 0x1a, 0xd20, 0x15e7400, 0x581d00, 0xa, 0xb20
.long 0x0, 0x0, 0x0, 0x0, 0x0, 0x0, 0x0, 0x0
.long 0xb67400, 0x209d00, 0x1a, 0xc20, 0x1607400, 0x581d00, 0xa, 0x920
.long 0x0, 0x0, 0x0, 0x0, 0x0, 0x0, 0x0, 0x0
.long 0x17e7800, 0x601e00, 0x1a, 0xb20, 0x587800, 0x169e00, 0x6, 0xb20
.long 0xbf7800, 0x305e00, 0x2, 0xb20, 0x0, 0x0, 0x0, 0x0
.long 0x1807800, 0x601e00, 0x1a, 0x920, 0x5a7800, 0x169e00, 0x6, 0x920
.long 0xc17800, 0x305e00, 0x2, 0x920, 0x0, 0x0, 0x0, 0x0
.long 0xb67800, 0x2d9e00, 0x1a, 0xd20, 0x15e7800, 0x581e00, 0xa, 0xb20
.long 0x0, 0x0, 0x0, 0x0, 0x0, 0x0, 0x0, 0x0
.long 0xb67800, 0x209e00, 0x1a, 0xc20, 0x1607800, 0x581e00, 0xa, 0x920
.long 0x0, 0x0, 0x0, 0x0, 0x0, 0x0, 0x0, 0x0
.long 0x17e7c00, 0x601f00, 0x1a, 0xb20, 0x587c00, 0x169f00, 0x6, 0xb20
.long 0xbf7c00, 0x305f00, 0x2, 0xb20, 0x0, 0x0, 0x0, 0x0
.long 0x1807c00, 0x601f00, 0x1a, 0x920, 0x5a7c00, 0x169f00, 0x6, 0x920
.long 0xc17c00, 0x305f00, 0x2, 0x920, 0x0, 0x0, 0x0, 0x0
.long 0xb67c00, 0x2d9f00, 0x1a, 0xd20, 0x15e7c00, 0x581f00, 0xa, 0xb20
.long 0x0, 0x0, 0x0, 0x0, 0x0, 0x0, 0x0, 0x0
.long 0xb67c00, 0x209f00, 0x1a, 0xc20, 0x1607c00, 0x581f00, 0xa, 0x920
.long 0x0, 0x0, 0x0, 0x0, 0x0, 0x0, 0x0, 0x0
.long 0x1b67000, 0x6d9c00, 0x1b, 0xd20, 0x483000, 0x128c00, 0xa, 0xb20
.long 0x0, 0x0, 0x0, 0x0, 0x0, 0x0, 0x0, 0x0
.long 0x1b67000, 0x609c00, 0x1b, 0xe20, 0x4a3000, 0x128c00, 0xa, 0x920
.long 0x0, 0x0, 0x0, 0x0, 0x0, 0x0, 0x0, 0x0
.long 0x340000, 0xd8000, 0x1c, 0xb20, 0xcf7000, 0x345c00, 0xa, 0xb20
.long 0x0, 0x0, 0x0, 0x0, 0x0, 0x0, 0x0, 0x0
.long 0x360000, 0xd8000, 0x1c, 0x920, 0xd17000, 0x345c00, 0xa, 0x91e
.long 0x0, 0x0, 0x0, 0x0, 0x0, 0x0, 0x0, 0x0
.long 0x1b67400, 0x6d9d00, 0x1b, 0xd20, 0x483400, 0x128d00, 0xa, 0xb20
.long 0x0, 0x0, 0x0, 0x0, 0x0, 0x0, 0x0, 0x0
.long 0x1b67400, 0x609d00, 0x1b, 0xe20, 0x4a3400, 0x128d00, 0xa, 0x920
.long 0x0, 0x0, 0x0, 0x0, 0x0, 0x0, 0x0, 0x0
.long 0x340400, 0xd8100, 0x1c, 0xb20, 0xcf7400, 0x345d00, 0xa, 0xb20
.long 0x0, 0x0, 0x0, 0x0, 0x0, 0x0, 0x0, 0x0
.long 0x360400, 0xd8100, 0x1c, 0x920, 0xd17400, 0x345d00, 0xa, 0x91e
.long 0x0, 0x0, 0x0, 0x0, 0x0, 0x0, 0x0, 0x0
.long 0x1b67800, 0x6d9e00, 0x1b, 0xd20, 0x483800, 0x128e00, 0xa, 0xb20
.long 0x0, 0x0, 0x0, 0x0, 0x0, 0x0, 0x0, 0x0
.long 0x1b67800, 0x609e00, 0x1b, 0xe20, 0x4a3800, 0x128e00, 0xa, 0x920
.long 0x0, 0x0, 0x0, 0x0, 0x0, 0x0, 0x0, 0x0
.long 0x340800, 0xd8200, 0x1c, 0xb20, 0xcf7800, 0x345e00, 0xa, 0xb20
.long 0x0, 0x0, 0x0, 0x0, 0x0, 0x0, 0x0, 0x0
.long 0x360800, 0xd8200, 0x1c, 0x920, 0xd17800, 0x345e00, 0xa, 0x91e
.long 0x0, 0x0, 0x0, 0x0, 0x0, 0x0, 0x0, 0x0
.long 0x1b67c00, 0x6d9f00, 0x1b, 0xd20, 0x483c00, 0x128f00, 0xa, 0xb20
.long 0x0, 0x0, 0x0, 0x0, 0x0, 0x0, 0x0, 0x0
.long 0x1b67c00, 0x609f00, 0x1b, 0xe20, 0x4a3c00, 0x128f00, 0xa, 0x920
.long 0x0, 0x0, 0x0, 0x0, 0x0, 0x0, 0x0, 0x0
.long 0x340c00, 0xd8300, 0x1c, 0xb20, 0xcf7c00, 0x345f00, 0xa, 0xb20
.long 0x0, 0x0, 0x0, 0x0, 0x0, 0x0, 0x0, 0x0
.long 0x360c00, 0xd8300, 0x1c, 0x920, 0xd17c00, 0x345f00, 0xa, 0x91e
.long 0x0, 0x0, 0x0, 0x0, 0x0, 0x0, 0x0, 0x0
.long 0x123a000, 0x496800, 0x18, 0xb20, 0x1441000, 0x518400, 0x10, 0xb20
.long 0x0, 0x0, 0x0, 0x0, 0x0, 0x0, 0x0, 0x0
.long 0x125a000, 0x496800, 0x18, 0x920, 0x1461000, 0x518400, 0x10, 0x920
.long 0x0, 0x0, 0x0, 0x0, 0x0, 0x0, 0x0, 0x0
.long 0x907000, 0x249c00, 0x22, 0xb20, 0xc77000, 0x325c00, 0x6, 0xb20
.long 0x0, 0x0, 0x0, 0x0, 0x0, 0x0, 0x0, 0x0
.long 0x927000, 0x249c00, 0x22, 0x920, 0xc97000, 0x325c00, 0x6, 0x920
.long 0x0, 0x0, 0x0, 0x0, 0x0, 0x0, 0x0, 0x0
.long 0x123a400, 0x496900, 0x18, 0xb20, 0x1441400, 0x518500, 0x10, 0xb20
.long 0x0, 0x0, 0x0, 0x0, 0x0, 0x0, 0x0, 0x0
.long 0x125a400, 0x496900, 0x18, 0x920, 0x1461400, 0x518500, 0x10, 0x920
.long 0x0, 0x0, 0x0, 0x0, 0x0, 0x0, 0x0, 0x0
.long 0x907400, 0x249d00, 0x22, 0xb20, 0xc77400, 0x325d00, 0x6, 0xb20
.long 0x0, 0x0, 0x0, 0x0, 0x0, 0x0, 0x0, 0x0
.long 0x927400, 0x249d00, 0x22, 0x920, 0xc97400, 0x325d00, 0x6, 0x920
.long 0x0, 0x0, 0x0, 0x0, 0x0, 0x0, 0x0, 0x0
.long 0x123a800, 0x496a00, 0x18, 0xb20, 0x1441800, 0x518600, 0x10, 0xb20
.long 0x0, 0x0, 0x0, 0x0, 0x0, 0x0, 0x0, 0x0
.long 0x125a800, 0x496a00, 0x18, 0x920, 0x1461800, 0x518600, 0x10, 0x920
.long 0x0, 0x0, 0x0, 0x0, 0x0, 0x0, 0x0, 0x0
.long 0x907800, 0x249e00, 0x22, 0xb20, 0xc77800, 0x325e00, 0x6, 0xb20
.long 0x0, 0x0, 0x0, 0x0, 0x0, 0x0, 0x0, 0x0
.long 0x927800, 0x249e00, 0x22, 0x920, 0xc97800, 0x325e00, 0x6, 0x920
.long 0x0, 0x0, 0x0, 0x0, 0x0, 0x0, 0x0, 0x0
.long 0x123ac00, 0x496b00, 0x18, 0xb20, 0x1441c00, 0x518700, 0x10, 0xb20
.long 0x0, 0x0, 0x0, 0x0, 0x0, 0x0, 0x0, 0x0
.long 0x125ac00, 0x496b00, 0x18, 0x920, 0x1461c00, 0x518700, 0x10, 0x920
.long 0x0, 0x0, 0x0, 0x0, 0x0, 0x0, 0x0, 0x0
.long 0x907c00, 0x249f00, 0x22, 0xb20, 0xc77c00, 0x325f00, 0x6, 0xb20
.long 0x0, 0x0, 0x0, 0x0, 0x0, 0x0, 0x0, 0x0
.long 0x927c00, 0x249f00, 0x22, 0x920, 0xc97c00, 0x325f00, 0x6, 0x920
.long 0x0, 0x0, 0x0, 0x0, 0x0, 0x0, 0x0, 0x0
.long 0x17a7000, 0x5f1c00, 0x18, 0xb20, 0x1301000, 0x4c8400, 0x6, 0xb20
.long 0x1527000, 0x551c00, 0x4, 0xb20, 0x0, 0x0, 0x0, 0x0
.long 0x17c7000, 0x5f1c00, 0x18, 0x920, 0x1321000, 0x4c8400, 0x6, 0x920
.long 0x1547000, 0x551c00, 0x4, 0x920, 0x0, 0x0, 0x0, 0x0
.long 0xb87000, 0x2e1c00, 0x1b, 0xd20, 0xcb7000, 0x335c00, 0x8, 0xb20
.long 0x0, 0x0, 0x0, 0x0, 0x0, 0x0, 0x0, 0x0
.long 0xb87000, 0x211c00, 0x1b, 0xe20, 0xcd7000, 0x335c00, 0x8, 0x920
.long 0x0, 0x0, 0x0, 0x0, 0x0, 0x0, 0x0, 0x0
.long 0x17a7400, 0x5f1d00, 0x18, 0xb20, 0x1301400, 0x4c8500, 0x6, 0xb20
.long 0x1527400, 0x551d00, 0x4, 0xb20, 0x0, 0x0, 0x0, 0x0
.long 0x17c7400, 0x5f1d00, 0x18, 0x920, 0x1321400, 0x4c8500, 0x6, 0x920
.long 0x1547400, 0x551d00, 0x4, 0x920, 0x0, 0x0, 0x0, 0x0
.long 0xb87400, 0x2e1d00, 0x1b, 0xd20, 0xcb7400, 0x335d00, 0x8, 0xb20
.long 0x0, 0x0, 0x0, 0x0, 0x0, 0x0, 0x0, 0x0
.long 0xb87400, 0x211d00, 0x1b, 0xe20, 0xcd7400, 0x335d00, 0x8, 0x920
.long 0x0, 0x0, 0x0, 0x0, 0x0, 0x0, 0x0, 0x0
.long 0x17a7800, 0x5f1e00, 0x18, 0xb20, 0x1301800, 0x4c8600, 0x6, 0xb20
.long 0x1527800, 0x551e00, 0x4, 0xb20, 0x0, 0x0, 0x0, 0x0
.long 0x17c7800, 0x5f1e00, 0x18, 0x920, 0x1321800, 0x4c8600, 0x6, 0x920
.long 0x1547800, 0x551e00, 0x4, 0x920, 0x0, 0x0, 0x0, 0x0
.long 0xb87800, 0x2e1e00, 0x1b, 0xd20, 0xcb7800, 0x335e00, 0x8, 0xb20
.long 0x0, 0x0, 0x0, 0x0, 0x0, 0x0, 0x0, 0x0
.long 0xb87800, 0x211e00, 0x1b, 0xe20, 0xcd7800, 0x335e00, 0x8, 0x920
.long 0x0, 0x0, 0x0, 0x0, 0x0, 0x0, 0x0, 0x0
.long 0x17a7c00, 0x5f1f00, 0x18, 0xb20, 0x1301c00, 0x4c8700, 0x6, 0xb20
.long 0x1527c00, 0x551f00, 0x4, 0xb20, 0x0, 0x0, 0x0, 0x0
.long 0x17c7c00, 0x5f1f00, 0x18, 0x920, 0x1321c00, 0x4c8700, 0x6, 0x920
.long 0x1547c00, 0x551f00, 0x4, 0x920, 0x0, 0x0, 0x0, 0x0
.long 0xb87c00, 0x2e1f00, 0x1b, 0xd20, 0xcb7c00, 0x335f00, 0x8, 0xb20
.long 0x0, 0x0, 0x0, 0x0, 0x0, 0x0, 0x0, 0x0
.long 0xb87c00, 0x211f00, 0x1b, 0xe20, 0xcd7c00, 0x335f00, 0x8, 0x920
.long 0x0, 0x0, 0x0, 0x0, 0x0, 0x0, 0x0, 0x0
.long 0x18a7000, 0x631c00, 0x20, 0xb20, 0x80000, 0x28000, 0x6, 0xb20
.long 0x0, 0x0, 0x0, 0x0, 0x0, 0x0, 0x0, 0x0
.long 0x18c7000, 0x631c00, 0x20, 0x920, 0xa0000, 0x28000, 0x6, 0x920
.long 0x0, 0x0, 0x0, 0x0, 0x0, 0x0, 0x0, 0x0
.long 0xbe7000, 0x2f9c00, 0x1c, 0xd10, 0x443000, 0x118c00, 0x8, 0xb20
.long 0x0, 0x0, 0x0, 0x0, 0x0, 0x0, 0x0, 0x0
.long 0xbe7000, 0x219c00, 0x1c, 0xc10, 0x463000, 0x118c00, 0x8, 0x920
.long 0x0, 0x0, 0x0, 0x0, 0x0, 0x0, 0x0, 0x0
.long 0x18a7400, 0x631d00, 0x20, 0xb20, 0x80400, 0x28100, 0x6, 0xb20
.long 0x0, 0x0, 0x0, 0x0, 0x0, 0x0, 0x0, 0x0
.long 0x18c7400, 0x631d00, 0x20, 0x920, 0xa0400, 0x28100, 0x6, 0x920
.long 0x0, 0x0, 0x0, 0x0, 0x0, 0x0, 0x0, 0x0
.long 0xbe7400, 0x2f9d00, 0x1c, 0xd10, 0x443400, 0x118d00, 0x8, 0xb20
.long 0x0, 0x0, 0x0, 0x0, 0x0, 0x0, 0x0, 0x0
.long 0xbe7400, 0x219d00, 0x1c, 0xc10, 0x463400, 0x118d00, 0x8, 0x920
.long 0x0, 0x0, 0x0, 0x0, 0x0, 0x0, 0x0, 0x0
.long 0x18a7800, 0x631e00, 0x20, 0xb20, 0x80800, 0x28200, 0x6, 0xb20
.long 0x0, 0x0, 0x0, 0x0, 0x0, 0x0, 0x0, 0x0
.long 0x18c7800, 0x631e00, 0x20, 0x920, 0xa0800, 0x28200, 0x6, 0x920
.long 0x0, 0x0, 0x0, 0x0, 0x0, 0x0, 0x0, 0x0
.long 0xbe7800, 0x2f9e00, 0x1c, 0xd10, 0x443800, 0x118e00, 0x8, 0xb20
.long 0x0, 0x0, 0x0, 0x0, 0x0, 0x0, 0x0, 0x0
.long 0xbe7800, 0x219e00, 0x1c, 0xc10, 0x463800, 0x118e00, 0x8, 0x920
.long 0x0, 0x0, 0x0, 0x0, 0x0, 0x0, 0x0, 0x0
.long 0x18a7c00, 0x631f00, 0x20, 0xb20, 0x80c00, 0x28300, 0x6, 0xb20
.long 0x0, 0x0, 0x0, 0x0, 0x0, 0x0, 0x0, 0x0
.long 0x18c7c00, 0x631f00, 0x20, 0x920, 0xa0c00, 0x28300, 0x6, 0x920
.long 0x0, 0x0, 0x0, 0x0, 0x0, 0x0, 0x0, 0x0
.long 0xbe7c00, 0x2f9f00, 0x1c, 0xd10, 0x443c00, 0x118f00, 0x8, 0xb20
.long 0x0, 0x0, 0x0, 0x0, 0x0, 0x0, 0x0, 0x0
.long 0xbe7c00, 0x219f00, 0x1c, 0xc10, 0x463c00, 0x118f00, 0x8, 0x920
.long 0x0, 0x0, 0x0, 0x0, 0x0, 0x0, 0x0, 0x0
.long 0x1ae7000, 0x6b9c00, 0x19, 0xd20, 0x10ba000, 0x436800, 0xc, 0xb20
.long 0x0, 0x0, 0x0, 0x0, 0x0, 0x0, 0x0, 0x0
.long 0x1ae7000, 0x5f9c00, 0x19, 0xe20, 0x10da000, 0x436800, 0xc, 0x920
.long 0x0, 0x0, 0x0, 0x0, 0x0, 0x0, 0x0, 0x0
.long 0x947000, 0x259c00, 0x24, 0xb20, 0x383000, 0xe8c00, 0x2, 0xb20
.long 0x0, 0x0, 0x0, 0x0, 0x0, 0x0, 0x0, 0x0
.long 0x967000, 0x259c00, 0x24, 0x920, 0x3a3000, 0xe8c00, 0x2, 0x920
.long 0x0, 0x0, 0x0, 0x0, 0x0, 0x0, 0x0, 0x0
.long 0x1ae7400, 0x6b9d00, 0x19, 0xd20, 0x10ba400, 0x436900, 0xc, 0xb20
.long 0x0, 0x0, 0x0, 0x0, 0x0, 0x0, 0x0, 0x0
.long 0x1ae7400, 0x5f9d00, 0x19, 0xe20, 0x10da400, 0x436900, 0xc, 0x920
.long 0x0, 0x0, 0x0, 0x0, 0x0, 0x0, 0x0, 0x0
.long 0x947400, 0x259d00, 0x24, 0xb20, 0x383400, 0xe8d00, 0x2, 0xb20
.long 0x0, 0x0, 0x0, 0x0, 0x0, 0x0, 0x0, 0x0
.long 0x967400, 0x259d00, 0x24, 0x920, 0x3a3400, 0xe8d00, 0x2, 0x920
.long 0x0, 0x0, 0x0, 0x0, 0x0, 0x0, 0x0, 0x0
.long 0x1ae7800, 0x6b9e00, 0x19, 0xd20, 0x10ba800, 0x436a00, 0xc, 0xb20
.long 0x0, 0x0, 0x0, 0x0, 0x0, 0x0, 0x0, 0x0
.long 0x1ae7800, 0x5f9e00, 0x19, 0xe20, 0x10da800, 0x436a00, 0xc, 0x920
.long 0x0, 0x0, 0x0, 0x0, 0x0, 0x0, 0x0, 0x0
.long 0x947800, 0x259e00, 0x24, 0xb20, 0x383800, 0xe8e00, 0x2, 0xb20
.long 0x0, 0x0, 0x0, 0x0, 0x0, 0x0, 0x0, 0x0
.long 0x967800, 0x259e00, 0x24, 0x920, 0x3a3800, 0xe8e00, 0x2, 0x920
.long 0x0, 0x0, 0x0, 0x0, 0x0, 0x0, 0x0, 0x0
.long 0x1ae7c00, 0x6b9f00, 0x19, 0xd20, 0x10bac00, 0x436b00, 0xc, 0xb20
.long 0x0, 0x0, 0x0, 0x0, 0x0, 0x0, 0x0, 0x0
.long 0x1ae7c00, 0x5f9f00, 0x19, 0xe20, 0x10dac00, 0x436b00, 0xc, 0x920
.long 0x0, 0x0, 0x0, 0x0, 0x0, 0x0, 0x0, 0x0
.long 0x947c00, 0x259f00, 0x24, 0xb20, 0x383c00, 0xe8f00, 0x2, 0xb20
.long 0x0, 0x0, 0x0, 0x0, 0x0, 0x0, 0x0, 0x0
.long 0x967c00, 0x259f00, 0x24, 0x920, 0x3a3c00, 0xe8f00, 0x2, 0x920
.long 0x0, 0x0, 0x0, 0x0, 0x0, 0x0, 0x0, 0x0
.long 0x1ba7000, 0x6e9c00, 0x1c, 0xd20, 0x15a7000, 0x571c00, 0x8, 0xb20
.long 0x0, 0x0, 0x0, 0x0, 0x0, 0x0, 0x0, 0x0
.long 0x1ba7000, 0x611c00, 0x1c, 0xe20, 0x15c7000, 0x571c00, 0x8, 0x920
.long 0x0, 0x0, 0x0, 0x0, 0x0, 0x0, 0x0, 0x0
.long 0xaa7000, 0x2a9c00, 0x17, 0xd20, 0x180000, 0x68000, 0xe, 0xb20
.long 0x0, 0x0, 0x0, 0x0, 0x0, 0x0, 0x0, 0x0
.long 0xaa7000, 0x1f1c00, 0x17, 0xc20, 0x1a0000, 0x68000, 0xe, 0x920
.long 0x0, 0x0, 0x0, 0x0, 0x0, 0x0, 0x0, 0x0
.long 0x1ba7400, 0x6e9d00, 0x1c, 0xd20, 0x15a7400, 0x571d00, 0x8, 0xb20
.long 0x0, 0x0, 0x0, 0x0, 0x0, 0x0, 0x0, 0x0
.long 0x1ba7400, 0x611d00, 0x1c, 0xe20, 0x15c7400, 0x571d00, 0x8, 0x920
.long 0x0, 0x0, 0x0, 0x0, 0x0, 0x0, 0x0, 0x0
.long 0xaa7400, 0x2a9d00, 0x17, 0xd20, 0x180400, 0x68100, 0xe, 0xb20
.long 0x0, 0x0, 0x0, 0x0, 0x0, 0x0, 0x0, 0x0
.long 0xaa7400, 0x1f1d00, 0x17, 0xc20, 0x1a0400, 0x68100, 0xe, 0x920
.long 0x0, 0x0, 0x0, 0x0, 0x0, 0x0, 0x0, 0x0
.long 0x1ba7800, 0x6e9e00, 0x1c, 0xd20, 0x15a7800, 0x571e00, 0x8, 0xb20
.long 0x0, 0x0, 0x0, 0x0, 0x0, 0x0, 0x0, 0x0
.long 0x1ba7800, 0x611e00, 0x1c, 0xe20, 0x15c7800, 0x571e00, 0x8, 0x920
.long 0x0, 0x0, 0x0, 0x0, 0x0, 0x0, 0x0, 0x0
.long 0xaa7800, 0x2a9e00, 0x17, 0xd20, 0x180800, 0x68200, 0xe, 0xb20
.long 0x0, 0x0, 0x0, 0x0, 0x0, 0x0, 0x0, 0x0
.long 0xaa7800, 0x1f1e00, 0x17, 0xc20, 0x1a0800, 0x68200, 0xe, 0x920
.long 0x0, 0x0, 0x0, 0x0, 0x0, 0x0, 0x0, 0x0
.long 0x1ba7c00, 0x6e9f00, 0x1c, 0xd20, 0x15a7c00, 0x571f00, 0x8, 0xb20
.long 0x0, 0x0, 0x0, 0x0, 0x0, 0x0, 0x0, 0x0
.long 0x1ba7c00, 0x611f00, 0x1c, 0xe20, 0x15c7c00, 0x571f00, 0x8, 0x920
.long 0x0, 0x0, 0x0, 0x0, 0x0, 0x0, 0x0, 0x0
.long 0xaa7c00, 0x2a9f00, 0x17, 0xd20, 0x180c00, 0x68300, 0xe, 0xb20
.long 0x0, 0x0, 0x0, 0x0, 0x0, 0x0, 0x0, 0x0
.long 0xaa7c00, 0x1f1f00, 0x17, 0xc20, 0x1a0c00, 0x68300, 0xe, 0x920
.long 0x0, 0x0, 0x0, 0x0, 0x0, 0x0, 0x0, 0x0
.long 0xa67000, 0x299c00, 0x16, 0xd20, 0xeb5000, 0x3b5400, 0xe, 0xb20
.long 0x0, 0x0, 0x0, 0x0, 0x0, 0x0, 0x0, 0x0
.long 0xa67000, 0x1e9c00, 0x16, 0xc20, 0xed5000, 0x3b5400, 0xe, 0x920
.long 0x0, 0x0, 0x0, 0x0, 0x0, 0x0, 0x0, 0x0
.long 0xae7000, 0x2b9c00, 0x18, 0xd20, 0x547000, 0x159c00, 0x4, 0xb20
.long 0xc37000, 0x315c00, 0x4, 0xb20, 0x0, 0x0, 0x0, 0x0
.long 0xae7000, 0x1f9c00, 0x18, 0xc20, 0x567000, 0x159c00, 0x4, 0x920
.long 0xc57000, 0x315c00, 0x4, 0x920, 0x0, 0x0, 0x0, 0x0
.long 0xa67400, 0x299d00, 0x16, 0xd20, 0xeb5400, 0x3b5500, 0xe, 0xb20
.long 0x0, 0x0, 0x0, 0x0, 0x0, 0x0, 0x0, 0x0
.long 0xa67400, 0x1e9d00, 0x16, 0xc20, 0xed5400, 0x3b5500, 0xe, 0x920
.long 0x0, 0x0, 0x0, 0x0, 0x0, 0x0, 0x0, 0x0
.long 0xae7400, 0x2b9d00, 0x18, 0xd20, 0x547400, 0x159d00, 0x4, 0xb20
.long 0xc37400, 0x315d00, 0x4, 0xb20, 0x0, 0x0, 0x0, 0x0
.long 0xae7400, 0x1f9d00, 0x18, 0xc20, 0x567400, 0x159d00, 0x4, 0x920
.long 0xc57400, 0x315d00, 0x4, 0x920, 0x0, 0x0, 0x0, 0x0
.long 0xa67800, 0x299e00, 0x16, 0xd20, 0xeb5800, 0x3b5600, 0xe, 0xb20
.long 0x0, 0x0, 0x0, 0x0, 0x0, 0x0, 0x0, 0x0
.long 0xa67800, 0x1e9e00, 0x16, 0xc20, 0xed5800, 0x3b5600, 0xe, 0x920
.long 0x0, 0x0, 0x0, 0x0, 0x0, 0x0, 0x0, 0x0
.long 0xae7800, 0x2b9e00, 0x18, 0xd20, 0x547800, 0x159e00, 0x4, 0xb20
.long 0xc37800, 0x315e00, 0x4, 0xb20, 0x0, 0x0, 0x0, 0x0
.long 0xae7800, 0x1f9e00, 0x18, 0xc20, 0x567800, 0x159e00, 0x4, 0x920
.long 0xc57800, 0x315e00, 0x4, 0x920, 0x0, 0x0, 0x0, 0x0
.long 0xa67c00, 0x299f00, 0x16, 0xd20, 0xeb5c00, 0x3b5700, 0xe, 0xb20
.long 0x0, 0x0, 0x0, 0x0, 0x0, 0x0, 0x0, 0x0
.long 0xa67c00, 0x1e9f00, 0x16, 0xc20, 0xed5c00, 0x3b5700, 0xe, 0x920
.long 0x0, 0x0, 0x0, 0x0, 0x0, 0x0, 0x0, 0x0
.long 0xae7c00, 0x2b9f00, 0x18, 0xd20, 0x547c00, 0x159f00, 0x4, 0xb20
.long 0xc37c00, 0x315f00, 0x4, 0xb20, 0x0, 0x0, 0x0, 0x0
.long 0xae7c00, 0x1f9f00, 0x18, 0xc20, 0x567c00, 0x159f00, 0x4, 0x920
.long 0xc57c00, 0x315f00, 0x4, 0x920, 0x0, 0x0, 0x0, 0x0
.long 0x1aa7000, 0x6a9c00, 0x18, 0xd20, 0xe75000, 0x3a5400, 0xc, 0xb20
.long 0x0, 0x0, 0x0, 0x0, 0x0, 0x0, 0x0, 0x0
.long 0x1aa7000, 0x5f1c00, 0x18, 0xe20, 0xe95000, 0x3a5400, 0xc, 0x920
.long 0x0, 0x0, 0x0, 0x0, 0x0, 0x0, 0x0, 0x0
.long 0xb27000, 0x2c9c00, 0x19, 0xd20, 0x1627000, 0x591c00, 0xc, 0xb20
.long 0x0, 0x0, 0x0, 0x0, 0x0, 0x0, 0x0, 0x0
.long 0xb27000, 0x201c00, 0x19, 0xc20, 0x1647000, 0x591c00, 0xc, 0x920
.long 0x0, 0x0, 0x0, 0x0, 0x0, 0x0, 0x0, 0x0
.long 0x1aa7400, 0x6a9d00, 0x18, 0xd20, 0xe75400, 0x3a5500, 0xc, 0xb20
.long 0x0, 0x0, 0x0, 0x0, 0x0, 0x0, 0x0, 0x0
.long 0x1aa7400, 0x5f1d00, 0x18, 0xe20, 0xe95400, 0x3a5500, 0xc, 0x920
.long 0x0, 0x0, 0x0, 0x0, 0x0, 0x0, 0x0, 0x0
.long 0xb27400, 0x2c9d00, 0x19, 0xd20, 0x1627400, 0x591d00, 0xc, 0xb20
.long 0x0, 0x0, 0x0, 0x0, 0x0, 0x0, 0x0, 0x0
.long 0xb27400, 0x201d00, 0x19, 0xc20, 0x1647400, 0x591d00, 0xc, 0x920
.long 0x0, 0x0, 0x0, 0x0, 0x0, 0x0, 0x0, 0x0
.long 0x1aa7800, 0x6a9e00, 0x18, 0xd20, 0xe75800, 0x3a5600, 0xc, 0xb20
.long 0x0, 0x0, 0x0, 0x0, 0x0, 0x0, 0x0, 0x0
.long 0x1aa7800, 0x5f1e00, 0x18, 0xe20, 0xe95800, 0x3a5600, 0xc, 0x920
.long 0x0, 0x0, 0x0, 0x0, 0x0, 0x0, 0x0, 0x0
.long 0xb27800, 0x2c9e00, 0x19, 0xd20, 0x1627800, 0x591e00, 0xc, 0xb20
.long 0x0, 0x0, 0x0, 0x0, 0x0, 0x0, 0x0, 0x0
.long 0xb27800, 0x201e00, 0x19, 0xc20, 0x1647800, 0x591e00, 0xc, 0x920
.long 0x0, 0x0, 0x0, 0x0, 0x0, 0x0, 0x0, 0x0
.long 0x1aa7c00, 0x6a9f00, 0x18, 0xd20, 0xe75c00, 0x3a5700, 0xc, 0xb20
.long 0x0, 0x0, 0x0, 0x0, 0x0, 0x0, 0x0, 0x0
.long 0x1aa7c00, 0x5f1f00, 0x18, 0xe20, 0xe95c00, 0x3a5700, 0xc, 0x920
.long 0x0, 0x0, 0x0, 0x0, 0x0, 0x0, 0x0, 0x0
.long 0xb27c00, 0x2c9f00, 0x19, 0xd20, 0x1627c00, 0x591f00, 0xc, 0xb20
.long 0x0, 0x0, 0x0, 0x0, 0x0, 0x0, 0x0, 0x0
.long 0xb27c00, 0x201f00, 0x19, 0xc20, 0x1647c00, 0x591f00, 0xc, 0x920
.long 0x0, 0x0, 0x0, 0x0, 0x0, 0x0, 0x0, 0x0
.long 0x1ac7000, 0x6b1c00, 0x18, 0xd20, 0x647000, 0x199c00, 0xc, 0xb20
.long 0x0, 0x0, 0x0, 0x0, 0x0, 0x0, 0x0, 0x0
.long 0x1ac7000, 0x5f1c00, 0x18, 0xc20, 0x667000, 0x199c00, 0xc, 0x920
.long 0x0, 0x0, 0x0, 0x0, 0x0, 0x0, 0x0, 0x0
.long 0xac7000, 0x2b1c00, 0x18, 0xd20, 0x4c3000, 0x138c00, 0xc, 0xb20
.long 0x0, 0x0, 0x0, 0x0, 0x0, 0x0, 0x0, 0x0
.long 0xac7000, 0x1f9c00, 0x18, 0xe20, 0x4e3000, 0x138c00, 0xc, 0x920
.long 0x0, 0x0, 0x0, 0x0, 0x0, 0x0, 0x0, 0x0
.long 0x1ac7400, 0x6b1d00, 0x18, 0xd20, 0x647400, 0x199d00, 0xc, 0xb20
.long 0x0, 0x0, 0x0, 0x0, 0x0, 0x0, 0x0, 0x0
.long 0x1ac7400, 0x5f1d00, 0x18, 0xc20, 0x667400, 0x199d00, 0xc, 0x920
.long 0x0, 0x0, 0x0, 0x0, 0x0, 0x0, 0x0, 0x0
.long 0xac7400, 0x2b1d00, 0x18, 0xd20, 0x4c3400, 0x138d00, 0xc, 0xb20
.long 0x0, 0x0, 0x0, 0x0, 0x0, 0x0, 0x0, 0x0
.long 0xac7400, 0x1f9d00, 0x18, 0xe20, 0x4e3400, 0x138d00, 0xc, 0x920
.long 0x0, 0x0, 0x0, 0x0, 0x0, 0x0, 0x0, 0x0
.long 0x1ac7800, 0x6b1e00, 0x18, 0xd20, 0x647800, 0x199e00, 0xc, 0xb20
.long 0x0, 0x0, 0x0, 0x0, 0x0, 0x0, 0x0, 0x0
.long 0x1ac7800, 0x5f1e00, 0x18, 0xc20, 0x667800, 0x199e00, 0xc, 0x920
.long 0x0, 0x0, 0x0, 0x0, 0x0, 0x0, 0x0, 0x0
.long 0xac7800, 0x2b1e00, 0x18, 0xd20, 0x4c3800, 0x138e00, 0xc, 0xb20
.long 0x0, 0x0, 0x0, 0x0, 0x0, 0x0, 0x0, 0x0
.long 0xac7800, 0x1f9e00, 0x18, 0xe20, 0x4e3800, 0x138e00, 0xc, 0x920
.long 0x0, 0x0, 0x0, 0x0, 0x0, 0x0, 0x0, 0x0
.long 0x1ac7c00, 0x6b1f00, 0x18, 0xd20, 0x647c00, 0x199f00, 0xc, 0xb20
.long 0x0, 0x0, 0x0, 0x0, 0x0, 0x0, 0x0, 0x0
.long 0x1ac7c00, 0x5f1f00, 0x18, 0xc20, 0x667c00, 0x199f00, 0xc, 0x920
.long 0x0, 0x0, 0x0, 0x0, 0x0, 0x0, 0x0, 0x0
.long 0xac7c00, 0x2b1f00, 0x18, 0xd20, 0x4c3c00, 0x138f00, 0xc, 0xb20
.long 0x0, 0x0, 0x0, 0x0, 0x0, 0x0, 0x0, 0x0
.long 0xac7c00, 0x1f9f00, 0x18, 0xe20, 0x4e3c00, 0x138f00, 0xc, 0x920
.long 0x0, 0x0, 0x0, 0x0, 0x0, 0x0, 0x0, 0x0
.long 0x1b07000, 0x6c1c00, 0x19, 0xd20, 0x13c1000, 0x4f8400, 0xc, 0xb20
.long 0x0, 0x0, 0x0, 0x0, 0x0, 0x0, 0x0, 0x0
.long 0x1b07000, 0x5f9c00, 0x19, 0xc20, 0x13e1000, 0x4f8400, 0xc, 0x920
.long 0x0, 0x0, 0x0, 0x0, 0x0, 0x0, 0x0, 0x0
.long 0xb07000, 0x2c1c00, 0x19, 0xd20, 0x140000, 0x58000, 0xc, 0xb20
.long 0x0, 0x0, 0x0, 0x0, 0x0, 0x0, 0x0, 0x0
.long 0xb07000, 0x201c00, 0x19, 0xe20, 0x160000, 0x58000, 0xc, 0x920
.long 0x0, 0x0, 0x0, 0x0, 0x0, 0x0, 0x0, 0x0
.long 0x1b07400, 0x6c1d00, 0x19, 0xd20, 0x13c1400, 0x4f8500, 0xc, 0xb20
.long 0x0, 0x0, 0x0, 0x0, 0x0, 0x0, 0x0, 0x0
.long 0x1b07400, 0x5f9d00, 0x19, 0xc20, 0x13e1400, 0x4f8500, 0xc, 0x920
.long 0x0, 0x0, 0x0, 0x0, 0x0, 0x0, 0x0, 0x0
.long 0xb07400, 0x2c1d00, 0x19, 0xd20, 0x140400, 0x58100, 0xc, 0xb20
.long 0x0, 0x0, 0x0, 0x0, 0x0, 0x0, 0x0, 0x0
.long 0xb07400, 0x201d00, 0x19, 0xe20, 0x160400, 0x58100, 0xc, 0x920
.long 0x0, 0x0, 0x0, 0x0, 0x0, 0x0, 0x0, 0x0
.long 0x1b07800, 0x6c1e00, 0x19, 0xd20, 0x13c1800, 0x4f8600, 0xc, 0xb20
.long 0x0, 0x0, 0x0, 0x0, 0x0, 0x0, 0x0, 0x0
.long 0x1b07800, 0x5f9e00, 0x19, 0xc20, 0x13e1800, 0x4f8600, 0xc, 0x920
.long 0x0, 0x0, 0x0, 0x0, 0x0, 0x0, 0x0, 0x0
.long 0xb07800, 0x2c1e00, 0x19, 0xd20, 0x140800, 0x58200, 0xc, 0xb20
.long 0x0, 0x0, 0x0, 0x0, 0x0, 0x0, 0x0, 0x0
.long 0xb07800, 0x201e00, 0x19, 0xe20, 0x160800, 0x58200, 0xc, 0x920
.long 0x0, 0x0, 0x0, 0x0, 0x0, 0x0, 0x0, 0x0
.long 0x1b07c00, 0x6c1f00, 0x19, 0xd20, 0x13c1c00, 0x4f8700, 0xc, 0xb20
.long 0x0, 0x0, 0x0, 0x0, 0x0, 0x0, 0x0, 0x0
.long 0x1b07c00, 0x5f9f00, 0x19, 0xc20, 0x13e1c00, 0x4f8700, 0xc, 0x920
.long 0x0, 0x0, 0x0, 0x0, 0x0, 0x0, 0x0, 0x0
.long 0xb07c00, 0x2c1f00, 0x19, 0xd20, 0x140c00, 0x58300, 0xc, 0xb20
.long 0x0, 0x0, 0x0, 0x0, 0x0, 0x0, 0x0, 0x0
.long 0xb07c00, 0x201f00, 0x19, 0xe20, 0x160c00, 0x58300, 0xc, 0x920
.long 0x0, 0x0, 0x0, 0x0, 0x0, 0x0, 0x0, 0x0
.long 0x1c07000, 0x701c00, 0x1d, 0xd05, 0x1567000, 0x561c00, 0x6, 0xb20
.long 0x0, 0x0, 0x0, 0x0, 0x0, 0x0, 0x0, 0x0
.long 0x1c07000, 0x619c00, 0x1d, 0xc05, 0x1587000, 0x561c00, 0x6, 0x920
.long 0x0, 0x0, 0x0, 0x0, 0x0, 0x0, 0x0, 0x0
.long 0xa07000, 0x281c00, 0x15, 0xd20, 0xef5000, 0x3c5400, 0x10, 0xb20
.long 0x0, 0x0, 0x0, 0x0, 0x0, 0x0, 0x0, 0x0
.long 0xa07000, 0x1e1c00, 0x15, 0xe20, 0xf15000, 0x3c5400, 0x10, 0x920
.long 0x0, 0x0, 0x0, 0x0, 0x0, 0x0, 0x0, 0x0
.long 0x1c07400, 0x701d00, 0x1d, 0xd05, 0x1567400, 0x561d00, 0x6, 0xb20
.long 0x0, 0x0, 0x0, 0x0, 0x0, 0x0, 0x0, 0x0
.long 0x1c07400, 0x619d00, 0x1d, 0xc05, 0x1587400, 0x561d00, 0x6, 0x920
.long 0x0, 0x0, 0x0, 0x0, 0x0, 0x0, 0x0, 0x0
.long 0xa07400, 0x281d00, 0x15, 0xd20, 0xef5400, 0x3c5500, 0x10, 0xb20
.long 0x0, 0x0, 0x0, 0x0, 0x0, 0x0, 0x0, 0x0
.long 0xa07400, 0x1e1d00, 0x15, 0xe20, 0xf15400, 0x3c5500, 0x10, 0x920
.long 0x0, 0x0, 0x0, 0x0, 0x0, 0x0, 0x0, 0x0
.long 0x1c07800, 0x701e00, 0x1d, 0xd05, 0x1567800, 0x561e00, 0x6, 0xb20
.long 0x0, 0x0, 0x0, 0x0, 0x0, 0x0, 0x0, 0x0
.long 0x1c07800, 0x619e00, 0x1d, 0xc05, 0x1587800, 0x561e00, 0x6, 0x920
.long 0x0, 0x0, 0x0, 0x0, 0x0, 0x0, 0x0, 0x0
.long 0xa07800, 0x281e00, 0x15, 0xd20, 0xef5800, 0x3c5600, 0x10, 0xb20
.long 0x0, 0x0, 0x0, 0x0, 0x0, 0x0, 0x0, 0x0
.long 0xa07800, 0x1e1e00, 0x15, 0xe20, 0xf15800, 0x3c5600, 0x10, 0x920
.long 0x0, 0x0, 0x0, 0x0, 0x0, 0x0, 0x0, 0x0
.long 0x1c07c00, 0x701f00, 0x1d, 0xd05, 0x1567c00, 0x561f00, 0x6, 0xb20
.long 0x0, 0x0, 0x0, 0x0, 0x0, 0x0, 0x0, 0x0
.long 0x1c07c00, 0x619f00, 0x1d, 0xc05, 0x1587c00, 0x561f00, 0x6, 0x920
.long 0x0, 0x0, 0x0, 0x0, 0x0, 0x0, 0x0, 0x0
.long 0xa07c00, 0x281f00, 0x15, 0xd20, 0xef5c00, 0x3c5700, 0x10, 0xb20
.long 0x0, 0x0, 0x0, 0x0, 0x0, 0x0, 0x0, 0x0
.long 0xa07c00, 0x1e1f00, 0x15, 0xe20, 0xf15c00, 0x3c5700, 0x10, 0x920
.long 0x0, 0x0, 0x0, 0x0, 0x0, 0x0, 0x0, 0x0
.long 0x1867000, 0x621c00, 0x1e, 0xb20, 0x5c7000, 0x179c00, 0x8, 0xb20
.long 0x0, 0x0, 0x0, 0x0, 0x0, 0x0, 0x0, 0x0
.long 0x1887000, 0x621c00, 0x1e, 0x920, 0x5e7000, 0x179c00, 0x8, 0x920
.long 0x0, 0x0, 0x0, 0x0, 0x0, 0x0, 0x0, 0x0
.long 0xa87000, 0x2a1c00, 0x17, 0xd20, 0x10fa000, 0x446800, 0xe, 0xb20
.long 0x0, 0x0, 0x0, 0x0, 0x0, 0x0, 0x0, 0x0
.long 0xa87000, 0x1f1c00, 0x17, 0xe20, 0x111a000, 0x446800, 0xe, 0x920
.long 0x0, 0x0, 0x0, 0x0, 0x0, 0x0, 0x0, 0x0
.long 0x1867400, 0x621d00, 0x1e, 0xb20, 0x5c7400, 0x179d00, 0x8, 0xb20
.long 0x0, 0x0, 0x0, 0x0, 0x0, 0x0, 0x0, 0x0
.long 0x1887400, 0x621d00, 0x1e, 0x920, 0x5e7400, 0x179d00, 0x8, 0x920
.long 0x0, 0x0, 0x0, 0x0, 0x0, 0x0, 0x0, 0x0
.long 0xa87400, 0x2a1d00, 0x17, 0xd20, 0x10fa400, 0x446900, 0xe, 0xb20
.long 0x0, 0x0, 0x0, 0x0, 0x0, 0x0, 0x0, 0x0
.long 0xa87400, 0x1f1d00, 0x17, 0xe20, 0x111a400, 0x446900, 0xe, 0x920
.long 0x0, 0x0, 0x0, 0x0, 0x0, 0x0, 0x0, 0x0
.long 0x1867800, 0x621e00, 0x1e, 0xb20, 0x5c7800, 0x179e00, 0x8, 0xb20
.long 0x0, 0x0, 0x0, 0x0, 0x0, 0x0, 0x0, 0x0
.long 0x1887800, 0x621e00, 0x1e, 0x920, 0x5e7800, 0x179e00, 0x8, 0x920
.long 0x0, 0x0, 0x0, 0x0, 0x0, 0x0, 0x0, 0x0
.long 0xa87800, 0x2a1e00, 0x17, 0xd20, 0x10fa800, 0x446a00, 0xe, 0xb20
.long 0x0, 0x0, 0x0, 0x0, 0x0, 0x0, 0x0, 0x0
.long 0xa87800, 0x1f1e00, 0x17, 0xe20, 0x111a800, 0x446a00, 0xe, 0x920
.long 0x0, 0x0, 0x0, 0x0, 0x0, 0x0, 0x0, 0x0
.long 0x1867c00, 0x621f00, 0x1e, 0xb20, 0x5c7c00, 0x179f00, 0x8, 0xb20
.long 0x0, 0x0, 0x0, 0x0, 0x0, 0x0, 0x0, 0x0
.long 0x1887c00, 0x621f00, 0x1e, 0x920, 0x5e7c00, 0x179f00, 0x8, 0x920
.long 0x0, 0x0, 0x0, 0x0, 0x0, 0x0, 0x0, 0x0
.long 0xa87c00, 0x2a1f00, 0x17, 0xd20, 0x10fac00, 0x446b00, 0xe, 0xb20
.long 0x0, 0x0, 0x0, 0x0, 0x0, 0x0, 0x0, 0x0
.long 0xa87c00, 0x1f1f00, 0x17, 0xe20, 0x111ac00, 0x446b00, 0xe, 0x920
.long 0x0, 0x0, 0x0, 0x0, 0x0, 0x0, 0x0, 0x0
.long 0x1b27000, 0x6c9c00, 0x1a, 0xd20, 0x607000, 0x189c00, 0xa, 0xb20
.long 0x0, 0x0, 0x0, 0x0, 0x0, 0x0, 0x0, 0x0
.long 0x1b27000, 0x601c00, 0x1a, 0xe20, 0x627000, 0x189c00, 0xa, 0x920
.long 0x0, 0x0, 0x0, 0x0, 0x0, 0x0, 0x0, 0x0
.long 0xb47000, 0x2d1c00, 0x1a, 0xd20, 0x100000, 0x48000, 0xa, 0xb20
.long 0x0, 0x0, 0x0, 0x0, 0x0, 0x0, 0x0, 0x0
.long 0xb47000, 0x209c00, 0x1a, 0xe20, 0x120000, 0x48000, 0xa, 0x920
.long 0x0, 0x0, 0x0, 0x0, 0x0, 0x0, 0x0, 0x0
.long 0x1b27400, 0x6c9d00, 0x1a, 0xd20, 0x607400, 0x189d00, 0xa, 0xb20
.long 0x0, 0x0, 0x0, 0x0, 0x0, 0x0, 0x0, 0x0
.long 0x1b27400, 0x601d00, 0x1a, 0xe20, 0x627400, 0x189d00, 0xa, 0x920
.long 0x0, 0x0, 0x0, 0x0, 0x0, 0x0, 0x0, 0x0
.long 0xb47400, 0x2d1d00, 0x1a, 0xd20, 0x100400, 0x48100, 0xa, 0xb20
.long 0x0, 0x0, 0x0, 0x0, 0x0, 0x0, 0x0, 0x0
.long 0xb47400, 0x209d00, 0x1a, 0xe20, 0x120400, 0x48100, 0xa, 0x920
.long 0x0, 0x0, 0x0, 0x0, 0x0, 0x0, 0x0, 0x0
.long 0x1b27800, 0x6c9e00, 0x1a, 0xd20, 0x607800, 0x189e00, 0xa, 0xb20
.long 0x0, 0x0, 0x0, 0x0, 0x0, 0x0, 0x0, 0x0
.long 0x1b27800, 0x601e00, 0x1a, 0xe20, 0x627800, 0x189e00, 0xa, 0x920
.long 0x0, 0x0, 0x0, 0x0, 0x0, 0x0, 0x0, 0x0
.long 0xb47800, 0x2d1e00, 0x1a, 0xd20, 0x100800, 0x48200, 0xa, 0xb20
.long 0x0, 0x0, 0x0, 0x0, 0x0, 0x0, 0x0, 0x0
.long 0xb47800, 0x209e00, 0x1a, 0xe20, 0x120800, 0x48200, 0xa, 0x920
.long 0x0, 0x0, 0x0, 0x0, 0x0, 0x0, 0x0, 0x0
.long 0x1b27c00, 0x6c9f00, 0x1a, 0xd20, 0x607c00, 0x189f00, 0xa, 0xb20
.long 0x0, 0x0, 0x0, 0x0, 0x0, 0x0, 0x0, 0x0
.long 0x1b27c00, 0x601f00, 0x1a, 0xe20, 0x627c00, 0x189f00, 0xa, 0x920
.long 0x0, 0x0, 0x0, 0x0, 0x0, 0x0, 0x0, 0x0
.long 0xb47c00, 0x2d1f00, 0x1a, 0xd20, 0x100c00, 0x48300, 0xa, 0xb20
.long 0x0, 0x0, 0x0, 0x0, 0x0, 0x0, 0x0, 0x0
.long 0xb47c00, 0x209f00, 0x1a, 0xe20, 0x120c00, 0x48300, 0xa, 0x920
.long 0x0, 0x0, 0x0, 0x0, 0x0, 0x0, 0x0, 0x0
.long 0x1827000, 0x611c00, 0x1c, 0xb20, 0xe35000, 0x395400, 0xa, 0xb20
.long 0x0, 0x0, 0x0, 0x0, 0x0, 0x0, 0x0, 0x0
.long 0x1847000, 0x611c00, 0x1c, 0x920, 0xe55000, 0x395400, 0xa, 0x920
.long 0x0, 0x0, 0x0, 0x0, 0x0, 0x0, 0x0, 0x0
.long 0xba7000, 0x2e9c00, 0x1b, 0xd20, 0x503000, 0x140c00, 0x7, 0xd04
.long 0x0, 0x0, 0x0, 0x0, 0x0, 0x0, 0x0, 0x0
.long 0xba7000, 0x211c00, 0x1b, 0xc20, 0x503000, 0x110c00, 0x7, 0xe04
.long 0x0, 0x0, 0x0, 0x0, 0x0, 0x0, 0x0, 0x0
.long 0x1827400, 0x611d00, 0x1c, 0xb20, 0xe35400, 0x395500, 0xa, 0xb20
.long 0x0, 0x0, 0x0, 0x0, 0x0, 0x0, 0x0, 0x0
.long 0x1847400, 0x611d00, 0x1c, 0x920, 0xe55400, 0x395500, 0xa, 0x920
.long 0x0, 0x0, 0x0, 0x0, 0x0, 0x0, 0x0, 0x0
.long 0xba7400, 0x2e9d00, 0x1b, 0xd20, 0x503400, 0x140d00, 0x7, 0xd04
.long 0x0, 0x0, 0x0, 0x0, 0x0, 0x0, 0x0, 0x0
.long 0xba7400, 0x211d00, 0x1b, 0xc20, 0x503400, 0x110d00, 0x7, 0xe04
.long 0x0, 0x0, 0x0, 0x0, 0x0, 0x0, 0x0, 0x0
.long 0x1827800, 0x611e00, 0x1c, 0xb20, 0xe35800, 0x395600, 0xa, 0xb20
.long 0x0, 0x0, 0x0, 0x0, 0x0, 0x0, 0x0, 0x0
.long 0x1847800, 0x611e00, 0x1c, 0x920, 0xe55800, 0x395600, 0xa, 0x920
.long 0x0, 0x0, 0x0, 0x0, 0x0, 0x0, 0x0, 0x0
.long 0xba7800, 0x2e9e00, 0x1b, 0xd20, 0x503800, 0x140e00, 0x7, 0xd04
.long 0x0, 0x0, 0x0, 0x0, 0x0, 0x0, 0x0, 0x0
.long 0xba7800, 0x211e00, 0x1b, 0xc20, 0x503800, 0x110e00, 0x7, 0xe04
.long 0x0, 0x0, 0x0, 0x0, 0x0, 0x0, 0x0, 0x0
.long 0x1827c00, 0x611f00, 0x1c, 0xb20, 0xe35c00, 0x395700, 0xa, 0xb20
.long 0x0, 0x0, 0x0, 0x0, 0x0, 0x0, 0x0, 0x0
.long 0x1847c00, 0x611f00, 0x1c, 0x920, 0xe55c00, 0x395700, 0xa, 0x920
.long 0x0, 0x0, 0x0, 0x0, 0x0, 0x0, 0x0, 0x0
.long 0xba7c00, 0x2e9f00, 0x1b, 0xd20, 0x503c00, 0x140f00, 0x7, 0xd04
.long 0x0, 0x0, 0x0, 0x0, 0x0, 0x0, 0x0, 0x0
.long 0xba7c00, 0x211f00, 0x1b, 0xc20, 0x503c00, 0x110f00, 0x7, 0xe04
.long 0x0, 0x0, 0x0, 0x0, 0x0, 0x0, 0x0, 0x0
.long 0x240000, 0x98000, 0x14, 0xb20, 0x11ba000, 0x476800, 0x14, 0xb20
.long 0x0, 0x0, 0x0, 0x0, 0x0, 0x0, 0x0, 0x0
.long 0x260000, 0x98000, 0x14, 0x920, 0x11da000, 0x476800, 0x14, 0x920
.long 0x0, 0x0, 0x0, 0x0, 0x0, 0x0, 0x0, 0x0
.long 0x7c7000, 0x1f9c00, 0x18, 0xb20, 0x127a000, 0x49e800, 0xd, 0xd07
.long 0x0, 0x0, 0x0, 0x0, 0x0, 0x0, 0x0, 0x0
.long 0x7e7000, 0x1f9c00, 0x18, 0x920, 0x127a000, 0x43e800, 0xd, 0xe07
.long 0x0, 0x0, 0x0, 0x0, 0x0, 0x0, 0x0, 0x0
.long 0x240400, 0x98100, 0x14, 0xb20, 0x11ba400, 0x476900, 0x14, 0xb20
.long 0x0, 0x0, 0x0, 0x0, 0x0, 0x0, 0x0, 0x0
.long 0x260400, 0x98100, 0x14, 0x920, 0x11da400, 0x476900, 0x14, 0x920
.long 0x0, 0x0, 0x0, 0x0, 0x0, 0x0, 0x0, 0x0
.long 0x7c7400, 0x1f9d00, 0x18, 0xb20, 0x127a400, 0x49e900, 0xd, 0xd07
.long 0x0, 0x0, 0x0, 0x0, 0x0, 0x0, 0x0, 0x0
.long 0x7e7400, 0x1f9d00, 0x18, 0x920, 0x127a400, 0x43e900, 0xd, 0xe07
.long 0x0, 0x0, 0x0, 0x0, 0x0, 0x0, 0x0, 0x0
.long 0x240800, 0x98200, 0x14, 0xb20, 0x11ba800, 0x476a00, 0x14, 0xb20
.long 0x0, 0x0, 0x0, 0x0, 0x0, 0x0, 0x0, 0x0
.long 0x260800, 0x98200, 0x14, 0x920, 0x11da800, 0x476a00, 0x14, 0x920
.long 0x0, 0x0, 0x0, 0x0, 0x0, 0x0, 0x0, 0x0
.long 0x7c7800, 0x1f9e00, 0x18, 0xb20, 0x127a800, 0x49ea00, 0xd, 0xd07
.long 0x0, 0x0, 0x0, 0x0, 0x0, 0x0, 0x0, 0x0
.long 0x7e7800, 0x1f9e00, 0x18, 0x920, 0x127a800, 0x43ea00, 0xd, 0xe07
.long 0x0, 0x0, 0x0, 0x0, 0x0, 0x0, 0x0, 0x0
.long 0x240c00, 0x98300, 0x14, 0xb20, 0x11bac00, 0x476b00, 0x14, 0xb20
.long 0x0, 0x0, 0x0, 0x0, 0x0, 0x0, 0x0, 0x0
.long 0x260c00, 0x98300, 0x14, 0x920, 0x11dac00, 0x476b00, 0x14, 0x920
.long 0x0, 0x0, 0x0, 0x0, 0x0, 0x0, 0x0, 0x0
.long 0x7c7c00, 0x1f9f00, 0x18, 0xb20, 0x127ac00, 0x49eb00, 0xd, 0xd07
.long 0x0, 0x0, 0x0, 0x0, 0x0, 0x0, 0x0, 0x0
.long 0x7e7c00, 0x1f9f00, 0x18, 0x920, 0x127ac00, 0x43eb00, 0xd, 0xe07
.long 0x0, 0x0, 0x0, 0x0, 0x0, 0x0, 0x0, 0x0
.long 0xa47000, 0x291c00, 0x16, 0xd20, 0x1667000, 0x5a1c00, 0xe, 0xb20
.long 0x0, 0x0, 0x0, 0x0, 0x0, 0x0, 0x0, 0x0
.long 0xa47000, 0x1e9c00, 0x16, 0xe20, 0x1687000, 0x5a1c00, 0xe, 0x920
.long 0x0, 0x0, 0x0, 0x0, 0x0, 0x0, 0x0, 0x0
.long 0x2c0000, 0xb8000, 0x18, 0xb20, 0x16a7000, 0x5b1c00, 0x10, 0xb20
.long 0x0, 0x0, 0x0, 0x0, 0x0, 0x0, 0x0, 0x0
.long 0x2e0000, 0xb8000, 0x18, 0x920, 0x16c7000, 0x5b1c00, 0x10, 0x920
.long 0x0, 0x0, 0x0, 0x0, 0x0, 0x0, 0x0, 0x0
.long 0xa47400, 0x291d00, 0x16, 0xd20, 0x1667400, 0x5a1d00, 0xe, 0xb20
.long 0x0, 0x0, 0x0, 0x0, 0x0, 0x0, 0x0, 0x0
.long 0xa47400, 0x1e9d00, 0x16, 0xe20, 0x1687400, 0x5a1d00, 0xe, 0x920
.long 0x0, 0x0, 0x0, 0x0, 0x0, 0x0, 0x0, 0x0
.long 0x2c0400, 0xb8100, 0x18, 0xb20, 0x16a7400, 0x5b1d00, 0x10, 0xb20
.long 0x0, 0x0, 0x0, 0x0, 0x0, 0x0, 0x0, 0x0
.long 0x2e0400, 0xb8100, 0x18, 0x920, 0x16c7400, 0x5b1d00, 0x10, 0x920
.long 0x0, 0x0, 0x0, 0x0, 0x0, 0x0, 0x0, 0x0
.long 0xa47800, 0x291e00, 0x16, 0xd20, 0x1667800, 0x5a1e00, 0xe, 0xb20
.long 0x0, 0x0, 0x0, 0x0, 0x0, 0x0, 0x0, 0x0
.long 0xa47800, 0x1e9e00, 0x16, 0xe20, 0x1687800, 0x5a1e00, 0xe, 0x920
.long 0x0, 0x0, 0x0, 0x0, 0x0, 0x0, 0x0, 0x0
.long 0x2c0800, 0xb8200, 0x18, 0xb20, 0x16a7800, 0x5b1e00, 0x10, 0xb20
.long 0x0, 0x0, 0x0, 0x0, 0x0, 0x0, 0x0, 0x0
.long 0x2e0800, 0xb8200, 0x18, 0x920, 0x16c7800, 0x5b1e00, 0x10, 0x920
.long 0x0, 0x0, 0x0, 0x0, 0x0, 0x0, 0x0, 0x0
.long 0xa47c00, 0x291f00, 0x16, 0xd20, 0x1667c00, 0x5a1f00, 0xe, 0xb20
.long 0x0, 0x0, 0x0, 0x0, 0x0, 0x0, 0x0, 0x0
.long 0xa47c00, 0x1e9f00, 0x16, 0xe20, 0x1687c00, 0x5a1f00, 0xe, 0x920
.long 0x0, 0x0, 0x0, 0x0, 0x0, 0x0, 0x0, 0x0
.long 0x2c0c00, 0xb8300, 0x18, 0xb20, 0x16a7c00, 0x5b1f00, 0x10, 0xb20
.long 0x0, 0x0, 0x0, 0x0, 0x0, 0x0, 0x0, 0x0
.long 0x2e0c00, 0xb8300, 0x18, 0x920, 0x16c7c00, 0x5b1f00, 0x10, 0x920
.long 0x0, 0x0, 0x0, 0x0, 0x0, 0x0, 0x0, 0x0
.long 0x747000, 0x1d9c00, 0x14, 0xb20, 0x117a000, 0x466800, 0x12, 0xb20
.long 0x0, 0x0, 0x0, 0x0, 0x0, 0x0, 0x0, 0x0
.long 0x767000, 0x1d9c00, 0x14, 0x920, 0x119a000, 0x466800, 0x12, 0x920
.long 0x0, 0x0, 0x0, 0x0, 0x0, 0x0, 0x0, 0x0
.long 0x280000, 0xa8000, 0x16, 0xb20, 0x200000, 0x88000, 0x12, 0xb20
.long 0x0, 0x0, 0x0, 0x0, 0x0, 0x0, 0x0, 0x0
.long 0x2a0000, 0xa8000, 0x16, 0x920, 0x220000, 0x88000, 0x12, 0x920
.long 0x0, 0x0, 0x0, 0x0, 0x0, 0x0, 0x0, 0x0
.long 0x747400, 0x1d9d00, 0x14, 0xb20, 0x117a400, 0x466900, 0x12, 0xb20
.long 0x0, 0x0, 0x0, 0x0, 0x0, 0x0, 0x0, 0x0
.long 0x767400, 0x1d9d00, 0x14, 0x920, 0x119a400, 0x466900, 0x12, 0x920
.long 0x0, 0x0, 0x0, 0x0, 0x0, 0x0, 0x0, 0x0
.long 0x280400, 0xa8100, 0x16, 0xb20, 0x200400, 0x88100, 0x12, 0xb20
.long 0x0, 0x0, 0x0, 0x0, 0x0, 0x0, 0x0, 0x0
.long 0x2a0400, 0xa8100, 0x16, 0x920, 0x220400, 0x88100, 0x12, 0x920
.long 0x0, 0x0, 0x0, 0x0, 0x0, 0x0, 0x0, 0x0
.long 0x747800, 0x1d9e00, 0x14, 0xb20, 0x117a800, 0x466a00, 0x12, 0xb20
.long 0x0, 0x0, 0x0, 0x0, 0x0, 0x0, 0x0, 0x0
.long 0x767800, 0x1d9e00, 0x14, 0x920, 0x119a800, 0x466a00, 0x12, 0x920
.long 0x0, 0x0, 0x0, 0x0, 0x0, 0x0, 0x0, 0x0
.long 0x280800, 0xa8200, 0x16, 0xb20, 0x200800, 0x88200, 0x12, 0xb20
.long 0x0, 0x0, 0x0, 0x0, 0x0, 0x0, 0x0, 0x0
.long 0x2a0800, 0xa8200, 0x16, 0x920, 0x220800, 0x88200, 0x12, 0x920
.long 0x0, 0x0, 0x0, 0x0, 0x0, 0x0, 0x0, 0x0
.long 0x747c00, 0x1d9f00, 0x14, 0xb20, 0x117ac00, 0x466b00, 0x12, 0xb20
.long 0x0, 0x0, 0x0, 0x0, 0x0, 0x0, 0x0, 0x0
.long 0x767c00, 0x1d9f00, 0x14, 0x920, 0x119ac00, 0x466b00, 0x12, 0x920
.long 0x0, 0x0, 0x0, 0x0, 0x0, 0x0, 0x0, 0x0
.long 0x280c00, 0xa8300, 0x16, 0xb20, 0x200c00, 0x88300, 0x12, 0xb20
.long 0x0, 0x0, 0x0, 0x0, 0x0, 0x0, 0x0, 0x0
.long 0x2a0c00, 0xa8300, 0x16, 0x920, 0x220c00, 0x88300, 0x12, 0x920
.long 0x0, 0x0, 0x0, 0x0, 0x0, 0x0, 0x0, 0x0
.long 0x1bc7000, 0x6f1c00, 0x1c, 0xd20, 0xc0000, 0x38000, 0x8, 0xb20
.long 0x0, 0x0, 0x0, 0x0, 0x0, 0x0, 0x0, 0x0
.long 0x1bc7000, 0x611c00, 0x1c, 0xc20, 0xe0000, 0x38000, 0x8, 0x920
.long 0x0, 0x0, 0x0, 0x0, 0x0, 0x0, 0x0, 0x0
.long 0x11fa000, 0x486800, 0x16, 0xb20, 0x16e7000, 0x5c1c00, 0x12, 0xb20
.long 0x0, 0x0, 0x0, 0x0, 0x0, 0x0, 0x0, 0x0
.long 0x121a000, 0x486800, 0x16, 0x920, 0x1707000, 0x5c1c00, 0x12, 0x920
.long 0x0, 0x0, 0x0, 0x0, 0x0, 0x0, 0x0, 0x0
.long 0x1bc7400, 0x6f1d00, 0x1c, 0xd20, 0xc0400, 0x38100, 0x8, 0xb20
.long 0x0, 0x0, 0x0, 0x0, 0x0, 0x0, 0x0, 0x0
.long 0x1bc7400, 0x611d00, 0x1c, 0xc20, 0xe0400, 0x38100, 0x8, 0x920
.long 0x0, 0x0, 0x0, 0x0, 0x0, 0x0, 0x0, 0x0
.long 0x11fa400, 0x486900, 0x16, 0xb20, 0x16e7400, 0x5c1d00, 0x12, 0xb20
.long 0x0, 0x0, 0x0, 0x0, 0x0, 0x0, 0x0, 0x0
.long 0x121a400, 0x486900, 0x16, 0x920, 0x1707400, 0x5c1d00, 0x12, 0x920
.long 0x0, 0x0, 0x0, 0x0, 0x0, 0x0, 0x0, 0x0
.long 0x1bc7800, 0x6f1e00, 0x1c, 0xd20, 0xc0800, 0x38200, 0x8, 0xb20
.long 0x0, 0x0, 0x0, 0x0, 0x0, 0x0, 0x0, 0x0
.long 0x1bc7800, 0x611e00, 0x1c, 0xc20, 0xe0800, 0x38200, 0x8, 0x920
.long 0x0, 0x0, 0x0, 0x0, 0x0, 0x0, 0x0, 0x0
.long 0x11fa800, 0x486a00, 0x16, 0xb20, 0x16e7800, 0x5c1e00, 0x12, 0xb20
.long 0x0, 0x0, 0x0, 0x0, 0x0, 0x0, 0x0, 0x0
.long 0x121a800, 0x486a00, 0x16, 0x920, 0x1707800, 0x5c1e00, 0x12, 0x920
.long 0x0, 0x0, 0x0, 0x0, 0x0, 0x0, 0x0, 0x0
.long 0x1bc7c00, 0x6f1f00, 0x1c, 0xd20, 0xc0c00, 0x38300, 0x8, 0xb20
.long 0x0, 0x0, 0x0, 0x0, 0x0, 0x0, 0x0, 0x0
.long 0x1bc7c00, 0x611f00, 0x1c, 0xc20, 0xe0c00, 0x38300, 0x8, 0x920
.long 0x0, 0x0, 0x0, 0x0, 0x0, 0x0, 0x0, 0x0
.long 0x11fac00, 0x486b00, 0x16, 0xb20, 0x16e7c00, 0x5c1f00, 0x12, 0xb20
.long 0x0, 0x0, 0x0, 0x0, 0x0, 0x0, 0x0, 0x0
.long 0x121ac00, 0x486b00, 0x16, 0x920, 0x1707c00, 0x5c1f00, 0x12, 0x920
.long 0x0, 0x0, 0x0, 0x0, 0x0, 0x0, 0x0, 0x0
.long 0x1767000, 0x5e1c00, 0x16, 0xb20, 0x707000, 0x1c9c00, 0x12, 0xb20
.long 0x0, 0x0, 0x0, 0x0, 0x0, 0x0, 0x0, 0x0
.long 0x1787000, 0x5e1c00, 0x16, 0x920, 0x727000, 0x1c9c00, 0x12, 0x920
.long 0x0, 0x0, 0x0, 0x0, 0x0, 0x0, 0x0, 0x0
.long 0x787000, 0x1e9c00, 0x16, 0xb20, 0x380000, 0xe0000, 0xf, 0xd03
.long 0x0, 0x0, 0x0, 0x0, 0x0, 0x0, 0x0, 0x0
.long 0x7a7000, 0x1e9c00, 0x16, 0x920, 0x380000, 0x70000, 0xf, 0xe03
.long 0x0, 0x0, 0x0, 0x0, 0x0, 0x0, 0x0, 0x0
.long 0x1767400, 0x5e1d00, 0x16, 0xb20, 0x707400, 0x1c9d00, 0x12, 0xb20
.long 0x0, 0x0, 0x0, 0x0, 0x0, 0x0, 0x0, 0x0
.long 0x1787400, 0x5e1d00, 0x16, 0x920, 0x727400, 0x1c9d00, 0x12, 0x920
.long 0x0, 0x0, 0x0, 0x0, 0x0, 0x0, 0x0, 0x0
.long 0x787400, 0x1e9d00, 0x16, 0xb20, 0x380400, 0xe0100, 0xf, 0xd03
.long 0x0, 0x0, 0x0, 0x0, 0x0, 0x0, 0x0, 0x0
.long 0x7a7400, 0x1e9d00, 0x16, 0x920, 0x380400, 0x70100, 0xf, 0xe03
.long 0x0, 0x0, 0x0, 0x0, 0x0, 0x0, 0x0, 0x0
.long 0x1767800, 0x5e1e00, 0x16, 0xb20, 0x707800, 0x1c9e00, 0x12, 0xb20
.long 0x0, 0x0, 0x0, 0x0, 0x0, 0x0, 0x0, 0x0
.long 0x1787800, 0x5e1e00, 0x16, 0x920, 0x727800, 0x1c9e00, 0x12, 0x920
.long 0x0, 0x0, 0x0, 0x0, 0x0, 0x0, 0x0, 0x0
.long 0x787800, 0x1e9e00, 0x16, 0xb20, 0x380800, 0xe0200, 0xf, 0xd03
.long 0x0, 0x0, 0x0, 0x0, 0x0, 0x0, 0x0, 0x0
.long 0x7a7800, 0x1e9e00, 0x16, 0x920, 0x380800, 0x70200, 0xf, 0xe03
.long 0x0, 0x0, 0x0, 0x0, 0x0, 0x0, 0x0, 0x0
.long 0x1767c00, 0x5e1f00, 0x16, 0xb20, 0x707c00, 0x1c9f00, 0x12, 0xb20
.long 0x0, 0x0, 0x0, 0x0, 0x0, 0x0, 0x0, 0x0
.long 0x1787c00, 0x5e1f00, 0x16, 0x920, 0x727c00, 0x1c9f00, 0x12, 0x920
.long 0x0, 0x0, 0x0, 0x0, 0x0, 0x0, 0x0, 0x0
.long 0x787c00, 0x1e9f00, 0x16, 0xb20, 0x380c00, 0xe0300, 0xf, 0xd03
.long 0x0, 0x0, 0x0, 0x0, 0x0, 0x0, 0x0, 0x0
.long 0x7a7c00, 0x1e9f00, 0x16, 0x920, 0x380c00, 0x70300, 0xf, 0xe03
.long 0x0, 0x0, 0x0, 0x0, 0x0, 0x0, 0x0, 0x0
.long 0x1c0000, 0x78000, 0x10, 0xb20, 0x6c7000, 0x1b9c00, 0x10, 0xb20
.long 0xf7a000, 0x3e6800, 0x2, 0xb20, 0x0, 0x0, 0x0, 0x0
.long 0x1e0000, 0x78000, 0x10, 0x920, 0x6e7000, 0x1b9c00, 0x10, 0x920
.long 0xf9a000, 0x3e6800, 0x2, 0x920, 0x0, 0x0, 0x0, 0x0
.long 0x1a27000, 0x689c00, 0x16, 0xd20, 0x687000, 0x1a9c00, 0xe, 0xb20
.long 0x0, 0x0, 0x0, 0x0, 0x0, 0x0, 0x0, 0x0
.long 0x1a27000, 0x5e1c00, 0x16, 0xe20, 0x6a7000, 0x1a9c00, 0xe, 0x920
.long 0x0, 0x0, 0x0, 0x0, 0x0, 0x0, 0x0, 0x0
.long 0x1c0400, 0x78100, 0x10, 0xb20, 0x6c7400, 0x1b9d00, 0x10, 0xb20
.long 0xf7a400, 0x3e6900, 0x2, 0xb20, 0x0, 0x0, 0x0, 0x0
.long 0x1e0400, 0x78100, 0x10, 0x920, 0x6e7400, 0x1b9d00, 0x10, 0x920
.long 0xf9a400, 0x3e6900, 0x2, 0x920, 0x0, 0x0, 0x0, 0x0
.long 0x1a27400, 0x689d00, 0x16, 0xd20, 0x687400, 0x1a9d00, 0xe, 0xb20
.long 0x0, 0x0, 0x0, 0x0, 0x0, 0x0, 0x0, 0x0
.long 0x1a27400, 0x5e1d00, 0x16, 0xe20, 0x6a7400, 0x1a9d00, 0xe, 0x920
.long 0x0, 0x0, 0x0, 0x0, 0x0, 0x0, 0x0, 0x0
.long 0x1c0800, 0x78200, 0x10, 0xb20, 0x6c7800, 0x1b9e00, 0x10, 0xb20
.long 0xf7a800, 0x3e6a00, 0x2, 0xb20, 0x0, 0x0, 0x0, 0x0
.long 0x1e0800, 0x78200, 0x10, 0x920, 0x6e7800, 0x1b9e00, 0x10, 0x920
.long 0xf9a800, 0x3e6a00, 0x2, 0x920, 0x0, 0x0, 0x0, 0x0
.long 0x1a27800, 0x689e00, 0x16, 0xd20, 0x687800, 0x1a9e00, 0xe, 0xb20
.long 0x0, 0x0, 0x0, 0x0, 0x0, 0x0, 0x0, 0x0
.long 0x1a27800, 0x5e1e00, 0x16, 0xe20, 0x6a7800, 0x1a9e00, 0xe, 0x920
.long 0x0, 0x0, 0x0, 0x0, 0x0, 0x0, 0x0, 0x0
.long 0x1c0c00, 0x78300, 0x10, 0xb20, 0x6c7c00, 0x1b9f00, 0x10, 0xb20
.long 0xf7ac00, 0x3e6b00, 0x2, 0xb20, 0x0, 0x0, 0x0, 0x0
.long 0x1e0c00, 0x78300, 0x10, 0x920, 0x6e7c00, 0x1b9f00, 0x10, 0x920
.long 0xf9ac00, 0x3e6b00, 0x2, 0x920, 0x0, 0x0, 0x0, 0x0
.long 0x1a27c00, 0x689f00, 0x16, 0xd20, 0x687c00, 0x1a9f00, 0xe, 0xb20
.long 0x0, 0x0, 0x0, 0x0, 0x0, 0x0, 0x0, 0x0
.long 0x1a27c00, 0x5e1f00, 0x16, 0xe20, 0x6a7c00, 0x1a9f00, 0xe, 0x920
.long 0x0, 0x0, 0x0, 0x0, 0x0, 0x0, 0x0, 0x0
.long 0x14c1000, 0x538400, 0x14, 0xb20, 0x1481000, 0x528400, 0x12, 0xb20
.long 0x0, 0x0, 0x0, 0x0, 0x0, 0x0, 0x0, 0x0
.long 0x14e1000, 0x538400, 0x14, 0x906, 0x14a1000, 0x528400, 0x12, 0x920
.long 0x0, 0x0, 0x0, 0x0, 0x0, 0x0, 0x0, 0x0
.long 0x1727000, 0x5d1c00, 0x14, 0xb20, 0xf35000, 0x3d5400, 0x12, 0xb20
.long 0x0, 0x0, 0x0, 0x0, 0x0, 0x0, 0x0, 0x0
.long 0x1747000, 0x5d1c00, 0x14, 0x920, 0xf55000, 0x3d5400, 0x12, 0x920
.long 0x0, 0x0, 0x0, 0x0, 0x0, 0x0, 0x0, 0x0
.long 0x14c1400, 0x538500, 0x14, 0xb20, 0x1481400, 0x528500, 0x12, 0xb20
.long 0x0, 0x0, 0x0, 0x0, 0x0, 0x0, 0x0, 0x0
.long 0x14e1400, 0x538500, 0x14, 0x906, 0x14a1400, 0x528500, 0x12, 0x920
.long 0x0, 0x0, 0x0, 0x0, 0x0, 0x0, 0x0, 0x0
.long 0x1727400, 0x5d1d00, 0x14, 0xb20, 0xf35400, 0x3d5500, 0x12, 0xb20
.long 0x0, 0x0, 0x0, 0x0, 0x0, 0x0, 0x0, 0x0
.long 0x1747400, 0x5d1d00, 0x14, 0x920, 0xf55400, 0x3d5500, 0x12, 0x920
.long 0x0, 0x0, 0x0, 0x0, 0x0, 0x0, 0x0, 0x0
.long 0x14c1800, 0x538600, 0x14, 0xb20, 0x1481800, 0x528600, 0x12, 0xb20
.long 0x0, 0x0, 0x0, 0x0, 0x0, 0x0, 0x0, 0x0
.long 0x14e1800, 0x538600, 0x14, 0x906, 0x14a1800, 0x528600, 0x12, 0x920
.long 0x0, 0x0, 0x0, 0x0, 0x0, 0x0, 0x0, 0x0
.long 0x1727800, 0x5d1e00, 0x14, 0xb20, 0xf35800, 0x3d5600, 0x12, 0xb20
.long 0x0, 0x0, 0x0, 0x0, 0x0, 0x0, 0x0, 0x0
.long 0x1747800, 0x5d1e00, 0x14, 0x920, 0xf55800, 0x3d5600, 0x12, 0x920
.long 0x0, 0x0, 0x0, 0x0, 0x0, 0x0, 0x0, 0x0
.long 0x14c1c00, 0x538700, 0x14, 0xb20, 0x1481c00, 0x528700, 0x12, 0xb20
.long 0x0, 0x0, 0x0, 0x0, 0x0, 0x0, 0x0, 0x0
.long 0x14e1c00, 0x538700, 0x14, 0x906, 0x14a1c00, 0x528700, 0x12, 0x920
.long 0x0, 0x0, 0x0, 0x0, 0x0, 0x0, 0x0, 0x0
.long 0x1727c00, 0x5d1f00, 0x14, 0xb20, 0xf35c00, 0x3d5700, 0x12, 0xb20
.long 0x0, 0x0, 0x0, 0x0, 0x0, 0x0, 0x0, 0x0
.long 0x1747c00, 0x5d1f00, 0x14, 0x920, 0xf55c00, 0x3d5700, 0x12, 0x920
.long 0x0, 0x0, 0x0, 0x0, 0x0, 0x0, 0x0, 0x0
.size jobtab, 32768
.section .rodata,"a"
.p2align 6
.amdhsa_kernel standalone__ragged_sequences_varlen_flash_attn__ragged_kernel
  .amdhsa_next_free_vgpr 392
  .amdhsa_next_free_sgpr 102
  .amdhsa_accum_offset 256
  .amdhsa_group_segment_fixed_size 0
  .amdhsa_kernarg_size 56
  .amdhsa_user_sgpr_count 2
  .amdhsa_user_sgpr_kernarg_segment_ptr 1
  .amdhsa_system_sgpr_workgroup_id_x 1
.end_amdhsa_kernel
```
